```python
import torch

def _softmax(x, axis=-1):
    return torch.softmax(x, dim=axis)
def _gelu(x):
    return torch.nn.functional.gelu(x, approximate="tanh")
def _silu(x):
    return torch.nn.functional.silu(x)
def _sigmoid(x):
    return torch.sigmoid(x)
def _layernorm(x, axis=-1, eps=1e-5):
    m = x.mean(dim=axis, keepdim=True)
    v = x.var(dim=axis, keepdim=True, unbiased=False)
    return (x - m) / torch.sqrt(v + eps)
def _scatter_add(tgt, idx, src, axis=0):
    return tgt.clone().index_add_(axis, idx, src)
def _segment_sum(src, seg, n):
    out = torch.zeros((n,) + src.shape[1:], dtype=src.dtype)
    return out.index_add_(0, seg, src)
def _pad(x, pw):
    flat = tuple(v for pair in reversed(pw) for v in pair)
    return torch.nn.functional.pad(x, flat)

kernel_name = 'concat_heads__gqa_block_cached__gqa_block_cached__near_ridge'

def setup_inputs():

    _w = (lambda a: (lambda t: t.to(torch.bfloat16) if t.is_floating_point() else t)(torch.as_tensor(a)))
    def _A_setup():
        B, Sq, D = 16, 144, 640
        Hq, Hkv, Sk, Dh = 32, 32, 512, 128
        assert Hq % Hkv == 0, (Hq, Hkv)
        return {
            "x": _w((lambda *s: torch.randn(*s, dtype=torch.bfloat16) * 0.8)(B, Sq, D)),
            "k_cache": _w((lambda *s: torch.randn(*s, dtype=torch.bfloat16) * 0.8)(B, Hkv, Sk, Dh)),
            "v_cache": _w((lambda *s: torch.randn(*s, dtype=torch.bfloat16) * 0.05)(B, Hkv, Sk, Dh)),
            "wq": _w((lambda *s: torch.randn(*s, dtype=torch.bfloat16) * 0.8)(D, Hq * Dh) * (D ** -0.5)),
            "wo": _w((lambda *s: torch.randn(*s, dtype=torch.bfloat16) * 0.05)(Hq * Dh, D) * ((Hq * Dh) ** -0.5)),
        }
    _A_in = _A_setup()

    def _B_setup():
        B, Sq, D = 16, 144, 640
        Hq, Hkv, Sk, Dh = 32, 32, 512, 128
        assert Hq % Hkv == 0, (Hq, Hkv)
        return {
            "x": _w((lambda *s: torch.randn(*s, dtype=torch.bfloat16) * 0.8)(B, Sq, D)),
            "k_cache": _w((lambda *s: torch.randn(*s, dtype=torch.bfloat16) * 0.8)(B, Hkv, Sk, Dh)),
            "v_cache": _w((lambda *s: torch.randn(*s, dtype=torch.bfloat16) * 0.05)(B, Hkv, Sk, Dh)),
            "wq": _w((lambda *s: torch.randn(*s, dtype=torch.bfloat16) * 0.8)(D, Hq * Dh) * (D ** -0.5)),
            "wo": _w((lambda *s: torch.randn(*s, dtype=torch.bfloat16) * 0.05)(Hq * Dh, D) * ((Hq * Dh) ** -0.5)),
        }
    _B_in = _B_setup()

    return {
        "A_x": _A_in["x"],
        "A_k_cache": _A_in["k_cache"],
        "A_v_cache": _A_in["v_cache"],
        "A_wq": _A_in["wq"],
        "A_wo": _A_in["wo"],
        "B_x": _B_in["x"],
        "B_k_cache": _B_in["k_cache"],
        "B_v_cache": _B_in["v_cache"],
        "B_wq": _B_in["wq"],
        "B_wo": _B_in["wo"],
    }

def reference(A_x, A_k_cache, A_v_cache, A_wq, A_wo, B_x, B_k_cache, B_v_cache, B_wq, B_wo):
    def _A_ref(x, k_cache, v_cache, wq, wo):
        B, Sq, D = x.shape
        Hq, Dh = 32, 128
        Hkv = k_cache.shape[1]
        rep = Hq // Hkv
        q = (lambda x, *d: x.permute(*d))((x @ wq).reshape(B, Sq, Hq, Dh), 0, 2, 1, 3)
        k = (lambda x, n, axis: torch.repeat_interleave(x, n, dim=axis))(k_cache, rep, axis=1)
        v = (lambda x, n, axis: torch.repeat_interleave(x, n, dim=axis))(v_cache, rep, axis=1)
        scores = torch.einsum("bhqd,bhkd->bhqk", q, k) * (Dh ** -0.5)
        p = _softmax(scores, axis=-1)
        o = torch.einsum("bhqk,bhkd->bhqd", p, v)
        return (lambda x, *d: x.permute(*d))(o, 0, 2, 1, 3).reshape(B, Sq, Hq * Dh) @ wo

    def _B_ref(x, k_cache, v_cache, wq, wo):
        B, Sq, D = x.shape
        Hq, Dh = 32, 128
        Hkv = k_cache.shape[1]
        rep = Hq // Hkv
        q = (lambda x, *d: x.permute(*d))((x @ wq).reshape(B, Sq, Hq, Dh), 0, 2, 1, 3)
        k = (lambda x, n, axis: torch.repeat_interleave(x, n, dim=axis))(k_cache, rep, axis=1)
        v = (lambda x, n, axis: torch.repeat_interleave(x, n, dim=axis))(v_cache, rep, axis=1)
        scores = torch.einsum("bhqd,bhkd->bhqk", q, k) * (Dh ** -0.5)
        p = _softmax(scores, axis=-1)
        o = torch.einsum("bhqk,bhkd->bhqd", p, v)
        return (lambda x, *d: x.permute(*d))(o, 0, 2, 1, 3).reshape(B, Sq, Hq * Dh) @ wo

    a = _A_ref(A_x, A_k_cache, A_v_cache, A_wq, A_wo)
    b = _B_ref(B_x, B_k_cache, B_v_cache, B_wq, B_wo)
    return torch.concatenate([a, b], axis=-1)
```

```asm
; @launch kernel=xprep_kernel grid=(400,1,1) block=(256,1,1) lds=0
; @launch kernel=concat_heads__gqa_block_cached__gqa_block_cached__near_ridge_kernel grid=(1024,1,1) block=(256,1,1) lds=81920
; @launch kernel=oproj_kernel grid=(240,1,1) block=(256,1,1) lds=147456
.amdgcn_target "amdgcn-amd-amdhsa--gfx950"
.text
.globl xprep_kernel
.p2align 8
.type xprep_kernel,@function
xprep_kernel:
    s_cmp_ge_u32 s2, 400
    s_cbranch_scc1 xprep_kernel_end
    s_load_dwordx16 s[64:79], s[0:1], 0
    s_load_dwordx4 s[80:83], s[0:1], 64
    s_load_dwordx2 s[84:85], s[0:1], 80
    s_load_dwordx2 s[86:87], s[0:1], 96
    v_and_b32 v1, 63, v0
    v_lshrrev_b32 v2, 6, v0
    s_nop 0
    v_readfirstlane_b32 s28, v2
    s_lshl_b32 s3, s2, 2
    s_nop 0
    s_add_u32 s3, s3, s28
    s_mul_i32 s4, s3, 6554
    s_lshr_b32 s4, s4, 16
    s_mul_i32 s5, s4, 10
    s_sub_u32 s5, s3, s5
    s_mul_i32 s6, s4, 13108
    s_lshr_b32 s6, s6, 16
    s_mul_i32 s7, s6, 5
    s_sub_u32 s7, s4, s7
    s_lshr_b32 s29, s6, 4
    s_and_b32 s6, s6, 15
    s_mul_i32 s30, s6, 184320
    s_lshl_b32 s31, s5, 7
    s_add_u32 s30, s30, s31
    s_mul_i32 s31, s7, 40960
    s_add_u32 s30, s30, s31
    s_lshl_b32 s31, s3, 12
    s_add_u32 s31, s31, 37748736
    s_mul_i32 s34, s4, 40960
    s_add_u32 s34, s34, 37748736
    s_lshl_b32 s35, s5, 11
    s_add_u32 s34, s34, s35
    s_add_u32 s35, s34, 19456
    s_sub_u32 s36, s34, 1024
    s_add_u32 s37, s34, 18432
    s_cmp_eq_u32 s7, 4
    s_cselect_b32 s32, 15, 31
    s_cselect_b32 s38, 16, 0
    s_movk_i32 s33, 1280
    s_cselect_b32 s34, s34, s31
    s_cselect_b32 s35, s35, s31
    s_cselect_b32 s36, s36, s31
    s_cselect_b32 s37, s37, s31
    v_and_b32 v2, s32, v1
    v_mul_lo_u32 v2, v2, s33
    v_lshrrev_b32 v3, 5, v1
    v_lshl_add_u32 v2, v3, 5, v2
    v_and_b32 v3, s38, v1
    v_add_u32 v2, v2, v3
    v_lshlrev_b32 v3, 4, v1
    s_waitcnt lgkmcnt(0)
    s_cmp_eq_u32 s29, 0
    s_cselect_b32 s8, s64, s74
    s_cselect_b32 s9, s65, s75
    s_mov_b32 s10, 2949120
    s_mov_b32 s11, 0x00020000
    s_mov_b32 s12, s86
    s_and_b32 s13, s87, 0xffff
    s_mov_b32 s14, 44302336
    s_mov_b32 s15, 0x00020000
    buffer_load_dwordx4 v[4:7], v2, s[8:11], s30 offen offset:0
    buffer_load_dwordx4 v[8:11], v2, s[8:11], s30 offen offset:16
    buffer_load_dwordx4 v[12:15], v2, s[8:11], s30 offen offset:64
    buffer_load_dwordx4 v[16:19], v2, s[8:11], s30 offen offset:80
    s_waitcnt vmcnt(3)
    buffer_store_dwordx4 v[4:7], v3, s[12:15], s34 offen offset:0
    s_waitcnt vmcnt(3)
    buffer_store_dwordx4 v[8:11], v3, s[12:15], s35 offen offset:1024
    s_waitcnt vmcnt(3)
    buffer_store_dwordx4 v[12:15], v3, s[12:15], s36 offen offset:2048
    s_waitcnt vmcnt(3)
    buffer_store_dwordx4 v[16:19], v3, s[12:15], s37 offen offset:3072
xprep_kernel_end:
    s_endpgm
.globl concat_heads__gqa_block_cached__gqa_block_cached__near_ridge_kernel
.p2align 8
.type concat_heads__gqa_block_cached__gqa_block_cached__near_ridge_kernel,@function
concat_heads__gqa_block_cached__gqa_block_cached__near_ridge_kernel:
    s_cmp_ge_u32 s2, 1024
    s_cbranch_scc1 concat_heads__gqa_block_cached__gqa_block_cached__near_ridge_kernel_end
    s_load_dwordx16 s[64:79], s[0:1], 0
    s_load_dwordx4 s[80:83], s[0:1], 64
    s_load_dwordx2 s[84:85], s[0:1], 80
    s_load_dwordx2 s[86:87], s[0:1], 96
    v_and_b32 v254, 63, v0
    v_lshrrev_b32 v240, 6, v0
    s_nop 0
    v_readfirstlane_b32 s28, v240
    s_and_b32 s3, s2, 7
    s_lshr_b32 s4, s2, 3
    s_lshr_b32 s29, s3, 2
    s_and_b32 s3, s3, 3
    s_lshl_b32 s3, s3, 3
    s_and_b32 s5, s4, 7
    s_add_u32 s31, s3, s5
    s_lshr_b32 s30, s4, 3
    s_mov_b32 s37, 1040356334
    s_mov_b32 s38, 1115353651
    s_lshl_b32 s3, s29, 4
    s_add_u32 s3, s3, s30
    s_mul_i32 s3, s3, 204800
    s_add_u32 s33, s3, 37912576
    s_mul_i32 s4, s28, 40960
    s_add_u32 s3, s3, s4
    s_add_u32 s32, s3, 37748736
    s_lshl_b32 s36, s28, 12
    s_lshl_b32 s3, s28, 16
    s_lshl_b32 s4, s31, 8
    s_add_u32 s34, s3, s4
    s_lshl_b32 s3, s30, 5
    s_add_u32 s3, s3, s31
    s_lshl_b32 s3, s3, 17
    s_add_u32 s35, s3, s36
    s_lshl_b32 s39, s28, 11
    v_lshrrev_b32 v240, 4, v254
    v_and_b32 v241, 15, v254
    v_xor_b32 v242, v240, v241
    v_lshlrev_b32 v242, 4, v242
    v_lshl_add_u32 v252, v240, 8, v242
    v_lshl_add_u32 v250, v241, 8, v242
    v_lshlrev_b32 v242, 2, v240
    v_xor_b32 v242, v242, v241
    v_lshlrev_b32 v242, 4, v242
    v_lshl_add_u32 v253, v240, 8, v242
    v_lshl_add_u32 v104, v240, 13, v242
    v_xor_b32 v105, 32, v104
    v_and_b32 v242, 31, v254
    v_lshrrev_b32 v243, 5, v254
    v_lshlrev_b32 v106, 4, v254
    s_waitcnt lgkmcnt(0)
    s_cmp_eq_u32 s29, 0
    s_cselect_b32 s12, s66, s76
    s_cselect_b32 s13, s67, s77
    s_mov_b32 s14, 67108864
    s_mov_b32 s15, 0x00020000
    s_cselect_b32 s16, s68, s78
    s_cselect_b32 s17, s69, s79
    s_mov_b32 s18, 67108864
    s_mov_b32 s19, 0x00020000
    s_cselect_b32 s20, s70, s80
    s_cselect_b32 s21, s71, s81
    s_mov_b32 s22, 5242880
    s_mov_b32 s23, 0x00020000
    s_mov_b32 s24, s86
    s_and_b32 s25, s87, 0xffff
    s_mov_b32 s26, 44302336
    s_mov_b32 s27, 0x00020000
    s_add_u32 s40, s34, 0
    s_add_u32 m0, s39, 49152
    s_nop 0
    buffer_load_dwordx4 v104, s[20:23], s40 offen offset:0 lds
    s_add_u32 s40, s34, 32768
    s_add_u32 m0, s39, 50176
    s_nop 0
    buffer_load_dwordx4 v105, s[20:23], s40 offen offset:0 lds
    s_add_u32 s41, s32, 0
    s_add_u32 s42, s33, 0
    buffer_load_dwordx4 v[0:3], v106, s[24:27], s41 offen offset:0
    buffer_load_dwordx4 v[4:7], v106, s[24:27], s41 offen offset:1024
    buffer_load_dwordx4 v[8:11], v106, s[24:27], s42 offen offset:0
    s_add_u32 s40, s34, 262144
    s_add_u32 m0, s39, 57344
    s_nop 0
    buffer_load_dwordx4 v104, s[20:23], s40 offen offset:0 lds
    s_add_u32 s40, s34, 294912
    s_add_u32 m0, s39, 58368
    s_nop 0
    buffer_load_dwordx4 v105, s[20:23], s40 offen offset:0 lds
    s_add_u32 s41, s32, 2048
    s_add_u32 s42, s33, 1024
    buffer_load_dwordx4 v[12:15], v106, s[24:27], s41 offen offset:0
    buffer_load_dwordx4 v[16:19], v106, s[24:27], s41 offen offset:1024
    buffer_load_dwordx4 v[20:23], v106, s[24:27], s42 offen offset:0
    s_add_u32 s40, s34, 524288
    s_add_u32 m0, s39, 0
    s_nop 0
    buffer_load_dwordx4 v104, s[20:23], s40 offen offset:0 lds
    s_add_u32 s40, s34, 557056
    s_add_u32 m0, s39, 1024
    s_nop 0
    buffer_load_dwordx4 v105, s[20:23], s40 offen offset:0 lds
    s_add_u32 s41, s32, 4096
    s_add_u32 s42, s33, 2048
    buffer_load_dwordx4 v[24:27], v106, s[24:27], s41 offen offset:0
    buffer_load_dwordx4 v[28:31], v106, s[24:27], s41 offen offset:1024
    buffer_load_dwordx4 v[32:35], v106, s[24:27], s42 offen offset:0
    s_add_u32 s40, s34, 786432
    s_add_u32 m0, s39, 8192
    s_nop 0
    buffer_load_dwordx4 v104, s[20:23], s40 offen offset:0 lds
    s_add_u32 s40, s34, 819200
    s_add_u32 m0, s39, 9216
    s_nop 0
    buffer_load_dwordx4 v105, s[20:23], s40 offen offset:0 lds
    s_add_u32 s41, s32, 6144
    s_add_u32 s42, s33, 3072
    buffer_load_dwordx4 v[36:39], v106, s[24:27], s41 offen offset:0
    buffer_load_dwordx4 v[40:43], v106, s[24:27], s41 offen offset:1024
    buffer_load_dwordx4 v[44:47], v106, s[24:27], s42 offen offset:0
    s_add_u32 s40, s34, 1048576
    s_add_u32 m0, s39, 16384
    s_nop 0
    buffer_load_dwordx4 v104, s[20:23], s40 offen offset:0 lds
    s_add_u32 s40, s34, 1081344
    s_add_u32 m0, s39, 17408
    s_nop 0
    buffer_load_dwordx4 v105, s[20:23], s40 offen offset:0 lds
    s_add_u32 s41, s32, 8192
    s_add_u32 s42, s33, 4096
    buffer_load_dwordx4 v[48:51], v106, s[24:27], s41 offen offset:0
    buffer_load_dwordx4 v[52:55], v106, s[24:27], s41 offen offset:1024
    buffer_load_dwordx4 v[56:59], v106, s[24:27], s42 offen offset:0
    s_add_u32 s40, s34, 1310720
    s_add_u32 m0, s39, 24576
    s_nop 0
    buffer_load_dwordx4 v104, s[20:23], s40 offen offset:0 lds
    s_add_u32 s40, s34, 1343488
    s_add_u32 m0, s39, 25600
    s_nop 0
    buffer_load_dwordx4 v105, s[20:23], s40 offen offset:0 lds
    s_add_u32 s41, s32, 10240
    s_add_u32 s42, s33, 5120
    buffer_load_dwordx4 v[116:119], v106, s[24:27], s41 offen offset:0
    buffer_load_dwordx4 v[120:123], v106, s[24:27], s41 offen offset:1024
    buffer_load_dwordx4 v[124:127], v106, s[24:27], s42 offen offset:0
    s_add_u32 s40, s35, 0
    s_add_u32 m0, s36, 65536
    s_nop 0
    buffer_load_dwordx4 v252, s[12:15], s40 offen offset:0 nt lds
    v_xor_b32 v108, 64, v252
    buffer_load_dwordx4 v108, s[12:15], s40 offen offset:1024 nt lds
    v_xor_b32 v107, 128, v252
    buffer_load_dwordx4 v107, s[12:15], s40 offen offset:2048 nt lds
    v_xor_b32 v108, 192, v252
    buffer_load_dwordx4 v108, s[12:15], s40 offen offset:3072 nt lds
    v_lshrrev_b32 v244, 2, v241
    v_and_b32 v245, 3, v254
    v_and_b32 v110, 1, v240
    v_and_b32 v111, 1, v245
    v_lshl_add_u32 v111, v110, 1, v111
    v_lshrrev_b32 v112, 1, v245
    v_lshlrev_b32 v112, 3, v112
    s_add_u32 s3, s28, 0
    s_and_b32 s3, s3, 3
    s_lshl_b32 s44, s3, 6
    s_xor_b32 s45, s44, 32
    v_xor_b32 v246, s3, v244
    v_xor_b32 v247, 0, v111
    v_lshl_add_u32 v247, v246, 2, v247
    v_lshl_add_u32 v247, v247, 4, v112
    v_lshl_add_u32 v247, v244, 8, v247
    v_lshl_add_u32 v96, v243, 12, v247
    v_xor_b32 v247, 2, v111
    v_lshl_add_u32 v247, v246, 2, v247
    v_lshl_add_u32 v247, v247, 4, v112
    v_lshl_add_u32 v247, v244, 8, v247
    v_lshl_add_u32 v97, v243, 12, v247
    v_add_u32 v97, 1024, v97
    s_add_u32 s3, s28, 1
    s_and_b32 s3, s3, 3
    s_lshl_b32 s46, s3, 6
    s_xor_b32 s47, s46, 32
    v_xor_b32 v246, s3, v244
    v_xor_b32 v247, 0, v111
    v_lshl_add_u32 v247, v246, 2, v247
    v_lshl_add_u32 v247, v247, 4, v112
    v_lshl_add_u32 v247, v244, 8, v247
    v_lshl_add_u32 v98, v243, 12, v247
    v_xor_b32 v247, 2, v111
    v_lshl_add_u32 v247, v246, 2, v247
    v_lshl_add_u32 v247, v247, 4, v112
    v_lshl_add_u32 v247, v244, 8, v247
    v_lshl_add_u32 v99, v243, 12, v247
    v_add_u32 v99, 1024, v99
    s_add_u32 s3, s28, 2
    s_and_b32 s3, s3, 3
    s_lshl_b32 s48, s3, 6
    s_xor_b32 s49, s48, 32
    v_xor_b32 v246, s3, v244
    v_xor_b32 v247, 0, v111
    v_lshl_add_u32 v247, v246, 2, v247
    v_lshl_add_u32 v247, v247, 4, v112
    v_lshl_add_u32 v247, v244, 8, v247
    v_lshl_add_u32 v100, v243, 12, v247
    v_xor_b32 v247, 2, v111
    v_lshl_add_u32 v247, v246, 2, v247
    v_lshl_add_u32 v247, v247, 4, v112
    v_lshl_add_u32 v247, v244, 8, v247
    v_lshl_add_u32 v101, v243, 12, v247
    v_add_u32 v101, 1024, v101
    s_add_u32 s3, s28, 3
    s_and_b32 s3, s3, 3
    s_lshl_b32 s50, s3, 6
    s_xor_b32 s51, s50, 32
    v_xor_b32 v246, s3, v244
    v_xor_b32 v247, 0, v111
    v_lshl_add_u32 v247, v246, 2, v247
    v_lshl_add_u32 v247, v247, 4, v112
    v_lshl_add_u32 v247, v244, 8, v247
    v_lshl_add_u32 v102, v243, 12, v247
    v_xor_b32 v247, 2, v111
    v_lshl_add_u32 v247, v246, 2, v247
    v_lshl_add_u32 v247, v247, 4, v112
    v_lshl_add_u32 v247, v244, 8, v247
    v_lshl_add_u32 v103, v243, 12, v247
    v_add_u32 v103, 1024, v103
    v_lshlrev_b32 v247, 1, v243
    v_xor_b32 v247, v247, v111
    v_lshl_add_u32 v247, v244, 2, v247
    v_lshl_add_u32 v247, v247, 4, v112
    v_lshl_add_u32 v247, v244, 8, v247
    v_lshl_add_u32 v247, v243, 10, v247
    v_add_u32 v249, 16384, v247
    v_lshrrev_b32 v246, 1, v245
    v_lshl_or_b32 v246, v244, 2, v246
    v_lshlrev_b32 v247, 1, v110
    v_xor_b32 v246, v246, v247
    v_and_b32 v247, 1, v245
    v_lshlrev_b32 v247, 3, v247
    v_lshl_add_u32 v246, v246, 4, v247
    v_lshl_add_u32 v246, v244, 8, v246
    v_lshl_add_u32 v246, v240, 10, v246
    s_add_u32 s43, s36, 16384
    v_add_u32 v251, s43, v246
    s_lshl_b32 s3, s28, 2
    v_add_u32 v246, s3, v243
    v_xor_b32 v246, v246, v241
    v_lshlrev_b32 v246, 4, v246
    v_lshl_add_u32 v255, v241, 8, v246
    v_xor_b32 v246, v243, v241
    v_lshlrev_b32 v246, 4, v246
    v_lshl_add_u32 v246, v242, 8, v246
    v_add_u32 v248, 16384, v246
    s_waitcnt vmcnt(29)
    s_barrier
    ds_read_b64_tr_b16 v[64:65], v96 offset:49152
    ds_read_b64_tr_b16 v[66:67], v97 offset:49152
    ds_read_b64_tr_b16 v[68:69], v98 offset:49152
    ds_read_b64_tr_b16 v[70:71], v99 offset:49152
    ds_read_b64_tr_b16 v[72:73], v100 offset:49152
    ds_read_b64_tr_b16 v[74:75], v101 offset:49152
    ds_read_b64_tr_b16 v[76:77], v102 offset:49152
    ds_read_b64_tr_b16 v[78:79], v103 offset:49152
    ds_read_b64_tr_b16 v[80:81], v96 offset:51200
    ds_read_b64_tr_b16 v[82:83], v97 offset:51200
    ds_read_b64_tr_b16 v[84:85], v98 offset:51200
    ds_read_b64_tr_b16 v[86:87], v99 offset:51200
    ds_read_b64_tr_b16 v[88:89], v100 offset:51200
    ds_read_b64_tr_b16 v[90:91], v101 offset:51200
    ds_read_b64_tr_b16 v[92:93], v102 offset:51200
    ds_read_b64_tr_b16 v[94:95], v103 offset:51200
    s_waitcnt lgkmcnt(14)
    v_mfma_f32_32x32x16_bf16 v[160:175], v[64:67], v[0:3], 0
    v_mfma_f32_32x32x16_bf16 v[224:239], v[64:67], v[8:11], 0
    s_waitcnt lgkmcnt(12)
    v_mfma_f32_32x32x16_bf16 v[176:191], v[68:71], v[0:3], 0
    s_waitcnt vmcnt(24)
    s_barrier
    s_add_u32 s40, s34, 1572864
    s_add_u32 m0, s39, 32768
    s_nop 0
    buffer_load_dwordx4 v104, s[20:23], s40 offen offset:0 lds
    s_add_u32 s40, s34, 1605632
    s_add_u32 m0, s39, 33792
    s_nop 0
    buffer_load_dwordx4 v105, s[20:23], s40 offen offset:0 lds
    s_add_u32 s41, s32, 12288
    s_add_u32 s42, s33, 6144
    buffer_load_dwordx4 v[128:131], v106, s[24:27], s41 offen offset:0
    buffer_load_dwordx4 v[132:135], v106, s[24:27], s41 offen offset:1024
    buffer_load_dwordx4 v[136:139], v106, s[24:27], s42 offen offset:0
    s_waitcnt lgkmcnt(10)
    v_mfma_f32_32x32x16_bf16 v[192:207], v[72:75], v[0:3], 0
    s_waitcnt lgkmcnt(8)
    v_mfma_f32_32x32x16_bf16 v[208:223], v[76:79], v[0:3], 0
    ds_read_b64_tr_b16 v[64:65], v96 offset:57344
    ds_read_b64_tr_b16 v[66:67], v97 offset:57344
    ds_read_b64_tr_b16 v[68:69], v98 offset:57344
    ds_read_b64_tr_b16 v[70:71], v99 offset:57344
    ds_read_b64_tr_b16 v[72:73], v100 offset:57344
    ds_read_b64_tr_b16 v[74:75], v101 offset:57344
    ds_read_b64_tr_b16 v[76:77], v102 offset:57344
    ds_read_b64_tr_b16 v[78:79], v103 offset:57344
    s_waitcnt lgkmcnt(14)
    v_mfma_f32_32x32x16_bf16 v[160:175], v[80:83], v[4:7], v[160:175]
    v_mfma_f32_32x32x16_bf16 v[144:159], v[80:83], v[8:11], 0
    s_waitcnt lgkmcnt(12)
    v_mfma_f32_32x32x16_bf16 v[176:191], v[84:87], v[4:7], v[176:191]
    s_waitcnt lgkmcnt(10)
    v_mfma_f32_32x32x16_bf16 v[192:207], v[88:91], v[4:7], v[192:207]
    s_waitcnt lgkmcnt(8)
    v_mfma_f32_32x32x16_bf16 v[208:223], v[92:95], v[4:7], v[208:223]
    ds_read_b64_tr_b16 v[80:81], v96 offset:59392
    ds_read_b64_tr_b16 v[82:83], v97 offset:59392
    ds_read_b64_tr_b16 v[84:85], v98 offset:59392
    ds_read_b64_tr_b16 v[86:87], v99 offset:59392
    ds_read_b64_tr_b16 v[88:89], v100 offset:59392
    ds_read_b64_tr_b16 v[90:91], v101 offset:59392
    ds_read_b64_tr_b16 v[92:93], v102 offset:59392
    ds_read_b64_tr_b16 v[94:95], v103 offset:59392
    s_waitcnt lgkmcnt(14)
    v_mfma_f32_32x32x16_bf16 v[160:175], v[64:67], v[12:15], v[160:175]
    v_mfma_f32_32x32x16_bf16 v[224:239], v[64:67], v[20:23], v[224:239]
    s_waitcnt lgkmcnt(12)
    v_mfma_f32_32x32x16_bf16 v[176:191], v[68:71], v[12:15], v[176:191]
    s_waitcnt vmcnt(24)
    s_barrier
    s_add_u32 s40, s34, 1835008
    s_add_u32 m0, s39, 40960
    s_nop 0
    buffer_load_dwordx4 v104, s[20:23], s40 offen offset:0 lds
    s_add_u32 s40, s34, 1867776
    s_add_u32 m0, s39, 41984
    s_nop 0
    buffer_load_dwordx4 v105, s[20:23], s40 offen offset:0 lds
    s_add_u32 s41, s32, 14336
    s_add_u32 s42, s33, 7168
    buffer_load_dwordx4 v[0:3], v106, s[24:27], s41 offen offset:0
    buffer_load_dwordx4 v[4:7], v106, s[24:27], s41 offen offset:1024
    buffer_load_dwordx4 v[8:11], v106, s[24:27], s42 offen offset:0
    s_waitcnt lgkmcnt(10)
    v_mfma_f32_32x32x16_bf16 v[192:207], v[72:75], v[12:15], v[192:207]
    s_waitcnt lgkmcnt(8)
    v_mfma_f32_32x32x16_bf16 v[208:223], v[76:79], v[12:15], v[208:223]
    ds_read_b64_tr_b16 v[64:65], v96 offset:0
    ds_read_b64_tr_b16 v[66:67], v97 offset:0
    ds_read_b64_tr_b16 v[68:69], v98 offset:0
    ds_read_b64_tr_b16 v[70:71], v99 offset:0
    ds_read_b64_tr_b16 v[72:73], v100 offset:0
    ds_read_b64_tr_b16 v[74:75], v101 offset:0
    ds_read_b64_tr_b16 v[76:77], v102 offset:0
    ds_read_b64_tr_b16 v[78:79], v103 offset:0
    s_waitcnt lgkmcnt(14)
    v_mfma_f32_32x32x16_bf16 v[160:175], v[80:83], v[16:19], v[160:175]
    v_mfma_f32_32x32x16_bf16 v[144:159], v[80:83], v[20:23], v[144:159]
    s_waitcnt lgkmcnt(12)
    v_mfma_f32_32x32x16_bf16 v[176:191], v[84:87], v[16:19], v[176:191]
    s_waitcnt lgkmcnt(10)
    v_mfma_f32_32x32x16_bf16 v[192:207], v[88:91], v[16:19], v[192:207]
    s_waitcnt lgkmcnt(8)
    v_mfma_f32_32x32x16_bf16 v[208:223], v[92:95], v[16:19], v[208:223]
    ds_read_b64_tr_b16 v[80:81], v96 offset:2048
    ds_read_b64_tr_b16 v[82:83], v97 offset:2048
    ds_read_b64_tr_b16 v[84:85], v98 offset:2048
    ds_read_b64_tr_b16 v[86:87], v99 offset:2048
    ds_read_b64_tr_b16 v[88:89], v100 offset:2048
    ds_read_b64_tr_b16 v[90:91], v101 offset:2048
    ds_read_b64_tr_b16 v[92:93], v102 offset:2048
    ds_read_b64_tr_b16 v[94:95], v103 offset:2048
    s_waitcnt lgkmcnt(14)
    v_mfma_f32_32x32x16_bf16 v[160:175], v[64:67], v[24:27], v[160:175]
    v_mfma_f32_32x32x16_bf16 v[224:239], v[64:67], v[32:35], v[224:239]
    s_waitcnt lgkmcnt(12)
    v_mfma_f32_32x32x16_bf16 v[176:191], v[68:71], v[24:27], v[176:191]
    s_waitcnt vmcnt(24)
    s_barrier
    s_add_u32 s40, s34, 2097152
    s_add_u32 m0, s39, 49152
    s_nop 0
    buffer_load_dwordx4 v104, s[20:23], s40 offen offset:0 lds
    s_add_u32 s40, s34, 2129920
    s_add_u32 m0, s39, 50176
    s_nop 0
    buffer_load_dwordx4 v105, s[20:23], s40 offen offset:0 lds
    s_add_u32 s41, s32, 16384
    s_add_u32 s42, s33, 8192
    buffer_load_dwordx4 v[12:15], v106, s[24:27], s41 offen offset:0
    buffer_load_dwordx4 v[16:19], v106, s[24:27], s41 offen offset:1024
    buffer_load_dwordx4 v[20:23], v106, s[24:27], s42 offen offset:0
    s_waitcnt lgkmcnt(10)
    v_mfma_f32_32x32x16_bf16 v[192:207], v[72:75], v[24:27], v[192:207]
    s_waitcnt lgkmcnt(8)
    v_mfma_f32_32x32x16_bf16 v[208:223], v[76:79], v[24:27], v[208:223]
    ds_read_b64_tr_b16 v[64:65], v96 offset:8192
    ds_read_b64_tr_b16 v[66:67], v97 offset:8192
    ds_read_b64_tr_b16 v[68:69], v98 offset:8192
    ds_read_b64_tr_b16 v[70:71], v99 offset:8192
    ds_read_b64_tr_b16 v[72:73], v100 offset:8192
    ds_read_b64_tr_b16 v[74:75], v101 offset:8192
    ds_read_b64_tr_b16 v[76:77], v102 offset:8192
    ds_read_b64_tr_b16 v[78:79], v103 offset:8192
    s_waitcnt lgkmcnt(14)
    v_mfma_f32_32x32x16_bf16 v[160:175], v[80:83], v[28:31], v[160:175]
    v_mfma_f32_32x32x16_bf16 v[144:159], v[80:83], v[32:35], v[144:159]
    s_waitcnt lgkmcnt(12)
    v_mfma_f32_32x32x16_bf16 v[176:191], v[84:87], v[28:31], v[176:191]
    s_waitcnt lgkmcnt(10)
    v_mfma_f32_32x32x16_bf16 v[192:207], v[88:91], v[28:31], v[192:207]
    s_waitcnt lgkmcnt(8)
    v_mfma_f32_32x32x16_bf16 v[208:223], v[92:95], v[28:31], v[208:223]
    ds_read_b64_tr_b16 v[80:81], v96 offset:10240
    ds_read_b64_tr_b16 v[82:83], v97 offset:10240
    ds_read_b64_tr_b16 v[84:85], v98 offset:10240
    ds_read_b64_tr_b16 v[86:87], v99 offset:10240
    ds_read_b64_tr_b16 v[88:89], v100 offset:10240
    ds_read_b64_tr_b16 v[90:91], v101 offset:10240
    ds_read_b64_tr_b16 v[92:93], v102 offset:10240
    ds_read_b64_tr_b16 v[94:95], v103 offset:10240
    s_waitcnt lgkmcnt(14)
    v_mfma_f32_32x32x16_bf16 v[160:175], v[64:67], v[36:39], v[160:175]
    v_mfma_f32_32x32x16_bf16 v[224:239], v[64:67], v[44:47], v[224:239]
    s_waitcnt lgkmcnt(12)
    v_mfma_f32_32x32x16_bf16 v[176:191], v[68:71], v[36:39], v[176:191]
    s_waitcnt vmcnt(24)
    s_barrier
    s_add_u32 s40, s34, 2359296
    s_add_u32 m0, s39, 57344
    s_nop 0
    buffer_load_dwordx4 v104, s[20:23], s40 offen offset:0 lds
    s_add_u32 s40, s34, 2392064
    s_add_u32 m0, s39, 58368
    s_nop 0
    buffer_load_dwordx4 v105, s[20:23], s40 offen offset:0 lds
    s_add_u32 s41, s32, 18432
    s_add_u32 s42, s33, 9216
    buffer_load_dwordx4 v[24:27], v106, s[24:27], s41 offen offset:0
    buffer_load_dwordx4 v[28:31], v106, s[24:27], s41 offen offset:1024
    buffer_load_dwordx4 v[32:35], v106, s[24:27], s42 offen offset:0
    s_waitcnt lgkmcnt(10)
    v_mfma_f32_32x32x16_bf16 v[192:207], v[72:75], v[36:39], v[192:207]
    s_waitcnt lgkmcnt(8)
    v_mfma_f32_32x32x16_bf16 v[208:223], v[76:79], v[36:39], v[208:223]
    ds_read_b64_tr_b16 v[64:65], v96 offset:16384
    ds_read_b64_tr_b16 v[66:67], v97 offset:16384
    ds_read_b64_tr_b16 v[68:69], v98 offset:16384
    ds_read_b64_tr_b16 v[70:71], v99 offset:16384
    ds_read_b64_tr_b16 v[72:73], v100 offset:16384
    ds_read_b64_tr_b16 v[74:75], v101 offset:16384
    ds_read_b64_tr_b16 v[76:77], v102 offset:16384
    ds_read_b64_tr_b16 v[78:79], v103 offset:16384
    s_waitcnt lgkmcnt(14)
    v_mfma_f32_32x32x16_bf16 v[160:175], v[80:83], v[40:43], v[160:175]
    v_mfma_f32_32x32x16_bf16 v[144:159], v[80:83], v[44:47], v[144:159]
    s_waitcnt lgkmcnt(12)
    v_mfma_f32_32x32x16_bf16 v[176:191], v[84:87], v[40:43], v[176:191]
    s_waitcnt lgkmcnt(10)
    v_mfma_f32_32x32x16_bf16 v[192:207], v[88:91], v[40:43], v[192:207]
    s_waitcnt lgkmcnt(8)
    v_mfma_f32_32x32x16_bf16 v[208:223], v[92:95], v[40:43], v[208:223]
    ds_read_b64_tr_b16 v[80:81], v96 offset:18432
    ds_read_b64_tr_b16 v[82:83], v97 offset:18432
    ds_read_b64_tr_b16 v[84:85], v98 offset:18432
    ds_read_b64_tr_b16 v[86:87], v99 offset:18432
    ds_read_b64_tr_b16 v[88:89], v100 offset:18432
    ds_read_b64_tr_b16 v[90:91], v101 offset:18432
    ds_read_b64_tr_b16 v[92:93], v102 offset:18432
    ds_read_b64_tr_b16 v[94:95], v103 offset:18432
    s_waitcnt lgkmcnt(14)
    v_mfma_f32_32x32x16_bf16 v[160:175], v[64:67], v[48:51], v[160:175]
    v_mfma_f32_32x32x16_bf16 v[224:239], v[64:67], v[56:59], v[224:239]
    s_waitcnt lgkmcnt(12)
    v_mfma_f32_32x32x16_bf16 v[176:191], v[68:71], v[48:51], v[176:191]
    s_waitcnt vmcnt(24)
    s_barrier
    s_add_u32 s40, s34, 2621440
    s_add_u32 m0, s39, 0
    s_nop 0
    buffer_load_dwordx4 v104, s[20:23], s40 offen offset:0 lds
    s_add_u32 s40, s34, 2654208
    s_add_u32 m0, s39, 1024
    s_nop 0
    buffer_load_dwordx4 v105, s[20:23], s40 offen offset:0 lds
    s_add_u32 s41, s32, 20480
    s_add_u32 s42, s33, 10240
    buffer_load_dwordx4 v[36:39], v106, s[24:27], s41 offen offset:0
    buffer_load_dwordx4 v[40:43], v106, s[24:27], s41 offen offset:1024
    buffer_load_dwordx4 v[44:47], v106, s[24:27], s42 offen offset:0
    s_waitcnt lgkmcnt(10)
    v_mfma_f32_32x32x16_bf16 v[192:207], v[72:75], v[48:51], v[192:207]
    s_waitcnt lgkmcnt(8)
    v_mfma_f32_32x32x16_bf16 v[208:223], v[76:79], v[48:51], v[208:223]
    ds_read_b64_tr_b16 v[64:65], v96 offset:24576
    ds_read_b64_tr_b16 v[66:67], v97 offset:24576
    ds_read_b64_tr_b16 v[68:69], v98 offset:24576
    ds_read_b64_tr_b16 v[70:71], v99 offset:24576
    ds_read_b64_tr_b16 v[72:73], v100 offset:24576
    ds_read_b64_tr_b16 v[74:75], v101 offset:24576
    ds_read_b64_tr_b16 v[76:77], v102 offset:24576
    ds_read_b64_tr_b16 v[78:79], v103 offset:24576
    s_waitcnt lgkmcnt(14)
    v_mfma_f32_32x32x16_bf16 v[160:175], v[80:83], v[52:55], v[160:175]
    v_mfma_f32_32x32x16_bf16 v[144:159], v[80:83], v[56:59], v[144:159]
    s_waitcnt lgkmcnt(12)
    v_mfma_f32_32x32x16_bf16 v[176:191], v[84:87], v[52:55], v[176:191]
    s_waitcnt lgkmcnt(10)
    v_mfma_f32_32x32x16_bf16 v[192:207], v[88:91], v[52:55], v[192:207]
    s_waitcnt lgkmcnt(8)
    v_mfma_f32_32x32x16_bf16 v[208:223], v[92:95], v[52:55], v[208:223]
    ds_read_b64_tr_b16 v[80:81], v96 offset:26624
    ds_read_b64_tr_b16 v[82:83], v97 offset:26624
    ds_read_b64_tr_b16 v[84:85], v98 offset:26624
    ds_read_b64_tr_b16 v[86:87], v99 offset:26624
    ds_read_b64_tr_b16 v[88:89], v100 offset:26624
    ds_read_b64_tr_b16 v[90:91], v101 offset:26624
    ds_read_b64_tr_b16 v[92:93], v102 offset:26624
    ds_read_b64_tr_b16 v[94:95], v103 offset:26624
    s_waitcnt lgkmcnt(14)
    v_mfma_f32_32x32x16_bf16 v[160:175], v[64:67], v[116:119], v[160:175]
    v_mfma_f32_32x32x16_bf16 v[224:239], v[64:67], v[124:127], v[224:239]
    s_waitcnt lgkmcnt(12)
    v_mfma_f32_32x32x16_bf16 v[176:191], v[68:71], v[116:119], v[176:191]
    s_waitcnt vmcnt(20)
    s_barrier
    s_add_u32 s40, s34, 2883584
    s_add_u32 m0, s39, 8192
    s_nop 0
    buffer_load_dwordx4 v104, s[20:23], s40 offen offset:0 lds
    s_add_u32 s40, s34, 2916352
    s_add_u32 m0, s39, 9216
    s_nop 0
    buffer_load_dwordx4 v105, s[20:23], s40 offen offset:0 lds
    s_add_u32 s41, s32, 22528
    s_add_u32 s42, s33, 11264
    buffer_load_dwordx4 v[48:51], v106, s[24:27], s41 offen offset:0
    buffer_load_dwordx4 v[52:55], v106, s[24:27], s41 offen offset:1024
    buffer_load_dwordx4 v[56:59], v106, s[24:27], s42 offen offset:0
    s_waitcnt lgkmcnt(10)
    v_mfma_f32_32x32x16_bf16 v[192:207], v[72:75], v[116:119], v[192:207]
    s_waitcnt lgkmcnt(8)
    v_mfma_f32_32x32x16_bf16 v[208:223], v[76:79], v[116:119], v[208:223]
    ds_read_b64_tr_b16 v[64:65], v96 offset:32768
    ds_read_b64_tr_b16 v[66:67], v97 offset:32768
    ds_read_b64_tr_b16 v[68:69], v98 offset:32768
    ds_read_b64_tr_b16 v[70:71], v99 offset:32768
    ds_read_b64_tr_b16 v[72:73], v100 offset:32768
    ds_read_b64_tr_b16 v[74:75], v101 offset:32768
    ds_read_b64_tr_b16 v[76:77], v102 offset:32768
    ds_read_b64_tr_b16 v[78:79], v103 offset:32768
    s_waitcnt lgkmcnt(14)
    v_mfma_f32_32x32x16_bf16 v[160:175], v[80:83], v[120:123], v[160:175]
    v_mfma_f32_32x32x16_bf16 v[144:159], v[80:83], v[124:127], v[144:159]
    s_waitcnt lgkmcnt(12)
    v_mfma_f32_32x32x16_bf16 v[176:191], v[84:87], v[120:123], v[176:191]
    s_waitcnt lgkmcnt(10)
    v_mfma_f32_32x32x16_bf16 v[192:207], v[88:91], v[120:123], v[192:207]
    s_waitcnt lgkmcnt(8)
    v_mfma_f32_32x32x16_bf16 v[208:223], v[92:95], v[120:123], v[208:223]
    ds_read_b64_tr_b16 v[80:81], v96 offset:34816
    ds_read_b64_tr_b16 v[82:83], v97 offset:34816
    ds_read_b64_tr_b16 v[84:85], v98 offset:34816
    ds_read_b64_tr_b16 v[86:87], v99 offset:34816
    ds_read_b64_tr_b16 v[88:89], v100 offset:34816
    ds_read_b64_tr_b16 v[90:91], v101 offset:34816
    ds_read_b64_tr_b16 v[92:93], v102 offset:34816
    ds_read_b64_tr_b16 v[94:95], v103 offset:34816
    s_waitcnt lgkmcnt(14)
    v_mfma_f32_32x32x16_bf16 v[160:175], v[64:67], v[128:131], v[160:175]
    v_mfma_f32_32x32x16_bf16 v[224:239], v[64:67], v[136:139], v[224:239]
    s_waitcnt lgkmcnt(12)
    v_mfma_f32_32x32x16_bf16 v[176:191], v[68:71], v[128:131], v[176:191]
    s_waitcnt vmcnt(20)
    s_barrier
    s_add_u32 s40, s34, 3145728
    s_add_u32 m0, s39, 16384
    s_nop 0
    buffer_load_dwordx4 v104, s[20:23], s40 offen offset:0 lds
    s_add_u32 s40, s34, 3178496
    s_add_u32 m0, s39, 17408
    s_nop 0
    buffer_load_dwordx4 v105, s[20:23], s40 offen offset:0 lds
    s_add_u32 s41, s32, 24576
    s_add_u32 s42, s33, 12288
    buffer_load_dwordx4 v[116:119], v106, s[24:27], s41 offen offset:0
    buffer_load_dwordx4 v[120:123], v106, s[24:27], s41 offen offset:1024
    buffer_load_dwordx4 v[124:127], v106, s[24:27], s42 offen offset:0
    s_waitcnt lgkmcnt(10)
    v_mfma_f32_32x32x16_bf16 v[192:207], v[72:75], v[128:131], v[192:207]
    s_waitcnt lgkmcnt(8)
    v_mfma_f32_32x32x16_bf16 v[208:223], v[76:79], v[128:131], v[208:223]
    ds_read_b64_tr_b16 v[64:65], v96 offset:40960
    ds_read_b64_tr_b16 v[66:67], v97 offset:40960
    ds_read_b64_tr_b16 v[68:69], v98 offset:40960
    ds_read_b64_tr_b16 v[70:71], v99 offset:40960
    ds_read_b64_tr_b16 v[72:73], v100 offset:40960
    ds_read_b64_tr_b16 v[74:75], v101 offset:40960
    ds_read_b64_tr_b16 v[76:77], v102 offset:40960
    ds_read_b64_tr_b16 v[78:79], v103 offset:40960
    s_waitcnt lgkmcnt(14)
    v_mfma_f32_32x32x16_bf16 v[160:175], v[80:83], v[132:135], v[160:175]
    v_mfma_f32_32x32x16_bf16 v[144:159], v[80:83], v[136:139], v[144:159]
    s_waitcnt lgkmcnt(12)
    v_mfma_f32_32x32x16_bf16 v[176:191], v[84:87], v[132:135], v[176:191]
    s_waitcnt lgkmcnt(10)
    v_mfma_f32_32x32x16_bf16 v[192:207], v[88:91], v[132:135], v[192:207]
    s_waitcnt lgkmcnt(8)
    v_mfma_f32_32x32x16_bf16 v[208:223], v[92:95], v[132:135], v[208:223]
    ds_read_b64_tr_b16 v[80:81], v96 offset:43008
    ds_read_b64_tr_b16 v[82:83], v97 offset:43008
    ds_read_b64_tr_b16 v[84:85], v98 offset:43008
    ds_read_b64_tr_b16 v[86:87], v99 offset:43008
    ds_read_b64_tr_b16 v[88:89], v100 offset:43008
    ds_read_b64_tr_b16 v[90:91], v101 offset:43008
    ds_read_b64_tr_b16 v[92:93], v102 offset:43008
    ds_read_b64_tr_b16 v[94:95], v103 offset:43008
    s_waitcnt lgkmcnt(14)
    v_mfma_f32_32x32x16_bf16 v[160:175], v[64:67], v[0:3], v[160:175]
    v_mfma_f32_32x32x16_bf16 v[224:239], v[64:67], v[8:11], v[224:239]
    s_waitcnt lgkmcnt(12)
    v_mfma_f32_32x32x16_bf16 v[176:191], v[68:71], v[0:3], v[176:191]
    s_waitcnt vmcnt(20)
    s_barrier
    s_add_u32 s40, s34, 3407872
    s_add_u32 m0, s39, 24576
    s_nop 0
    buffer_load_dwordx4 v104, s[20:23], s40 offen offset:0 lds
    s_add_u32 s40, s34, 3440640
    s_add_u32 m0, s39, 25600
    s_nop 0
    buffer_load_dwordx4 v105, s[20:23], s40 offen offset:0 lds
    s_add_u32 s41, s32, 26624
    s_add_u32 s42, s33, 13312
    buffer_load_dwordx4 v[128:131], v106, s[24:27], s41 offen offset:0
    buffer_load_dwordx4 v[132:135], v106, s[24:27], s41 offen offset:1024
    buffer_load_dwordx4 v[136:139], v106, s[24:27], s42 offen offset:0
    s_waitcnt lgkmcnt(10)
    v_mfma_f32_32x32x16_bf16 v[192:207], v[72:75], v[0:3], v[192:207]
    s_waitcnt lgkmcnt(8)
    v_mfma_f32_32x32x16_bf16 v[208:223], v[76:79], v[0:3], v[208:223]
    ds_read_b64_tr_b16 v[64:65], v96 offset:49152
    ds_read_b64_tr_b16 v[66:67], v97 offset:49152
    ds_read_b64_tr_b16 v[68:69], v98 offset:49152
    ds_read_b64_tr_b16 v[70:71], v99 offset:49152
    ds_read_b64_tr_b16 v[72:73], v100 offset:49152
    ds_read_b64_tr_b16 v[74:75], v101 offset:49152
    ds_read_b64_tr_b16 v[76:77], v102 offset:49152
    ds_read_b64_tr_b16 v[78:79], v103 offset:49152
    s_waitcnt lgkmcnt(14)
    v_mfma_f32_32x32x16_bf16 v[160:175], v[80:83], v[4:7], v[160:175]
    v_mfma_f32_32x32x16_bf16 v[144:159], v[80:83], v[8:11], v[144:159]
    s_waitcnt lgkmcnt(12)
    v_mfma_f32_32x32x16_bf16 v[176:191], v[84:87], v[4:7], v[176:191]
    s_waitcnt lgkmcnt(10)
    v_mfma_f32_32x32x16_bf16 v[192:207], v[88:91], v[4:7], v[192:207]
    s_waitcnt lgkmcnt(8)
    v_mfma_f32_32x32x16_bf16 v[208:223], v[92:95], v[4:7], v[208:223]
    ds_read_b64_tr_b16 v[80:81], v96 offset:51200
    ds_read_b64_tr_b16 v[82:83], v97 offset:51200
    ds_read_b64_tr_b16 v[84:85], v98 offset:51200
    ds_read_b64_tr_b16 v[86:87], v99 offset:51200
    ds_read_b64_tr_b16 v[88:89], v100 offset:51200
    ds_read_b64_tr_b16 v[90:91], v101 offset:51200
    ds_read_b64_tr_b16 v[92:93], v102 offset:51200
    ds_read_b64_tr_b16 v[94:95], v103 offset:51200
    s_waitcnt lgkmcnt(14)
    v_mfma_f32_32x32x16_bf16 v[160:175], v[64:67], v[12:15], v[160:175]
    v_mfma_f32_32x32x16_bf16 v[224:239], v[64:67], v[20:23], v[224:239]
    s_waitcnt lgkmcnt(12)
    v_mfma_f32_32x32x16_bf16 v[176:191], v[68:71], v[12:15], v[176:191]
    s_waitcnt vmcnt(20)
    s_barrier
    s_add_u32 s40, s34, 3670016
    s_add_u32 m0, s39, 32768
    s_nop 0
    buffer_load_dwordx4 v104, s[20:23], s40 offen offset:0 lds
    s_add_u32 s40, s34, 3702784
    s_add_u32 m0, s39, 33792
    s_nop 0
    buffer_load_dwordx4 v105, s[20:23], s40 offen offset:0 lds
    s_add_u32 s41, s32, 28672
    s_add_u32 s42, s33, 14336
    buffer_load_dwordx4 v[0:3], v106, s[24:27], s41 offen offset:0
    buffer_load_dwordx4 v[4:7], v106, s[24:27], s41 offen offset:1024
    buffer_load_dwordx4 v[8:11], v106, s[24:27], s42 offen offset:0
    s_waitcnt lgkmcnt(10)
    v_mfma_f32_32x32x16_bf16 v[192:207], v[72:75], v[12:15], v[192:207]
    s_waitcnt lgkmcnt(8)
    v_mfma_f32_32x32x16_bf16 v[208:223], v[76:79], v[12:15], v[208:223]
    ds_read_b64_tr_b16 v[64:65], v96 offset:57344
    ds_read_b64_tr_b16 v[66:67], v97 offset:57344
    ds_read_b64_tr_b16 v[68:69], v98 offset:57344
    ds_read_b64_tr_b16 v[70:71], v99 offset:57344
    ds_read_b64_tr_b16 v[72:73], v100 offset:57344
    ds_read_b64_tr_b16 v[74:75], v101 offset:57344
    ds_read_b64_tr_b16 v[76:77], v102 offset:57344
    ds_read_b64_tr_b16 v[78:79], v103 offset:57344
    s_waitcnt lgkmcnt(14)
    v_mfma_f32_32x32x16_bf16 v[160:175], v[80:83], v[16:19], v[160:175]
    v_mfma_f32_32x32x16_bf16 v[144:159], v[80:83], v[20:23], v[144:159]
    s_waitcnt lgkmcnt(12)
    v_mfma_f32_32x32x16_bf16 v[176:191], v[84:87], v[16:19], v[176:191]
    s_waitcnt lgkmcnt(10)
    v_mfma_f32_32x32x16_bf16 v[192:207], v[88:91], v[16:19], v[192:207]
    s_waitcnt lgkmcnt(8)
    v_mfma_f32_32x32x16_bf16 v[208:223], v[92:95], v[16:19], v[208:223]
    ds_read_b64_tr_b16 v[80:81], v96 offset:59392
    ds_read_b64_tr_b16 v[82:83], v97 offset:59392
    ds_read_b64_tr_b16 v[84:85], v98 offset:59392
    ds_read_b64_tr_b16 v[86:87], v99 offset:59392
    ds_read_b64_tr_b16 v[88:89], v100 offset:59392
    ds_read_b64_tr_b16 v[90:91], v101 offset:59392
    ds_read_b64_tr_b16 v[92:93], v102 offset:59392
    ds_read_b64_tr_b16 v[94:95], v103 offset:59392
    s_waitcnt lgkmcnt(14)
    v_mfma_f32_32x32x16_bf16 v[160:175], v[64:67], v[24:27], v[160:175]
    v_mfma_f32_32x32x16_bf16 v[224:239], v[64:67], v[32:35], v[224:239]
    s_waitcnt lgkmcnt(12)
    v_mfma_f32_32x32x16_bf16 v[176:191], v[68:71], v[24:27], v[176:191]
    s_waitcnt vmcnt(20)
    s_barrier
    s_add_u32 s40, s34, 3932160
    s_add_u32 m0, s39, 40960
    s_nop 0
    buffer_load_dwordx4 v104, s[20:23], s40 offen offset:0 lds
    s_add_u32 s40, s34, 3964928
    s_add_u32 m0, s39, 41984
    s_nop 0
    buffer_load_dwordx4 v105, s[20:23], s40 offen offset:0 lds
    s_add_u32 s41, s32, 30720
    s_add_u32 s42, s33, 15360
    buffer_load_dwordx4 v[12:15], v106, s[24:27], s41 offen offset:0
    buffer_load_dwordx4 v[16:19], v106, s[24:27], s41 offen offset:1024
    buffer_load_dwordx4 v[20:23], v106, s[24:27], s42 offen offset:0
    s_waitcnt lgkmcnt(10)
    v_mfma_f32_32x32x16_bf16 v[192:207], v[72:75], v[24:27], v[192:207]
    s_waitcnt lgkmcnt(8)
    v_mfma_f32_32x32x16_bf16 v[208:223], v[76:79], v[24:27], v[208:223]
    ds_read_b64_tr_b16 v[64:65], v96 offset:0
    ds_read_b64_tr_b16 v[66:67], v97 offset:0
    ds_read_b64_tr_b16 v[68:69], v98 offset:0
    ds_read_b64_tr_b16 v[70:71], v99 offset:0
    ds_read_b64_tr_b16 v[72:73], v100 offset:0
    ds_read_b64_tr_b16 v[74:75], v101 offset:0
    ds_read_b64_tr_b16 v[76:77], v102 offset:0
    ds_read_b64_tr_b16 v[78:79], v103 offset:0
    s_waitcnt lgkmcnt(14)
    v_mfma_f32_32x32x16_bf16 v[160:175], v[80:83], v[28:31], v[160:175]
    v_mfma_f32_32x32x16_bf16 v[144:159], v[80:83], v[32:35], v[144:159]
    s_waitcnt lgkmcnt(12)
    v_mfma_f32_32x32x16_bf16 v[176:191], v[84:87], v[28:31], v[176:191]
    s_waitcnt lgkmcnt(10)
    v_mfma_f32_32x32x16_bf16 v[192:207], v[88:91], v[28:31], v[192:207]
    s_waitcnt lgkmcnt(8)
    v_mfma_f32_32x32x16_bf16 v[208:223], v[92:95], v[28:31], v[208:223]
    ds_read_b64_tr_b16 v[80:81], v96 offset:2048
    ds_read_b64_tr_b16 v[82:83], v97 offset:2048
    ds_read_b64_tr_b16 v[84:85], v98 offset:2048
    ds_read_b64_tr_b16 v[86:87], v99 offset:2048
    ds_read_b64_tr_b16 v[88:89], v100 offset:2048
    ds_read_b64_tr_b16 v[90:91], v101 offset:2048
    ds_read_b64_tr_b16 v[92:93], v102 offset:2048
    ds_read_b64_tr_b16 v[94:95], v103 offset:2048
    s_waitcnt lgkmcnt(14)
    v_mfma_f32_32x32x16_bf16 v[160:175], v[64:67], v[36:39], v[160:175]
    v_mfma_f32_32x32x16_bf16 v[224:239], v[64:67], v[44:47], v[224:239]
    s_waitcnt lgkmcnt(12)
    v_mfma_f32_32x32x16_bf16 v[176:191], v[68:71], v[36:39], v[176:191]
    s_waitcnt vmcnt(20)
    s_barrier
    s_add_u32 s40, s34, 4194304
    s_add_u32 m0, s39, 49152
    s_nop 0
    buffer_load_dwordx4 v104, s[20:23], s40 offen offset:0 lds
    s_add_u32 s40, s34, 4227072
    s_add_u32 m0, s39, 50176
    s_nop 0
    buffer_load_dwordx4 v105, s[20:23], s40 offen offset:0 lds
    s_add_u32 s41, s32, 32768
    s_add_u32 s42, s33, 16384
    buffer_load_dwordx4 v[24:27], v106, s[24:27], s41 offen offset:0
    buffer_load_dwordx4 v[28:31], v106, s[24:27], s41 offen offset:1024
    buffer_load_dwordx4 v[32:35], v106, s[24:27], s42 offen offset:0
    s_waitcnt lgkmcnt(10)
    v_mfma_f32_32x32x16_bf16 v[192:207], v[72:75], v[36:39], v[192:207]
    s_waitcnt lgkmcnt(8)
    v_mfma_f32_32x32x16_bf16 v[208:223], v[76:79], v[36:39], v[208:223]
    ds_read_b64_tr_b16 v[64:65], v96 offset:8192
    ds_read_b64_tr_b16 v[66:67], v97 offset:8192
    ds_read_b64_tr_b16 v[68:69], v98 offset:8192
    ds_read_b64_tr_b16 v[70:71], v99 offset:8192
    ds_read_b64_tr_b16 v[72:73], v100 offset:8192
    ds_read_b64_tr_b16 v[74:75], v101 offset:8192
    ds_read_b64_tr_b16 v[76:77], v102 offset:8192
    ds_read_b64_tr_b16 v[78:79], v103 offset:8192
    s_waitcnt lgkmcnt(14)
    v_mfma_f32_32x32x16_bf16 v[160:175], v[80:83], v[40:43], v[160:175]
    v_mfma_f32_32x32x16_bf16 v[144:159], v[80:83], v[44:47], v[144:159]
    s_waitcnt lgkmcnt(12)
    v_mfma_f32_32x32x16_bf16 v[176:191], v[84:87], v[40:43], v[176:191]
    s_waitcnt lgkmcnt(10)
    v_mfma_f32_32x32x16_bf16 v[192:207], v[88:91], v[40:43], v[192:207]
    s_waitcnt lgkmcnt(8)
    v_mfma_f32_32x32x16_bf16 v[208:223], v[92:95], v[40:43], v[208:223]
    ds_read_b64_tr_b16 v[80:81], v96 offset:10240
    ds_read_b64_tr_b16 v[82:83], v97 offset:10240
    ds_read_b64_tr_b16 v[84:85], v98 offset:10240
    ds_read_b64_tr_b16 v[86:87], v99 offset:10240
    ds_read_b64_tr_b16 v[88:89], v100 offset:10240
    ds_read_b64_tr_b16 v[90:91], v101 offset:10240
    ds_read_b64_tr_b16 v[92:93], v102 offset:10240
    ds_read_b64_tr_b16 v[94:95], v103 offset:10240
    s_waitcnt lgkmcnt(14)
    v_mfma_f32_32x32x16_bf16 v[160:175], v[64:67], v[48:51], v[160:175]
    v_mfma_f32_32x32x16_bf16 v[224:239], v[64:67], v[56:59], v[224:239]
    s_waitcnt lgkmcnt(12)
    v_mfma_f32_32x32x16_bf16 v[176:191], v[68:71], v[48:51], v[176:191]
    s_waitcnt vmcnt(20)
    s_barrier
    s_add_u32 s40, s34, 4456448
    s_add_u32 m0, s39, 57344
    s_nop 0
    buffer_load_dwordx4 v104, s[20:23], s40 offen offset:0 lds
    s_add_u32 s40, s34, 4489216
    s_add_u32 m0, s39, 58368
    s_nop 0
    buffer_load_dwordx4 v105, s[20:23], s40 offen offset:0 lds
    s_add_u32 s41, s32, 34816
    s_add_u32 s42, s33, 17408
    buffer_load_dwordx4 v[36:39], v106, s[24:27], s41 offen offset:0
    buffer_load_dwordx4 v[40:43], v106, s[24:27], s41 offen offset:1024
    buffer_load_dwordx4 v[44:47], v106, s[24:27], s42 offen offset:0
    s_waitcnt lgkmcnt(10)
    v_mfma_f32_32x32x16_bf16 v[192:207], v[72:75], v[48:51], v[192:207]
    s_waitcnt lgkmcnt(8)
    v_mfma_f32_32x32x16_bf16 v[208:223], v[76:79], v[48:51], v[208:223]
    ds_read_b64_tr_b16 v[64:65], v96 offset:16384
    ds_read_b64_tr_b16 v[66:67], v97 offset:16384
    ds_read_b64_tr_b16 v[68:69], v98 offset:16384
    ds_read_b64_tr_b16 v[70:71], v99 offset:16384
    ds_read_b64_tr_b16 v[72:73], v100 offset:16384
    ds_read_b64_tr_b16 v[74:75], v101 offset:16384
    ds_read_b64_tr_b16 v[76:77], v102 offset:16384
    ds_read_b64_tr_b16 v[78:79], v103 offset:16384
    s_waitcnt lgkmcnt(14)
    v_mfma_f32_32x32x16_bf16 v[160:175], v[80:83], v[52:55], v[160:175]
    v_mfma_f32_32x32x16_bf16 v[144:159], v[80:83], v[56:59], v[144:159]
    s_waitcnt lgkmcnt(12)
    v_mfma_f32_32x32x16_bf16 v[176:191], v[84:87], v[52:55], v[176:191]
    s_waitcnt lgkmcnt(10)
    v_mfma_f32_32x32x16_bf16 v[192:207], v[88:91], v[52:55], v[192:207]
    s_waitcnt lgkmcnt(8)
    v_mfma_f32_32x32x16_bf16 v[208:223], v[92:95], v[52:55], v[208:223]
    ds_read_b64_tr_b16 v[80:81], v96 offset:18432
    ds_read_b64_tr_b16 v[82:83], v97 offset:18432
    ds_read_b64_tr_b16 v[84:85], v98 offset:18432
    ds_read_b64_tr_b16 v[86:87], v99 offset:18432
    ds_read_b64_tr_b16 v[88:89], v100 offset:18432
    ds_read_b64_tr_b16 v[90:91], v101 offset:18432
    ds_read_b64_tr_b16 v[92:93], v102 offset:18432
    ds_read_b64_tr_b16 v[94:95], v103 offset:18432
    s_waitcnt lgkmcnt(14)
    v_mfma_f32_32x32x16_bf16 v[160:175], v[64:67], v[116:119], v[160:175]
    v_mfma_f32_32x32x16_bf16 v[224:239], v[64:67], v[124:127], v[224:239]
    s_waitcnt lgkmcnt(12)
    v_mfma_f32_32x32x16_bf16 v[176:191], v[68:71], v[116:119], v[176:191]
    s_waitcnt vmcnt(20)
    s_barrier
    s_add_u32 s40, s34, 4718592
    s_add_u32 m0, s39, 0
    s_nop 0
    buffer_load_dwordx4 v104, s[20:23], s40 offen offset:0 lds
    s_add_u32 s40, s34, 4751360
    s_add_u32 m0, s39, 1024
    s_nop 0
    buffer_load_dwordx4 v105, s[20:23], s40 offen offset:0 lds
    s_add_u32 s41, s32, 36864
    s_add_u32 s42, s33, 18432
    buffer_load_dwordx4 v[48:51], v106, s[24:27], s41 offen offset:0
    buffer_load_dwordx4 v[52:55], v106, s[24:27], s41 offen offset:1024
    buffer_load_dwordx4 v[56:59], v106, s[24:27], s42 offen offset:0
    s_waitcnt lgkmcnt(10)
    v_mfma_f32_32x32x16_bf16 v[192:207], v[72:75], v[116:119], v[192:207]
    s_waitcnt lgkmcnt(8)
    v_mfma_f32_32x32x16_bf16 v[208:223], v[76:79], v[116:119], v[208:223]
    ds_read_b64_tr_b16 v[64:65], v96 offset:24576
    ds_read_b64_tr_b16 v[66:67], v97 offset:24576
    ds_read_b64_tr_b16 v[68:69], v98 offset:24576
    ds_read_b64_tr_b16 v[70:71], v99 offset:24576
    ds_read_b64_tr_b16 v[72:73], v100 offset:24576
    ds_read_b64_tr_b16 v[74:75], v101 offset:24576
    ds_read_b64_tr_b16 v[76:77], v102 offset:24576
    ds_read_b64_tr_b16 v[78:79], v103 offset:24576
    s_waitcnt lgkmcnt(14)
    v_mfma_f32_32x32x16_bf16 v[160:175], v[80:83], v[120:123], v[160:175]
    v_mfma_f32_32x32x16_bf16 v[144:159], v[80:83], v[124:127], v[144:159]
    s_waitcnt lgkmcnt(12)
    v_mfma_f32_32x32x16_bf16 v[176:191], v[84:87], v[120:123], v[176:191]
    s_waitcnt lgkmcnt(10)
    v_mfma_f32_32x32x16_bf16 v[192:207], v[88:91], v[120:123], v[192:207]
    s_waitcnt lgkmcnt(8)
    v_mfma_f32_32x32x16_bf16 v[208:223], v[92:95], v[120:123], v[208:223]
    ds_read_b64_tr_b16 v[80:81], v96 offset:26624
    ds_read_b64_tr_b16 v[82:83], v97 offset:26624
    ds_read_b64_tr_b16 v[84:85], v98 offset:26624
    ds_read_b64_tr_b16 v[86:87], v99 offset:26624
    ds_read_b64_tr_b16 v[88:89], v100 offset:26624
    ds_read_b64_tr_b16 v[90:91], v101 offset:26624
    ds_read_b64_tr_b16 v[92:93], v102 offset:26624
    ds_read_b64_tr_b16 v[94:95], v103 offset:26624
    s_waitcnt lgkmcnt(14)
    v_mfma_f32_32x32x16_bf16 v[160:175], v[64:67], v[128:131], v[160:175]
    v_mfma_f32_32x32x16_bf16 v[224:239], v[64:67], v[136:139], v[224:239]
    s_waitcnt lgkmcnt(12)
    v_mfma_f32_32x32x16_bf16 v[176:191], v[68:71], v[128:131], v[176:191]
    s_waitcnt vmcnt(20)
    s_barrier
    s_add_u32 s40, s34, 4980736
    s_add_u32 m0, s39, 8192
    s_nop 0
    buffer_load_dwordx4 v104, s[20:23], s40 offen offset:0 lds
    s_add_u32 s40, s34, 5013504
    s_add_u32 m0, s39, 9216
    s_nop 0
    buffer_load_dwordx4 v105, s[20:23], s40 offen offset:0 lds
    s_add_u32 s41, s32, 38912
    s_add_u32 s42, s33, 19456
    buffer_load_dwordx4 v[116:119], v106, s[24:27], s41 offen offset:0
    buffer_load_dwordx4 v[120:123], v106, s[24:27], s41 offen offset:1024
    buffer_load_dwordx4 v[124:127], v106, s[24:27], s42 offen offset:0
    s_waitcnt lgkmcnt(10)
    v_mfma_f32_32x32x16_bf16 v[192:207], v[72:75], v[128:131], v[192:207]
    s_waitcnt lgkmcnt(8)
    v_mfma_f32_32x32x16_bf16 v[208:223], v[76:79], v[128:131], v[208:223]
    ds_read_b64_tr_b16 v[64:65], v96 offset:32768
    ds_read_b64_tr_b16 v[66:67], v97 offset:32768
    ds_read_b64_tr_b16 v[68:69], v98 offset:32768
    ds_read_b64_tr_b16 v[70:71], v99 offset:32768
    ds_read_b64_tr_b16 v[72:73], v100 offset:32768
    ds_read_b64_tr_b16 v[74:75], v101 offset:32768
    ds_read_b64_tr_b16 v[76:77], v102 offset:32768
    ds_read_b64_tr_b16 v[78:79], v103 offset:32768
    s_waitcnt lgkmcnt(14)
    v_mfma_f32_32x32x16_bf16 v[160:175], v[80:83], v[132:135], v[160:175]
    v_mfma_f32_32x32x16_bf16 v[144:159], v[80:83], v[136:139], v[144:159]
    s_waitcnt lgkmcnt(12)
    v_mfma_f32_32x32x16_bf16 v[176:191], v[84:87], v[132:135], v[176:191]
    s_waitcnt lgkmcnt(10)
    v_mfma_f32_32x32x16_bf16 v[192:207], v[88:91], v[132:135], v[192:207]
    s_waitcnt lgkmcnt(8)
    v_mfma_f32_32x32x16_bf16 v[208:223], v[92:95], v[132:135], v[208:223]
    ds_read_b64_tr_b16 v[80:81], v96 offset:34816
    ds_read_b64_tr_b16 v[82:83], v97 offset:34816
    ds_read_b64_tr_b16 v[84:85], v98 offset:34816
    ds_read_b64_tr_b16 v[86:87], v99 offset:34816
    ds_read_b64_tr_b16 v[88:89], v100 offset:34816
    ds_read_b64_tr_b16 v[90:91], v101 offset:34816
    ds_read_b64_tr_b16 v[92:93], v102 offset:34816
    ds_read_b64_tr_b16 v[94:95], v103 offset:34816
    s_waitcnt lgkmcnt(14)
    v_mfma_f32_32x32x16_bf16 v[160:175], v[64:67], v[0:3], v[160:175]
    v_mfma_f32_32x32x16_bf16 v[224:239], v[64:67], v[8:11], v[224:239]
    s_waitcnt lgkmcnt(12)
    v_mfma_f32_32x32x16_bf16 v[176:191], v[68:71], v[0:3], v[176:191]
    s_waitcnt vmcnt(20)
    s_barrier
    s_add_u32 s40, s35, 16384
    s_add_u32 m0, s36, 16384
    s_nop 0
    buffer_load_dwordx4 v252, s[12:15], s40 offen offset:0 nt lds
    v_xor_b32 v108, 64, v252
    buffer_load_dwordx4 v108, s[12:15], s40 offen offset:1024 nt lds
    v_xor_b32 v107, 128, v252
    buffer_load_dwordx4 v107, s[12:15], s40 offen offset:2048 nt lds
    v_xor_b32 v108, 192, v252
    buffer_load_dwordx4 v108, s[12:15], s40 offen offset:3072 nt lds
    s_waitcnt lgkmcnt(10)
    v_mfma_f32_32x32x16_bf16 v[192:207], v[72:75], v[0:3], v[192:207]
    s_waitcnt lgkmcnt(8)
    v_mfma_f32_32x32x16_bf16 v[208:223], v[76:79], v[0:3], v[208:223]
    ds_read_b64_tr_b16 v[64:65], v96 offset:40960
    ds_read_b64_tr_b16 v[66:67], v97 offset:40960
    ds_read_b64_tr_b16 v[68:69], v98 offset:40960
    ds_read_b64_tr_b16 v[70:71], v99 offset:40960
    ds_read_b64_tr_b16 v[72:73], v100 offset:40960
    ds_read_b64_tr_b16 v[74:75], v101 offset:40960
    ds_read_b64_tr_b16 v[76:77], v102 offset:40960
    ds_read_b64_tr_b16 v[78:79], v103 offset:40960
    s_waitcnt lgkmcnt(14)
    v_mfma_f32_32x32x16_bf16 v[160:175], v[80:83], v[4:7], v[160:175]
    v_mfma_f32_32x32x16_bf16 v[144:159], v[80:83], v[8:11], v[144:159]
    s_waitcnt lgkmcnt(12)
    v_mfma_f32_32x32x16_bf16 v[176:191], v[84:87], v[4:7], v[176:191]
    s_waitcnt lgkmcnt(10)
    v_mfma_f32_32x32x16_bf16 v[192:207], v[88:91], v[4:7], v[192:207]
    s_waitcnt lgkmcnt(8)
    v_mfma_f32_32x32x16_bf16 v[208:223], v[92:95], v[4:7], v[208:223]
    ds_read_b64_tr_b16 v[80:81], v96 offset:43008
    ds_read_b64_tr_b16 v[82:83], v97 offset:43008
    ds_read_b64_tr_b16 v[84:85], v98 offset:43008
    ds_read_b64_tr_b16 v[86:87], v99 offset:43008
    ds_read_b64_tr_b16 v[88:89], v100 offset:43008
    ds_read_b64_tr_b16 v[90:91], v101 offset:43008
    ds_read_b64_tr_b16 v[92:93], v102 offset:43008
    ds_read_b64_tr_b16 v[94:95], v103 offset:43008
    s_waitcnt lgkmcnt(14)
    v_mfma_f32_32x32x16_bf16 v[160:175], v[64:67], v[12:15], v[160:175]
    v_mfma_f32_32x32x16_bf16 v[224:239], v[64:67], v[20:23], v[224:239]
    s_waitcnt lgkmcnt(12)
    v_mfma_f32_32x32x16_bf16 v[176:191], v[68:71], v[12:15], v[176:191]
    s_waitcnt vmcnt(19)
    s_barrier
    s_waitcnt lgkmcnt(10)
    v_mfma_f32_32x32x16_bf16 v[192:207], v[72:75], v[12:15], v[192:207]
    s_waitcnt lgkmcnt(8)
    v_mfma_f32_32x32x16_bf16 v[208:223], v[76:79], v[12:15], v[208:223]
    ds_read_b64_tr_b16 v[64:65], v96 offset:49152
    ds_read_b64_tr_b16 v[66:67], v97 offset:49152
    ds_read_b64_tr_b16 v[68:69], v98 offset:49152
    ds_read_b64_tr_b16 v[70:71], v99 offset:49152
    ds_read_b64_tr_b16 v[72:73], v100 offset:49152
    ds_read_b64_tr_b16 v[74:75], v101 offset:49152
    ds_read_b64_tr_b16 v[76:77], v102 offset:49152
    ds_read_b64_tr_b16 v[78:79], v103 offset:49152
    s_waitcnt lgkmcnt(14)
    v_mfma_f32_32x32x16_bf16 v[160:175], v[80:83], v[16:19], v[160:175]
    v_mfma_f32_32x32x16_bf16 v[144:159], v[80:83], v[20:23], v[144:159]
    s_waitcnt lgkmcnt(12)
    v_mfma_f32_32x32x16_bf16 v[176:191], v[84:87], v[16:19], v[176:191]
    s_waitcnt lgkmcnt(10)
    v_mfma_f32_32x32x16_bf16 v[192:207], v[88:91], v[16:19], v[192:207]
    s_waitcnt lgkmcnt(8)
    v_mfma_f32_32x32x16_bf16 v[208:223], v[92:95], v[16:19], v[208:223]
    ds_read_b64_tr_b16 v[80:81], v96 offset:51200
    ds_read_b64_tr_b16 v[82:83], v97 offset:51200
    ds_read_b64_tr_b16 v[84:85], v98 offset:51200
    ds_read_b64_tr_b16 v[86:87], v99 offset:51200
    ds_read_b64_tr_b16 v[88:89], v100 offset:51200
    ds_read_b64_tr_b16 v[90:91], v101 offset:51200
    ds_read_b64_tr_b16 v[92:93], v102 offset:51200
    ds_read_b64_tr_b16 v[94:95], v103 offset:51200
    s_waitcnt lgkmcnt(14)
    v_mfma_f32_32x32x16_bf16 v[160:175], v[64:67], v[24:27], v[160:175]
    v_mfma_f32_32x32x16_bf16 v[224:239], v[64:67], v[32:35], v[224:239]
    s_waitcnt lgkmcnt(12)
    v_mfma_f32_32x32x16_bf16 v[176:191], v[68:71], v[24:27], v[176:191]
    s_waitcnt vmcnt(14)
    s_barrier
    s_add_u32 s40, s35, 0
    s_add_u32 m0, s36, 32768
    s_nop 0
    buffer_load_dwordx4 v253, s[16:19], s40 offen offset:0 nt lds
    v_xor_b32 v108, 32, v253
    buffer_load_dwordx4 v108, s[16:19], s40 offen offset:1024 nt lds
    buffer_load_dwordx4 v253, s[16:19], s40 offen offset:2048 nt lds
    v_xor_b32 v108, 32, v253
    buffer_load_dwordx4 v108, s[16:19], s40 offen offset:3072 nt lds
    s_waitcnt lgkmcnt(10)
    v_mfma_f32_32x32x16_bf16 v[192:207], v[72:75], v[24:27], v[192:207]
    s_waitcnt lgkmcnt(8)
    v_mfma_f32_32x32x16_bf16 v[208:223], v[76:79], v[24:27], v[208:223]
    ds_read_b64_tr_b16 v[64:65], v96 offset:57344
    ds_read_b64_tr_b16 v[66:67], v97 offset:57344
    ds_read_b64_tr_b16 v[68:69], v98 offset:57344
    ds_read_b64_tr_b16 v[70:71], v99 offset:57344
    ds_read_b64_tr_b16 v[72:73], v100 offset:57344
    ds_read_b64_tr_b16 v[74:75], v101 offset:57344
    ds_read_b64_tr_b16 v[76:77], v102 offset:57344
    ds_read_b64_tr_b16 v[78:79], v103 offset:57344
    s_waitcnt lgkmcnt(14)
    v_mfma_f32_32x32x16_bf16 v[160:175], v[80:83], v[28:31], v[160:175]
    v_mfma_f32_32x32x16_bf16 v[144:159], v[80:83], v[32:35], v[144:159]
    s_waitcnt lgkmcnt(12)
    v_mfma_f32_32x32x16_bf16 v[176:191], v[84:87], v[28:31], v[176:191]
    s_waitcnt lgkmcnt(10)
    v_mfma_f32_32x32x16_bf16 v[192:207], v[88:91], v[28:31], v[192:207]
    s_waitcnt lgkmcnt(8)
    v_mfma_f32_32x32x16_bf16 v[208:223], v[92:95], v[28:31], v[208:223]
    ds_read_b64_tr_b16 v[80:81], v96 offset:59392
    ds_read_b64_tr_b16 v[82:83], v97 offset:59392
    ds_read_b64_tr_b16 v[84:85], v98 offset:59392
    ds_read_b64_tr_b16 v[86:87], v99 offset:59392
    ds_read_b64_tr_b16 v[88:89], v100 offset:59392
    ds_read_b64_tr_b16 v[90:91], v101 offset:59392
    ds_read_b64_tr_b16 v[92:93], v102 offset:59392
    ds_read_b64_tr_b16 v[94:95], v103 offset:59392
    s_waitcnt lgkmcnt(14)
    v_mfma_f32_32x32x16_bf16 v[160:175], v[64:67], v[36:39], v[160:175]
    v_mfma_f32_32x32x16_bf16 v[224:239], v[64:67], v[44:47], v[224:239]
    s_waitcnt lgkmcnt(12)
    v_mfma_f32_32x32x16_bf16 v[176:191], v[68:71], v[36:39], v[176:191]
    s_waitcnt vmcnt(13)
    s_barrier
    s_waitcnt lgkmcnt(10)
    v_mfma_f32_32x32x16_bf16 v[192:207], v[72:75], v[36:39], v[192:207]
    s_waitcnt lgkmcnt(8)
    v_mfma_f32_32x32x16_bf16 v[208:223], v[76:79], v[36:39], v[208:223]
    ds_read_b64_tr_b16 v[64:65], v96 offset:0
    ds_read_b64_tr_b16 v[66:67], v97 offset:0
    ds_read_b64_tr_b16 v[68:69], v98 offset:0
    ds_read_b64_tr_b16 v[70:71], v99 offset:0
    ds_read_b64_tr_b16 v[72:73], v100 offset:0
    ds_read_b64_tr_b16 v[74:75], v101 offset:0
    ds_read_b64_tr_b16 v[76:77], v102 offset:0
    ds_read_b64_tr_b16 v[78:79], v103 offset:0
    s_waitcnt lgkmcnt(14)
    v_mfma_f32_32x32x16_bf16 v[160:175], v[80:83], v[40:43], v[160:175]
    v_mfma_f32_32x32x16_bf16 v[144:159], v[80:83], v[44:47], v[144:159]
    s_waitcnt lgkmcnt(12)
    v_mfma_f32_32x32x16_bf16 v[176:191], v[84:87], v[40:43], v[176:191]
    s_waitcnt lgkmcnt(10)
    v_mfma_f32_32x32x16_bf16 v[192:207], v[88:91], v[40:43], v[192:207]
    s_waitcnt lgkmcnt(8)
    v_mfma_f32_32x32x16_bf16 v[208:223], v[92:95], v[40:43], v[208:223]
    ds_read_b64_tr_b16 v[80:81], v96 offset:2048
    ds_read_b64_tr_b16 v[82:83], v97 offset:2048
    ds_read_b64_tr_b16 v[84:85], v98 offset:2048
    ds_read_b64_tr_b16 v[86:87], v99 offset:2048
    ds_read_b64_tr_b16 v[88:89], v100 offset:2048
    ds_read_b64_tr_b16 v[90:91], v101 offset:2048
    ds_read_b64_tr_b16 v[92:93], v102 offset:2048
    ds_read_b64_tr_b16 v[94:95], v103 offset:2048
    s_waitcnt lgkmcnt(14)
    v_mfma_f32_32x32x16_bf16 v[160:175], v[64:67], v[48:51], v[160:175]
    v_mfma_f32_32x32x16_bf16 v[224:239], v[64:67], v[56:59], v[224:239]
    s_waitcnt lgkmcnt(12)
    v_mfma_f32_32x32x16_bf16 v[176:191], v[68:71], v[48:51], v[176:191]
    s_waitcnt vmcnt(8)
    s_barrier
    s_add_u32 s40, s35, 32768
    s_add_u32 m0, s36, 49152
    s_nop 0
    buffer_load_dwordx4 v252, s[12:15], s40 offen offset:0 nt lds
    v_xor_b32 v108, 64, v252
    buffer_load_dwordx4 v108, s[12:15], s40 offen offset:1024 nt lds
    v_xor_b32 v107, 128, v252
    buffer_load_dwordx4 v107, s[12:15], s40 offen offset:2048 nt lds
    v_xor_b32 v108, 192, v252
    buffer_load_dwordx4 v108, s[12:15], s40 offen offset:3072 nt lds
    s_waitcnt lgkmcnt(10)
    v_mfma_f32_32x32x16_bf16 v[192:207], v[72:75], v[48:51], v[192:207]
    s_waitcnt lgkmcnt(8)
    v_mfma_f32_32x32x16_bf16 v[208:223], v[76:79], v[48:51], v[208:223]
    ds_read_b64_tr_b16 v[64:65], v96 offset:8192
    ds_read_b64_tr_b16 v[66:67], v97 offset:8192
    ds_read_b64_tr_b16 v[68:69], v98 offset:8192
    ds_read_b64_tr_b16 v[70:71], v99 offset:8192
    ds_read_b64_tr_b16 v[72:73], v100 offset:8192
    ds_read_b64_tr_b16 v[74:75], v101 offset:8192
    ds_read_b64_tr_b16 v[76:77], v102 offset:8192
    ds_read_b64_tr_b16 v[78:79], v103 offset:8192
    s_waitcnt lgkmcnt(14)
    v_mfma_f32_32x32x16_bf16 v[160:175], v[80:83], v[52:55], v[160:175]
    v_mfma_f32_32x32x16_bf16 v[144:159], v[80:83], v[56:59], v[144:159]
    s_waitcnt lgkmcnt(12)
    v_mfma_f32_32x32x16_bf16 v[176:191], v[84:87], v[52:55], v[176:191]
    s_waitcnt lgkmcnt(10)
    v_mfma_f32_32x32x16_bf16 v[192:207], v[88:91], v[52:55], v[192:207]
    s_waitcnt lgkmcnt(8)
    v_mfma_f32_32x32x16_bf16 v[208:223], v[92:95], v[52:55], v[208:223]
    ds_read_b64_tr_b16 v[80:81], v96 offset:10240
    ds_read_b64_tr_b16 v[82:83], v97 offset:10240
    ds_read_b64_tr_b16 v[84:85], v98 offset:10240
    ds_read_b64_tr_b16 v[86:87], v99 offset:10240
    ds_read_b64_tr_b16 v[88:89], v100 offset:10240
    ds_read_b64_tr_b16 v[90:91], v101 offset:10240
    ds_read_b64_tr_b16 v[92:93], v102 offset:10240
    ds_read_b64_tr_b16 v[94:95], v103 offset:10240
    s_waitcnt lgkmcnt(14)
    v_mfma_f32_32x32x16_bf16 v[160:175], v[64:67], v[116:119], v[160:175]
    v_mfma_f32_32x32x16_bf16 v[224:239], v[64:67], v[124:127], v[224:239]
    s_waitcnt lgkmcnt(12)
    v_mfma_f32_32x32x16_bf16 v[176:191], v[68:71], v[116:119], v[176:191]
    s_barrier
    s_waitcnt lgkmcnt(10)
    v_mfma_f32_32x32x16_bf16 v[192:207], v[72:75], v[116:119], v[192:207]
    s_waitcnt lgkmcnt(8)
    v_mfma_f32_32x32x16_bf16 v[208:223], v[76:79], v[116:119], v[208:223]
    s_waitcnt lgkmcnt(6)
    v_mfma_f32_32x32x16_bf16 v[160:175], v[80:83], v[120:123], v[160:175]
    v_mfma_f32_32x32x16_bf16 v[144:159], v[80:83], v[124:127], v[144:159]
    s_waitcnt lgkmcnt(4)
    v_mfma_f32_32x32x16_bf16 v[176:191], v[84:87], v[120:123], v[176:191]
    s_waitcnt lgkmcnt(2)
    v_mfma_f32_32x32x16_bf16 v[192:207], v[88:91], v[120:123], v[192:207]
    s_waitcnt lgkmcnt(0)
    v_mfma_f32_32x32x16_bf16 v[208:223], v[92:95], v[120:123], v[208:223]
    v_mov_b32 v64, v224
    v_mov_b32 v65, v225
    v_mov_b32 v66, v226
    v_mov_b32 v67, v227
    v_mov_b32 v68, v228
    v_mov_b32 v69, v229
    v_mov_b32 v70, v230
    v_mov_b32 v71, v231
    v_mov_b32 v72, v232
    v_mov_b32 v73, v233
    v_mov_b32 v74, v234
    v_mov_b32 v75, v235
    v_mov_b32 v76, v236
    v_mov_b32 v77, v237
    v_mov_b32 v78, v238
    v_mov_b32 v79, v239
    v_permlane16_swap_b32 v144, v64
    v_permlane16_swap_b32 v145, v65
    v_permlane16_swap_b32 v146, v66
    v_permlane16_swap_b32 v147, v67
    v_permlane16_swap_b32 v148, v68
    v_permlane16_swap_b32 v149, v69
    v_permlane16_swap_b32 v150, v70
    v_permlane16_swap_b32 v151, v71
    v_permlane16_swap_b32 v152, v72
    v_permlane16_swap_b32 v153, v73
    v_permlane16_swap_b32 v154, v74
    v_permlane16_swap_b32 v155, v75
    v_permlane16_swap_b32 v156, v76
    v_permlane16_swap_b32 v157, v77
    v_permlane16_swap_b32 v158, v78
    v_permlane16_swap_b32 v159, v79
    v_add_f32 v224, v224, v64
    v_add_f32 v225, v225, v65
    v_add_f32 v226, v226, v66
    v_add_f32 v227, v227, v67
    v_add_f32 v228, v228, v68
    v_add_f32 v229, v229, v69
    v_add_f32 v230, v230, v70
    v_add_f32 v231, v231, v71
    v_add_f32 v232, v232, v72
    v_add_f32 v233, v233, v73
    v_add_f32 v234, v234, v74
    v_add_f32 v235, v235, v75
    v_add_f32 v236, v236, v76
    v_add_f32 v237, v237, v77
    v_add_f32 v238, v238, v78
    v_add_f32 v239, v239, v79
    v_cvt_pk_bf16_f32 v96, v224, v225
    v_cvt_pk_bf16_f32 v97, v226, v227
    v_cvt_pk_bf16_f32 v98, v228, v229
    v_cvt_pk_bf16_f32 v99, v230, v231
    v_cvt_pk_bf16_f32 v100, v232, v233
    v_cvt_pk_bf16_f32 v101, v234, v235
    v_cvt_pk_bf16_f32 v102, v236, v237
    v_cvt_pk_bf16_f32 v103, v238, v239
    v_xor_b32 v240, 32, v255
    s_waitcnt lgkmcnt(0)
    s_barrier
    s_mov_b32 exec_lo, 0xffff
    s_mov_b32 exec_hi, 0xffff
    s_nop 0
    ds_write_b128 v255, v[96:99] offset:0
    ds_write_b128 v240, v[100:103] offset:0
    s_mov_b64 exec, -1
    s_nop 0
    v_cvt_pk_bf16_f32 v128, v160, v161
    v_cvt_pk_bf16_f32 v129, v162, v163
    v_cvt_pk_bf16_f32 v130, v164, v165
    v_cvt_pk_bf16_f32 v131, v166, v167
    v_cvt_pk_bf16_f32 v132, v168, v169
    v_cvt_pk_bf16_f32 v133, v170, v171
    v_cvt_pk_bf16_f32 v134, v172, v173
    v_cvt_pk_bf16_f32 v135, v174, v175
    v_cvt_pk_bf16_f32 v136, v176, v177
    v_cvt_pk_bf16_f32 v137, v178, v179
    v_cvt_pk_bf16_f32 v138, v180, v181
    v_cvt_pk_bf16_f32 v139, v182, v183
    v_cvt_pk_bf16_f32 v140, v184, v185
    v_cvt_pk_bf16_f32 v141, v186, v187
    v_cvt_pk_bf16_f32 v142, v188, v189
    v_cvt_pk_bf16_f32 v143, v190, v191
    v_cvt_pk_bf16_f32 v144, v192, v193
    v_cvt_pk_bf16_f32 v145, v194, v195
    v_cvt_pk_bf16_f32 v146, v196, v197
    v_cvt_pk_bf16_f32 v147, v198, v199
    v_cvt_pk_bf16_f32 v148, v200, v201
    v_cvt_pk_bf16_f32 v149, v202, v203
    v_cvt_pk_bf16_f32 v150, v204, v205
    v_cvt_pk_bf16_f32 v151, v206, v207
    v_cvt_pk_bf16_f32 v152, v208, v209
    v_cvt_pk_bf16_f32 v153, v210, v211
    v_cvt_pk_bf16_f32 v154, v212, v213
    v_cvt_pk_bf16_f32 v155, v214, v215
    v_cvt_pk_bf16_f32 v156, v216, v217
    v_cvt_pk_bf16_f32 v157, v218, v219
    v_cvt_pk_bf16_f32 v158, v220, v221
    v_cvt_pk_bf16_f32 v159, v222, v223
    s_waitcnt lgkmcnt(0)
    s_barrier
    ds_read_b128 v[160:163], v250 offset:0
    v_add_u32 v246, s43, v250
    ds_read_b128 v[164:167], v246 offset:49152
    v_xor_b32 v247, 64, v250
    ds_read_b128 v[168:171], v247 offset:0
    v_add_u32 v246, s43, v247
    ds_read_b128 v[172:175], v246 offset:49152
    v_xor_b32 v247, 128, v250
    ds_read_b128 v[176:179], v247 offset:0
    v_add_u32 v246, s43, v247
    ds_read_b128 v[180:183], v246 offset:49152
    v_xor_b32 v247, 192, v250
    ds_read_b128 v[184:187], v247 offset:0
    v_add_u32 v246, s43, v247
    ds_read_b128 v[188:191], v246 offset:49152
    s_waitcnt lgkmcnt(6)
    v_mfma_f32_16x16x32_bf16 v[224:227], v[164:167], v[160:163], 0
    v_xor_b32 v247, s44, v248
    ds_read_b128 v[160:163], v247 offset:49152
    ds_read_b128 v[164:167], v247 offset:57344
    s_waitcnt lgkmcnt(6)
    v_mfma_f32_16x16x32_bf16 v[224:227], v[172:175], v[168:171], v[224:227]
    v_xor_b32 v246, s45, v248
    ds_read_b128 v[168:171], v246 offset:49152
    ds_read_b128 v[172:175], v246 offset:57344
    s_waitcnt lgkmcnt(6)
    v_mfma_f32_16x16x32_bf16 v[224:227], v[180:183], v[176:179], v[224:227]
    v_xor_b32 v247, s46, v248
    ds_read_b128 v[176:179], v247 offset:49152
    ds_read_b128 v[180:183], v247 offset:57344
    s_waitcnt lgkmcnt(6)
    v_mfma_f32_16x16x32_bf16 v[224:227], v[188:191], v[184:187], v[224:227]
    v_xor_b32 v246, s47, v248
    ds_read_b128 v[184:187], v246 offset:49152
    ds_read_b128 v[188:191], v246 offset:57344
    s_waitcnt lgkmcnt(7)
    v_mfma_f32_32x32x16_bf16 v[64:79], v[160:163], v[128:131], 0
    v_xor_b32 v247, s48, v248
    ds_read_b128 v[160:163], v247 offset:49152
    s_waitcnt lgkmcnt(7)
    v_mfma_f32_32x32x16_bf16 v[80:95], v[164:167], v[128:131], 0
    ds_read_b128 v[164:167], v247 offset:57344
    s_waitcnt lgkmcnt(7)
    v_mfma_f32_32x32x16_bf16 v[64:79], v[168:171], v[132:135], v[64:79]
    v_xor_b32 v246, s49, v248
    ds_read_b128 v[168:171], v246 offset:49152
    s_waitcnt lgkmcnt(7)
    v_mfma_f32_32x32x16_bf16 v[80:95], v[172:175], v[132:135], v[80:95]
    ds_read_b128 v[172:175], v246 offset:57344
    s_waitcnt lgkmcnt(7)
    v_mfma_f32_32x32x16_bf16 v[64:79], v[176:179], v[136:139], v[64:79]
    v_xor_b32 v247, s50, v248
    ds_read_b128 v[176:179], v247 offset:49152
    s_waitcnt lgkmcnt(7)
    v_mfma_f32_32x32x16_bf16 v[80:95], v[180:183], v[136:139], v[80:95]
    ds_read_b128 v[180:183], v247 offset:57344
    s_waitcnt lgkmcnt(7)
    v_mfma_f32_32x32x16_bf16 v[64:79], v[184:187], v[140:143], v[64:79]
    v_xor_b32 v246, s51, v248
    ds_read_b128 v[184:187], v246 offset:49152
    s_waitcnt lgkmcnt(7)
    v_mfma_f32_32x32x16_bf16 v[80:95], v[188:191], v[140:143], v[80:95]
    ds_read_b128 v[188:191], v246 offset:57344
    s_waitcnt lgkmcnt(7)
    v_mfma_f32_32x32x16_bf16 v[64:79], v[160:163], v[144:147], v[64:79]
    s_waitcnt lgkmcnt(6)
    v_mfma_f32_32x32x16_bf16 v[80:95], v[164:167], v[144:147], v[80:95]
    s_waitcnt lgkmcnt(5)
    v_mfma_f32_32x32x16_bf16 v[64:79], v[168:171], v[148:151], v[64:79]
    s_waitcnt vmcnt(8) lgkmcnt(0)
    s_barrier
    s_add_u32 s40, s35, 16384
    s_add_u32 m0, s36, 65536
    s_nop 0
    buffer_load_dwordx4 v253, s[16:19], s40 offen offset:0 nt lds
    v_xor_b32 v245, 32, v253
    buffer_load_dwordx4 v245, s[16:19], s40 offen offset:1024 nt lds
    buffer_load_dwordx4 v253, s[16:19], s40 offen offset:2048 nt lds
    v_xor_b32 v245, 32, v253
    buffer_load_dwordx4 v245, s[16:19], s40 offen offset:3072 nt lds
    ds_read_b128 v[160:163], v250 offset:0
    v_add_u32 v247, s43, v250
    ds_read_b128 v[164:167], v247 offset:0
    v_xor_b32 v246, 64, v250
    ds_read_b128 v[168:171], v246 offset:0
    v_mfma_f32_32x32x16_bf16 v[80:95], v[172:175], v[148:151], v[80:95]
    v_add_u32 v247, s43, v246
    ds_read_b128 v[172:175], v247 offset:0
    v_mfma_f32_32x32x16_bf16 v[64:79], v[176:179], v[152:155], v[64:79]
    v_xor_b32 v246, 128, v250
    ds_read_b128 v[176:179], v246 offset:0
    v_mfma_f32_32x32x16_bf16 v[80:95], v[180:183], v[152:155], v[80:95]
    v_add_u32 v247, s43, v246
    ds_read_b128 v[180:183], v247 offset:0
    v_mfma_f32_32x32x16_bf16 v[64:79], v[184:187], v[156:159], v[64:79]
    v_xor_b32 v246, 192, v250
    ds_read_b128 v[184:187], v246 offset:0
    v_mfma_f32_32x32x16_bf16 v[80:95], v[188:191], v[156:159], v[80:95]
    v_add_u32 v247, s43, v246
    ds_read_b128 v[188:191], v247 offset:0
    s_waitcnt lgkmcnt(6)
    v_mfma_f32_16x16x32_bf16 v[228:231], v[164:167], v[160:163], 0
    v_xor_b32 v246, s44, v248
    ds_read_b128 v[160:163], v246 offset:0
    ds_read_b128 v[164:167], v246 offset:8192
    v_max3_f32 v242, v224, v225, v226
    v_max_f32 v242, v242, v227
    v_mov_b32 v243, v242
    s_waitcnt lgkmcnt(6)
    v_mfma_f32_16x16x32_bf16 v[228:231], v[172:175], v[168:171], v[228:231]
    v_xor_b32 v247, s45, v248
    ds_read_b128 v[168:171], v247 offset:0
    ds_read_b128 v[172:175], v247 offset:8192
    v_max3_f32 v240, v64, v65, v66
    v_max3_f32 v241, v67, v68, v69
    v_permlane32_swap_b32 v242, v243
    s_waitcnt lgkmcnt(6)
    v_mfma_f32_16x16x32_bf16 v[228:231], v[180:183], v[176:179], v[228:231]
    v_xor_b32 v246, s46, v248
    ds_read_b128 v[176:179], v246 offset:0
    ds_read_b128 v[180:183], v246 offset:8192
    v_max3_f32 v240, v240, v70, v71
    v_max_f32 v242, v242, v243
    v_mov_b32 v243, v242
    s_waitcnt lgkmcnt(6)
    v_mfma_f32_16x16x32_bf16 v[228:231], v[188:191], v[184:187], v[228:231]
    v_xor_b32 v247, s47, v248
    ds_read_b128 v[184:187], v247 offset:0
    ds_read_b128 v[188:191], v247 offset:8192
    v_max3_f32 v241, v241, v72, v73
    v_max3_f32 v240, v240, v74, v75
    v_max3_f32 v241, v241, v76, v77
    s_waitcnt lgkmcnt(7)
    v_mfma_f32_32x32x16_bf16 v[96:111], v[160:163], v[128:131], 0
    v_xor_b32 v246, s48, v248
    ds_read_b128 v[160:163], v246 offset:0
    v_permlane16_swap_b32 v242, v243
    v_max3_f32 v240, v240, v78, v79
    v_max_f32 v242, v242, v243
    v_max3_f32 v241, v241, v80, v81
    v_max3_f32 v240, v240, v82, v83
    s_waitcnt lgkmcnt(7)
    v_mfma_f32_32x32x16_bf16 v[112:127], v[164:167], v[128:131], 0
    ds_read_b128 v[164:167], v246 offset:8192
    v_max3_f32 v241, v241, v84, v85
    v_max3_f32 v240, v240, v86, v87
    v_max3_f32 v241, v241, v88, v89
    v_max3_f32 v240, v240, v90, v91
    v_max3_f32 v241, v241, v92, v93
    s_waitcnt lgkmcnt(7)
    v_mfma_f32_32x32x16_bf16 v[96:111], v[168:171], v[132:135], v[96:111]
    v_xor_b32 v247, s49, v248
    ds_read_b128 v[168:171], v247 offset:0
    v_max3_f32 v240, v240, v94, v95
    v_max_f32 v240, v240, v241
    v_mov_b32 v241, v240
    s_nop 1
    v_permlane32_swap_b32 v240, v241
    s_waitcnt lgkmcnt(7)
    v_mfma_f32_32x32x16_bf16 v[112:127], v[172:175], v[132:135], v[112:127]
    ds_read_b128 v[172:175], v247 offset:8192
    v_max_f32 v240, v240, v241
    v_mov_b32 v236, v240
    v_mov_b32 v234, v242
    v_mul_f32 v238, s37, v240
    v_mul_f32 v239, s37, v242
    s_waitcnt lgkmcnt(7)
    v_mfma_f32_32x32x16_bf16 v[96:111], v[176:179], v[136:139], v[96:111]
    v_xor_b32 v246, s50, v248
    ds_read_b128 v[176:179], v246 offset:0
    v_fma_f32 v224, v224, s37, -v239
    v_fma_f32 v225, v225, s37, -v239
    v_fma_f32 v226, v226, s37, -v239
    v_fma_f32 v227, v227, s37, -v239
    v_exp_f32 v224, v224
    s_waitcnt lgkmcnt(7)
    v_mfma_f32_32x32x16_bf16 v[112:127], v[180:183], v[136:139], v[112:127]
    ds_read_b128 v[180:183], v246 offset:8192
    v_exp_f32 v225, v225
    v_exp_f32 v226, v226
    v_exp_f32 v227, v227
    v_fma_f32 v64, v64, s37, -v238
    v_fma_f32 v65, v65, s37, -v238
    s_waitcnt lgkmcnt(7)
    v_mfma_f32_32x32x16_bf16 v[96:111], v[184:187], v[140:143], v[96:111]
    v_xor_b32 v247, s51, v248
    ds_read_b128 v[184:187], v247 offset:0
    v_fma_f32 v66, v66, s37, -v238
    v_fma_f32 v67, v67, s37, -v238
    v_fma_f32 v68, v68, s37, -v238
    v_fma_f32 v69, v69, s37, -v238
    v_fma_f32 v70, v70, s37, -v238
    s_waitcnt lgkmcnt(7)
    v_mfma_f32_32x32x16_bf16 v[112:127], v[188:191], v[140:143], v[112:127]
    ds_read_b128 v[188:191], v247 offset:8192
    v_fma_f32 v71, v71, s37, -v238
    v_add_f32 v243, v224, v225
    v_add_f32 v242, v226, v227
    v_cvt_pk_bf16_f32 v232, v224, v225
    v_cvt_pk_bf16_f32 v233, v226, v227
    s_waitcnt lgkmcnt(7)
    v_mfma_f32_32x32x16_bf16 v[96:111], v[160:163], v[144:147], v[96:111]
    v_add_f32 v235, v243, v242
    v_exp_f32 v64, v64
    v_exp_f32 v65, v65
    v_exp_f32 v66, v66
    v_exp_f32 v67, v67
    s_waitcnt lgkmcnt(6)
    v_mfma_f32_32x32x16_bf16 v[112:127], v[164:167], v[144:147], v[112:127]
    v_exp_f32 v68, v68
    v_exp_f32 v69, v69
    v_exp_f32 v70, v70
    v_exp_f32 v71, v71
    v_mov_b32 v237, v64
    s_waitcnt lgkmcnt(5)
    v_mfma_f32_32x32x16_bf16 v[96:111], v[168:171], v[148:151], v[96:111]
    s_waitcnt vmcnt(8) lgkmcnt(0)
    s_barrier
    s_add_u32 s40, s35, 49152
    s_add_u32 m0, s36, 16384
    s_nop 0
    buffer_load_dwordx4 v252, s[12:15], s40 offen offset:0 nt lds
    v_xor_b32 v245, 64, v252
    buffer_load_dwordx4 v245, s[12:15], s40 offen offset:1024 nt lds
    v_xor_b32 v244, 128, v252
    buffer_load_dwordx4 v244, s[12:15], s40 offen offset:2048 nt lds
    v_xor_b32 v245, 192, v252
    buffer_load_dwordx4 v245, s[12:15], s40 offen offset:3072 nt lds
    ds_read_b64_tr_b16 v[160:161], v251 offset:16384
    v_xor_b32 v246, 32, v251
    ds_read_b64_tr_b16 v[162:163], v246 offset:16384
    v_xor_b32 v247, 64, v251
    ds_read_b64_tr_b16 v[164:165], v247 offset:16384
    v_xor_b32 v246, 96, v251
    ds_read_b64_tr_b16 v[166:167], v246 offset:16384
    v_xor_b32 v247, 128, v251
    ds_read_b64_tr_b16 v[168:169], v247 offset:16384
    v_xor_b32 v246, 160, v251
    ds_read_b64_tr_b16 v[170:171], v246 offset:16384
    v_mov_b32 v241, v65
    v_cvt_pk_bf16_f32 v64, v64, v65
    v_add_f32 v237, v237, v66
    v_add_f32 v241, v241, v67
    v_cvt_pk_bf16_f32 v65, v66, v67
    v_mfma_f32_32x32x16_bf16 v[112:127], v[172:175], v[148:151], v[112:127]
    v_xor_b32 v247, 192, v251
    ds_read_b64_tr_b16 v[172:173], v247 offset:16384
    v_xor_b32 v246, 224, v251
    ds_read_b64_tr_b16 v[174:175], v246 offset:16384
    v_add_f32 v237, v237, v68
    v_add_f32 v241, v241, v69
    v_cvt_pk_bf16_f32 v66, v68, v69
    v_add_f32 v237, v237, v70
    v_add_f32 v241, v241, v71
    v_mfma_f32_32x32x16_bf16 v[96:111], v[176:179], v[152:155], v[96:111]
    ds_read_b64_tr_b16 v[176:177], v249 offset:16384
    ds_read_b64_tr_b16 v[178:179], v249 offset:18432
    v_cvt_pk_bf16_f32 v67, v70, v71
    v_fma_f32 v72, v72, s37, -v238
    v_fma_f32 v73, v73, s37, -v238
    v_fma_f32 v74, v74, s37, -v238
    v_fma_f32 v75, v75, s37, -v238
    v_mfma_f32_32x32x16_bf16 v[112:127], v[180:183], v[152:155], v[112:127]
    v_xor_b32 v247, 64, v249
    ds_read_b64_tr_b16 v[180:181], v247 offset:16384
    ds_read_b64_tr_b16 v[182:183], v247 offset:18432
    v_fma_f32 v76, v76, s37, -v238
    v_fma_f32 v77, v77, s37, -v238
    v_fma_f32 v78, v78, s37, -v238
    v_fma_f32 v79, v79, s37, -v238
    v_exp_f32 v72, v72
    v_mfma_f32_32x32x16_bf16 v[96:111], v[184:187], v[156:159], v[96:111]
    v_xor_b32 v246, 128, v249
    ds_read_b64_tr_b16 v[184:185], v246 offset:16384
    ds_read_b64_tr_b16 v[186:187], v246 offset:18432
    v_exp_f32 v73, v73
    v_exp_f32 v74, v74
    v_exp_f32 v75, v75
    v_exp_f32 v76, v76
    v_exp_f32 v77, v77
    v_mfma_f32_32x32x16_bf16 v[112:127], v[188:191], v[156:159], v[112:127]
    v_xor_b32 v247, 192, v249
    ds_read_b64_tr_b16 v[188:189], v247 offset:16384
    ds_read_b64_tr_b16 v[190:191], v247 offset:18432
    v_exp_f32 v78, v78
    v_exp_f32 v79, v79
    v_add_f32 v237, v237, v72
    v_add_f32 v241, v241, v73
    v_cvt_pk_bf16_f32 v72, v72, v73
    s_waitcnt lgkmcnt(14)
    v_mfma_f32_16x16x16_bf16 v[192:195], v[160:161], v[232:233], 0
    v_mfma_f32_16x16x16_bf16 v[196:199], v[162:163], v[232:233], 0
    ds_read_b64_tr_b16 v[160:161], v249 offset:20480
    ds_read_b64_tr_b16 v[162:163], v249 offset:22528
    v_add_f32 v237, v237, v74
    v_add_f32 v241, v241, v75
    v_cvt_pk_bf16_f32 v73, v74, v75
    v_add_f32 v237, v237, v76
    v_add_f32 v241, v241, v77
    s_waitcnt lgkmcnt(14)
    v_mfma_f32_16x16x16_bf16 v[200:203], v[164:165], v[232:233], 0
    v_mfma_f32_16x16x16_bf16 v[204:207], v[166:167], v[232:233], 0
    v_xor_b32 v246, 64, v249
    ds_read_b64_tr_b16 v[164:165], v246 offset:20480
    ds_read_b64_tr_b16 v[166:167], v246 offset:22528
    v_cvt_pk_bf16_f32 v74, v76, v77
    v_add_f32 v237, v237, v78
    v_add_f32 v241, v241, v79
    v_cvt_pk_bf16_f32 v75, v78, v79
    s_waitcnt lgkmcnt(14)
    v_mfma_f32_16x16x16_bf16 v[208:211], v[168:169], v[232:233], 0
    v_mfma_f32_16x16x16_bf16 v[212:215], v[170:171], v[232:233], 0
    v_xor_b32 v247, 128, v249
    ds_read_b64_tr_b16 v[168:169], v247 offset:20480
    ds_read_b64_tr_b16 v[170:171], v247 offset:22528
    v_fma_f32 v80, v80, s37, -v238
    v_fma_f32 v81, v81, s37, -v238
    v_fma_f32 v82, v82, s37, -v238
    v_fma_f32 v83, v83, s37, -v238
    s_waitcnt lgkmcnt(14)
    v_mfma_f32_16x16x16_bf16 v[216:219], v[172:173], v[232:233], 0
    v_mfma_f32_16x16x16_bf16 v[220:223], v[174:175], v[232:233], 0
    v_xor_b32 v246, 192, v249
    ds_read_b64_tr_b16 v[172:173], v246 offset:20480
    ds_read_b64_tr_b16 v[174:175], v246 offset:22528
    v_fma_f32 v84, v84, s37, -v238
    v_fma_f32 v85, v85, s37, -v238
    v_fma_f32 v86, v86, s37, -v238
    v_fma_f32 v87, v87, s37, -v238
    s_waitcnt lgkmcnt(14)
    v_mfma_f32_32x32x16_bf16 v[0:15], v[176:179], v[64:67], 0
    ds_read_b64_tr_b16 v[176:177], v249 offset:24576
    ds_read_b64_tr_b16 v[178:179], v249 offset:26624
    v_exp_f32 v80, v80
    v_exp_f32 v81, v81
    v_exp_f32 v82, v82
    v_exp_f32 v83, v83
    s_waitcnt lgkmcnt(14)
    v_mfma_f32_32x32x16_bf16 v[16:31], v[180:183], v[64:67], 0
    v_xor_b32 v247, 64, v249
    ds_read_b64_tr_b16 v[180:181], v247 offset:24576
    ds_read_b64_tr_b16 v[182:183], v247 offset:26624
    v_exp_f32 v84, v84
    v_exp_f32 v85, v85
    v_exp_f32 v86, v86
    v_exp_f32 v87, v87
    s_waitcnt lgkmcnt(14)
    v_mfma_f32_32x32x16_bf16 v[32:47], v[184:187], v[64:67], 0
    v_xor_b32 v246, 128, v249
    ds_read_b64_tr_b16 v[184:185], v246 offset:24576
    ds_read_b64_tr_b16 v[186:187], v246 offset:26624
    v_add_f32 v237, v237, v80
    v_add_f32 v241, v241, v81
    v_cvt_pk_bf16_f32 v80, v80, v81
    v_add_f32 v237, v237, v82
    s_waitcnt lgkmcnt(14)
    v_mfma_f32_32x32x16_bf16 v[48:63], v[188:191], v[64:67], 0
    v_xor_b32 v247, 192, v249
    ds_read_b64_tr_b16 v[188:189], v247 offset:24576
    ds_read_b64_tr_b16 v[190:191], v247 offset:26624
    v_add_f32 v241, v241, v83
    v_cvt_pk_bf16_f32 v81, v82, v83
    v_add_f32 v237, v237, v84
    v_add_f32 v241, v241, v85
    s_waitcnt lgkmcnt(14)
    v_mfma_f32_32x32x16_bf16 v[0:15], v[160:163], v[72:75], v[0:15]
    ds_read_b64_tr_b16 v[160:161], v249 offset:28672
    ds_read_b64_tr_b16 v[162:163], v249 offset:30720
    v_cvt_pk_bf16_f32 v82, v84, v85
    v_add_f32 v237, v237, v86
    v_add_f32 v241, v241, v87
    v_cvt_pk_bf16_f32 v83, v86, v87
    s_waitcnt lgkmcnt(14)
    v_mfma_f32_32x32x16_bf16 v[16:31], v[164:167], v[72:75], v[16:31]
    v_xor_b32 v246, 64, v249
    ds_read_b64_tr_b16 v[164:165], v246 offset:28672
    ds_read_b64_tr_b16 v[166:167], v246 offset:30720
    v_fma_f32 v88, v88, s37, -v238
    v_fma_f32 v89, v89, s37, -v238
    v_fma_f32 v90, v90, s37, -v238
    v_fma_f32 v91, v91, s37, -v238
    s_waitcnt lgkmcnt(14)
    v_mfma_f32_32x32x16_bf16 v[32:47], v[168:171], v[72:75], v[32:47]
    v_xor_b32 v247, 128, v249
    ds_read_b64_tr_b16 v[168:169], v247 offset:28672
    ds_read_b64_tr_b16 v[170:171], v247 offset:30720
    v_fma_f32 v92, v92, s37, -v238
    v_fma_f32 v93, v93, s37, -v238
    v_fma_f32 v94, v94, s37, -v238
    v_fma_f32 v95, v95, s37, -v238
    s_waitcnt lgkmcnt(14)
    v_mfma_f32_32x32x16_bf16 v[48:63], v[172:175], v[72:75], v[48:63]
    v_xor_b32 v246, 192, v249
    ds_read_b64_tr_b16 v[172:173], v246 offset:28672
    ds_read_b64_tr_b16 v[174:175], v246 offset:30720
    v_exp_f32 v88, v88
    v_exp_f32 v89, v89
    v_exp_f32 v90, v90
    v_exp_f32 v91, v91
    s_waitcnt lgkmcnt(14)
    v_mfma_f32_32x32x16_bf16 v[0:15], v[176:179], v[80:83], v[0:15]
    v_exp_f32 v92, v92
    v_exp_f32 v93, v93
    v_exp_f32 v94, v94
    v_exp_f32 v95, v95
    s_waitcnt lgkmcnt(12)
    v_mfma_f32_32x32x16_bf16 v[16:31], v[180:183], v[80:83], v[16:31]
    v_add_f32 v237, v237, v88
    v_add_f32 v241, v241, v89
    v_cvt_pk_bf16_f32 v88, v88, v89
    v_add_f32 v237, v237, v90
    s_waitcnt lgkmcnt(10)
    v_mfma_f32_32x32x16_bf16 v[32:47], v[184:187], v[80:83], v[32:47]
    s_waitcnt vmcnt(8) lgkmcnt(0)
    s_barrier
    s_add_u32 s40, s35, 32768
    s_add_u32 m0, s36, 32768
    s_nop 0
    buffer_load_dwordx4 v253, s[16:19], s40 offen offset:0 nt lds
    v_xor_b32 v245, 32, v253
    buffer_load_dwordx4 v245, s[16:19], s40 offen offset:1024 nt lds
    buffer_load_dwordx4 v253, s[16:19], s40 offen offset:2048 nt lds
    v_xor_b32 v245, 32, v253
    buffer_load_dwordx4 v245, s[16:19], s40 offen offset:3072 nt lds
    ds_read_b128 v[176:179], v250 offset:0
    v_add_u32 v247, s43, v250
    ds_read_b128 v[180:183], v247 offset:32768
    v_xor_b32 v246, 64, v250
    ds_read_b128 v[184:187], v246 offset:0
    v_add_f32 v241, v241, v91
    v_cvt_pk_bf16_f32 v89, v90, v91
    v_add_f32 v237, v237, v92
    v_add_f32 v241, v241, v93
    v_mfma_f32_32x32x16_bf16 v[48:63], v[188:191], v[80:83], v[48:63]
    v_add_u32 v247, s43, v246
    ds_read_b128 v[188:191], v247 offset:32768
    v_cvt_pk_bf16_f32 v90, v92, v93
    v_add_f32 v237, v237, v94
    v_add_f32 v241, v241, v95
    v_cvt_pk_bf16_f32 v91, v94, v95
    s_nop 1
    v_mfma_f32_32x32x16_bf16 v[0:15], v[160:163], v[88:91], v[0:15]
    v_xor_b32 v246, 128, v250
    ds_read_b128 v[160:163], v246 offset:0
    v_add_f32 v237, v237, v241
    v_mfma_f32_32x32x16_bf16 v[16:31], v[164:167], v[88:91], v[16:31]
    v_add_u32 v247, s43, v246
    ds_read_b128 v[164:167], v247 offset:32768
    v_mfma_f32_32x32x16_bf16 v[32:47], v[168:171], v[88:91], v[32:47]
    v_xor_b32 v246, 192, v250
    ds_read_b128 v[168:171], v246 offset:0
    v_mfma_f32_32x32x16_bf16 v[48:63], v[172:175], v[88:91], v[48:63]
    v_add_u32 v247, s43, v246
    ds_read_b128 v[172:175], v247 offset:32768
    s_waitcnt lgkmcnt(6)
    v_mfma_f32_16x16x32_bf16 v[224:227], v[180:183], v[176:179], 0
    v_xor_b32 v246, s44, v248
    ds_read_b128 v[176:179], v246 offset:32768
    ds_read_b128 v[180:183], v246 offset:40960
    v_max3_f32 v242, v228, v229, v230
    v_max_f32 v242, v242, v231
    v_mov_b32 v243, v242
    s_waitcnt lgkmcnt(6)
    v_mfma_f32_16x16x32_bf16 v[224:227], v[188:191], v[184:187], v[224:227]
    v_xor_b32 v247, s45, v248
    ds_read_b128 v[184:187], v247 offset:32768
    ds_read_b128 v[188:191], v247 offset:40960
    v_max3_f32 v240, v96, v97, v98
    v_max3_f32 v241, v99, v100, v101
    v_permlane32_swap_b32 v242, v243
    s_waitcnt lgkmcnt(6)
    v_mfma_f32_16x16x32_bf16 v[224:227], v[164:167], v[160:163], v[224:227]
    v_xor_b32 v246, s46, v248
    ds_read_b128 v[160:163], v246 offset:32768
    ds_read_b128 v[164:167], v246 offset:40960
    v_max3_f32 v240, v240, v102, v103
    v_max_f32 v242, v242, v243
    v_mov_b32 v243, v242
    s_waitcnt lgkmcnt(6)
    v_mfma_f32_16x16x32_bf16 v[224:227], v[172:175], v[168:171], v[224:227]
    v_xor_b32 v247, s47, v248
    ds_read_b128 v[168:171], v247 offset:32768
    ds_read_b128 v[172:175], v247 offset:40960
    v_max3_f32 v241, v241, v104, v105
    v_max3_f32 v240, v240, v106, v107
    v_max3_f32 v241, v241, v108, v109
    s_waitcnt lgkmcnt(7)
    v_mfma_f32_32x32x16_bf16 v[64:79], v[176:179], v[128:131], 0
    v_xor_b32 v246, s48, v248
    ds_read_b128 v[176:179], v246 offset:32768
    v_permlane16_swap_b32 v242, v243
    v_max3_f32 v240, v240, v110, v111
    v_max_f32 v242, v242, v243
    v_max3_f32 v241, v241, v112, v113
    v_sub_f32 v243, v242, v234
    s_waitcnt lgkmcnt(7)
    v_mfma_f32_32x32x16_bf16 v[80:95], v[180:183], v[128:131], 0
    ds_read_b128 v[180:183], v246 offset:40960
    v_max3_f32 v240, v240, v114, v115
    v_max3_f32 v241, v241, v116, v117
    v_max3_f32 v240, v240, v118, v119
    v_max3_f32 v241, v241, v120, v121
    v_max3_f32 v240, v240, v122, v123
    s_waitcnt lgkmcnt(7)
    v_mfma_f32_32x32x16_bf16 v[64:79], v[184:187], v[132:135], v[64:79]
    v_xor_b32 v247, s49, v248
    ds_read_b128 v[184:187], v247 offset:32768
    v_max3_f32 v241, v241, v124, v125
    v_max3_f32 v240, v240, v126, v127
    v_max_f32 v240, v240, v241
    v_mov_b32 v241, v240
    s_waitcnt lgkmcnt(7)
    v_mfma_f32_32x32x16_bf16 v[80:95], v[188:191], v[132:135], v[80:95]
    ds_read_b128 v[188:191], v247 offset:40960
    v_permlane32_swap_b32 v240, v241
    v_max_f32 v240, v240, v241
    v_sub_f32 v241, v240, v236
    v_max_f32 v241, v241, v243
    v_cmp_lt_f32 vcc, s38, v241
    s_waitcnt lgkmcnt(7)
    v_mfma_f32_32x32x16_bf16 v[64:79], v[160:163], v[136:139], v[64:79]
    v_xor_b32 v246, s50, v248
    ds_read_b128 v[160:163], v246 offset:32768
    s_nop 1
    s_cbranch_vccnz concat_heads__gqa_block_cached__gqa_block_cached__near_ridge_kernel_rs1
concat_heads__gqa_block_cached__gqa_block_cached__near_ridge_kernel_rb1:
    v_fma_f32 v228, v228, s37, -v239
    v_fma_f32 v229, v229, s37, -v239
    v_fma_f32 v230, v230, s37, -v239
    s_waitcnt lgkmcnt(7)
    v_mfma_f32_32x32x16_bf16 v[80:95], v[164:167], v[136:139], v[80:95]
    ds_read_b128 v[164:167], v246 offset:40960
    v_fma_f32 v231, v231, s37, -v239
    v_exp_f32 v228, v228
    v_exp_f32 v229, v229
    v_exp_f32 v230, v230
    v_exp_f32 v231, v231
    s_waitcnt lgkmcnt(7)
    v_mfma_f32_32x32x16_bf16 v[64:79], v[168:171], v[140:143], v[64:79]
    v_xor_b32 v247, s51, v248
    ds_read_b128 v[168:171], v247 offset:32768
    v_fma_f32 v96, v96, s37, -v238
    v_fma_f32 v97, v97, s37, -v238
    v_fma_f32 v98, v98, s37, -v238
    v_fma_f32 v99, v99, s37, -v238
    v_fma_f32 v100, v100, s37, -v238
    s_waitcnt lgkmcnt(7)
    v_mfma_f32_32x32x16_bf16 v[80:95], v[172:175], v[140:143], v[80:95]
    ds_read_b128 v[172:175], v247 offset:40960
    v_fma_f32 v101, v101, s37, -v238
    v_fma_f32 v102, v102, s37, -v238
    v_fma_f32 v103, v103, s37, -v238
    v_add_f32 v243, v228, v229
    v_add_f32 v242, v230, v231
    s_waitcnt lgkmcnt(7)
    v_mfma_f32_32x32x16_bf16 v[64:79], v[176:179], v[144:147], v[64:79]
    v_cvt_pk_bf16_f32 v232, v228, v229
    v_cvt_pk_bf16_f32 v233, v230, v231
    v_add_f32 v243, v243, v242
    v_add_f32 v235, v235, v243
    v_exp_f32 v96, v96
    s_waitcnt lgkmcnt(6)
    v_mfma_f32_32x32x16_bf16 v[80:95], v[180:183], v[144:147], v[80:95]
    v_exp_f32 v97, v97
    v_exp_f32 v98, v98
    v_exp_f32 v99, v99
    v_exp_f32 v100, v100
    v_exp_f32 v101, v101
    s_waitcnt lgkmcnt(5)
    v_mfma_f32_32x32x16_bf16 v[64:79], v[184:187], v[148:151], v[64:79]
    s_waitcnt vmcnt(8) lgkmcnt(0)
    s_barrier
    s_add_u32 s40, s35, 65536
    s_add_u32 m0, s36, 49152
    s_nop 0
    buffer_load_dwordx4 v252, s[12:15], s40 offen offset:0 nt lds
    v_xor_b32 v245, 64, v252
    buffer_load_dwordx4 v245, s[12:15], s40 offen offset:1024 nt lds
    v_xor_b32 v244, 128, v252
    buffer_load_dwordx4 v244, s[12:15], s40 offen offset:2048 nt lds
    v_xor_b32 v245, 192, v252
    buffer_load_dwordx4 v245, s[12:15], s40 offen offset:3072 nt lds
    ds_read_b64_tr_b16 v[176:177], v251 offset:49152
    v_xor_b32 v246, 32, v251
    ds_read_b64_tr_b16 v[178:179], v246 offset:49152
    v_xor_b32 v247, 64, v251
    ds_read_b64_tr_b16 v[180:181], v247 offset:49152
    v_xor_b32 v246, 96, v251
    ds_read_b64_tr_b16 v[182:183], v246 offset:49152
    v_xor_b32 v247, 128, v251
    ds_read_b64_tr_b16 v[184:185], v247 offset:49152
    v_xor_b32 v246, 160, v251
    ds_read_b64_tr_b16 v[186:187], v246 offset:49152
    v_exp_f32 v102, v102
    v_exp_f32 v103, v103
    v_add_f32 v237, v237, v96
    v_mov_b32 v241, v97
    v_cvt_pk_bf16_f32 v96, v96, v97
    v_mfma_f32_32x32x16_bf16 v[80:95], v[188:191], v[148:151], v[80:95]
    v_xor_b32 v247, 192, v251
    ds_read_b64_tr_b16 v[188:189], v247 offset:49152
    v_xor_b32 v246, 224, v251
    ds_read_b64_tr_b16 v[190:191], v246 offset:49152
    v_add_f32 v237, v237, v98
    v_add_f32 v241, v241, v99
    v_cvt_pk_bf16_f32 v97, v98, v99
    v_add_f32 v237, v237, v100
    v_add_f32 v241, v241, v101
    v_mfma_f32_32x32x16_bf16 v[64:79], v[160:163], v[152:155], v[64:79]
    ds_read_b64_tr_b16 v[160:161], v249 offset:49152
    ds_read_b64_tr_b16 v[162:163], v249 offset:51200
    v_cvt_pk_bf16_f32 v98, v100, v101
    v_add_f32 v237, v237, v102
    v_add_f32 v241, v241, v103
    v_cvt_pk_bf16_f32 v99, v102, v103
    v_fma_f32 v104, v104, s37, -v238
    v_mfma_f32_32x32x16_bf16 v[80:95], v[164:167], v[152:155], v[80:95]
    v_xor_b32 v247, 64, v249
    ds_read_b64_tr_b16 v[164:165], v247 offset:49152
    ds_read_b64_tr_b16 v[166:167], v247 offset:51200
    v_fma_f32 v105, v105, s37, -v238
    v_fma_f32 v106, v106, s37, -v238
    v_fma_f32 v107, v107, s37, -v238
    v_fma_f32 v108, v108, s37, -v238
    v_fma_f32 v109, v109, s37, -v238
    v_mfma_f32_32x32x16_bf16 v[64:79], v[168:171], v[156:159], v[64:79]
    v_xor_b32 v246, 128, v249
    ds_read_b64_tr_b16 v[168:169], v246 offset:49152
    ds_read_b64_tr_b16 v[170:171], v246 offset:51200
    v_fma_f32 v110, v110, s37, -v238
    v_fma_f32 v111, v111, s37, -v238
    v_exp_f32 v104, v104
    v_exp_f32 v105, v105
    v_exp_f32 v106, v106
    v_mfma_f32_32x32x16_bf16 v[80:95], v[172:175], v[156:159], v[80:95]
    v_xor_b32 v247, 192, v249
    ds_read_b64_tr_b16 v[172:173], v247 offset:49152
    ds_read_b64_tr_b16 v[174:175], v247 offset:51200
    v_exp_f32 v107, v107
    v_exp_f32 v108, v108
    v_exp_f32 v109, v109
    v_exp_f32 v110, v110
    v_exp_f32 v111, v111
    s_waitcnt lgkmcnt(14)
    v_mfma_f32_16x16x16_bf16 v[192:195], v[176:177], v[232:233], v[192:195]
    v_mfma_f32_16x16x16_bf16 v[196:199], v[178:179], v[232:233], v[196:199]
    ds_read_b64_tr_b16 v[176:177], v249 offset:53248
    ds_read_b64_tr_b16 v[178:179], v249 offset:55296
    v_add_f32 v237, v237, v104
    v_add_f32 v241, v241, v105
    v_cvt_pk_bf16_f32 v104, v104, v105
    v_add_f32 v237, v237, v106
    v_add_f32 v241, v241, v107
    s_waitcnt lgkmcnt(14)
    v_mfma_f32_16x16x16_bf16 v[200:203], v[180:181], v[232:233], v[200:203]
    v_mfma_f32_16x16x16_bf16 v[204:207], v[182:183], v[232:233], v[204:207]
    v_xor_b32 v246, 64, v249
    ds_read_b64_tr_b16 v[180:181], v246 offset:53248
    ds_read_b64_tr_b16 v[182:183], v246 offset:55296
    v_cvt_pk_bf16_f32 v105, v106, v107
    v_add_f32 v237, v237, v108
    v_add_f32 v241, v241, v109
    v_cvt_pk_bf16_f32 v106, v108, v109
    v_add_f32 v237, v237, v110
    s_waitcnt lgkmcnt(14)
    v_mfma_f32_16x16x16_bf16 v[208:211], v[184:185], v[232:233], v[208:211]
    v_mfma_f32_16x16x16_bf16 v[212:215], v[186:187], v[232:233], v[212:215]
    v_xor_b32 v247, 128, v249
    ds_read_b64_tr_b16 v[184:185], v247 offset:53248
    ds_read_b64_tr_b16 v[186:187], v247 offset:55296
    v_add_f32 v241, v241, v111
    v_cvt_pk_bf16_f32 v107, v110, v111
    v_fma_f32 v112, v112, s37, -v238
    v_fma_f32 v113, v113, s37, -v238
    v_fma_f32 v114, v114, s37, -v238
    s_waitcnt lgkmcnt(14)
    v_mfma_f32_16x16x16_bf16 v[216:219], v[188:189], v[232:233], v[216:219]
    v_mfma_f32_16x16x16_bf16 v[220:223], v[190:191], v[232:233], v[220:223]
    v_xor_b32 v246, 192, v249
    ds_read_b64_tr_b16 v[188:189], v246 offset:53248
    ds_read_b64_tr_b16 v[190:191], v246 offset:55296
    v_fma_f32 v115, v115, s37, -v238
    v_fma_f32 v116, v116, s37, -v238
    v_fma_f32 v117, v117, s37, -v238
    v_fma_f32 v118, v118, s37, -v238
    v_fma_f32 v119, v119, s37, -v238
    s_waitcnt lgkmcnt(14)
    v_mfma_f32_32x32x16_bf16 v[0:15], v[160:163], v[96:99], v[0:15]
    ds_read_b64_tr_b16 v[160:161], v249 offset:57344
    ds_read_b64_tr_b16 v[162:163], v249 offset:59392
    v_exp_f32 v112, v112
    v_exp_f32 v113, v113
    v_exp_f32 v114, v114
    v_exp_f32 v115, v115
    s_waitcnt lgkmcnt(14)
    v_mfma_f32_32x32x16_bf16 v[16:31], v[164:167], v[96:99], v[16:31]
    v_xor_b32 v247, 64, v249
    ds_read_b64_tr_b16 v[164:165], v247 offset:57344
    ds_read_b64_tr_b16 v[166:167], v247 offset:59392
    v_exp_f32 v116, v116
    v_exp_f32 v117, v117
    v_exp_f32 v118, v118
    v_exp_f32 v119, v119
    s_waitcnt lgkmcnt(14)
    v_mfma_f32_32x32x16_bf16 v[32:47], v[168:171], v[96:99], v[32:47]
    v_xor_b32 v246, 128, v249
    ds_read_b64_tr_b16 v[168:169], v246 offset:57344
    ds_read_b64_tr_b16 v[170:171], v246 offset:59392
    v_add_f32 v237, v237, v112
    v_add_f32 v241, v241, v113
    v_cvt_pk_bf16_f32 v112, v112, v113
    v_add_f32 v237, v237, v114
    s_waitcnt lgkmcnt(14)
    v_mfma_f32_32x32x16_bf16 v[48:63], v[172:175], v[96:99], v[48:63]
    v_xor_b32 v247, 192, v249
    ds_read_b64_tr_b16 v[172:173], v247 offset:57344
    ds_read_b64_tr_b16 v[174:175], v247 offset:59392
    v_add_f32 v241, v241, v115
    v_cvt_pk_bf16_f32 v113, v114, v115
    v_add_f32 v237, v237, v116
    v_add_f32 v241, v241, v117
    s_waitcnt lgkmcnt(14)
    v_mfma_f32_32x32x16_bf16 v[0:15], v[176:179], v[104:107], v[0:15]
    ds_read_b64_tr_b16 v[176:177], v249 offset:61440
    ds_read_b64_tr_b16 v[178:179], v249 offset:63488
    v_cvt_pk_bf16_f32 v114, v116, v117
    v_add_f32 v237, v237, v118
    v_add_f32 v241, v241, v119
    v_cvt_pk_bf16_f32 v115, v118, v119
    s_waitcnt lgkmcnt(14)
    v_mfma_f32_32x32x16_bf16 v[16:31], v[180:183], v[104:107], v[16:31]
    v_xor_b32 v246, 64, v249
    ds_read_b64_tr_b16 v[180:181], v246 offset:61440
    ds_read_b64_tr_b16 v[182:183], v246 offset:63488
    v_fma_f32 v120, v120, s37, -v238
    v_fma_f32 v121, v121, s37, -v238
    v_fma_f32 v122, v122, s37, -v238
    v_fma_f32 v123, v123, s37, -v238
    s_waitcnt lgkmcnt(14)
    v_mfma_f32_32x32x16_bf16 v[32:47], v[184:187], v[104:107], v[32:47]
    v_xor_b32 v247, 128, v249
    ds_read_b64_tr_b16 v[184:185], v247 offset:61440
    ds_read_b64_tr_b16 v[186:187], v247 offset:63488
    v_fma_f32 v124, v124, s37, -v238
    v_fma_f32 v125, v125, s37, -v238
    v_fma_f32 v126, v126, s37, -v238
    v_fma_f32 v127, v127, s37, -v238
    s_waitcnt lgkmcnt(14)
    v_mfma_f32_32x32x16_bf16 v[48:63], v[188:191], v[104:107], v[48:63]
    v_xor_b32 v246, 192, v249
    ds_read_b64_tr_b16 v[188:189], v246 offset:61440
    ds_read_b64_tr_b16 v[190:191], v246 offset:63488
    v_exp_f32 v120, v120
    v_exp_f32 v121, v121
    v_exp_f32 v122, v122
    v_exp_f32 v123, v123
    s_waitcnt lgkmcnt(14)
    v_mfma_f32_32x32x16_bf16 v[0:15], v[160:163], v[112:115], v[0:15]
    v_exp_f32 v124, v124
    v_exp_f32 v125, v125
    v_exp_f32 v126, v126
    v_exp_f32 v127, v127
    s_waitcnt lgkmcnt(12)
    v_mfma_f32_32x32x16_bf16 v[16:31], v[164:167], v[112:115], v[16:31]
    v_add_f32 v237, v237, v120
    v_add_f32 v241, v241, v121
    v_cvt_pk_bf16_f32 v120, v120, v121
    v_add_f32 v237, v237, v122
    s_waitcnt lgkmcnt(10)
    v_mfma_f32_32x32x16_bf16 v[32:47], v[168:171], v[112:115], v[32:47]
    s_waitcnt vmcnt(8) lgkmcnt(0)
    s_barrier
    s_add_u32 s40, s35, 49152
    s_add_u32 m0, s36, 65536
    s_nop 0
    buffer_load_dwordx4 v253, s[16:19], s40 offen offset:0 nt lds
    v_xor_b32 v245, 32, v253
    buffer_load_dwordx4 v245, s[16:19], s40 offen offset:1024 nt lds
    buffer_load_dwordx4 v253, s[16:19], s40 offen offset:2048 nt lds
    v_xor_b32 v245, 32, v253
    buffer_load_dwordx4 v245, s[16:19], s40 offen offset:3072 nt lds
    ds_read_b128 v[160:163], v250 offset:0
    v_add_u32 v247, s43, v250
    ds_read_b128 v[164:167], v247 offset:0
    v_xor_b32 v246, 64, v250
    ds_read_b128 v[168:171], v246 offset:0
    v_add_f32 v241, v241, v123
    v_cvt_pk_bf16_f32 v121, v122, v123
    v_add_f32 v237, v237, v124
    v_add_f32 v241, v241, v125
    v_mfma_f32_32x32x16_bf16 v[48:63], v[172:175], v[112:115], v[48:63]
    v_add_u32 v247, s43, v246
    ds_read_b128 v[172:175], v247 offset:0
    v_cvt_pk_bf16_f32 v122, v124, v125
    v_add_f32 v237, v237, v126
    v_add_f32 v241, v241, v127
    v_cvt_pk_bf16_f32 v123, v126, v127
    s_nop 1
    v_mfma_f32_32x32x16_bf16 v[0:15], v[176:179], v[120:123], v[0:15]
    v_xor_b32 v246, 128, v250
    ds_read_b128 v[176:179], v246 offset:0
    v_add_f32 v237, v237, v241
    v_mfma_f32_32x32x16_bf16 v[16:31], v[180:183], v[120:123], v[16:31]
    v_add_u32 v247, s43, v246
    ds_read_b128 v[180:183], v247 offset:0
    v_mfma_f32_32x32x16_bf16 v[32:47], v[184:187], v[120:123], v[32:47]
    v_xor_b32 v246, 192, v250
    ds_read_b128 v[184:187], v246 offset:0
    v_mfma_f32_32x32x16_bf16 v[48:63], v[188:191], v[120:123], v[48:63]
    v_add_u32 v247, s43, v246
    ds_read_b128 v[188:191], v247 offset:0
    s_waitcnt lgkmcnt(6)
    v_mfma_f32_16x16x32_bf16 v[228:231], v[164:167], v[160:163], 0
    v_xor_b32 v246, s44, v248
    ds_read_b128 v[160:163], v246 offset:0
    ds_read_b128 v[164:167], v246 offset:8192
    v_max3_f32 v242, v224, v225, v226
    v_max_f32 v242, v242, v227
    v_mov_b32 v243, v242
    s_waitcnt lgkmcnt(6)
    v_mfma_f32_16x16x32_bf16 v[228:231], v[172:175], v[168:171], v[228:231]
    v_xor_b32 v247, s45, v248
    ds_read_b128 v[168:171], v247 offset:0
    ds_read_b128 v[172:175], v247 offset:8192
    v_max3_f32 v240, v64, v65, v66
    v_max3_f32 v241, v67, v68, v69
    v_permlane32_swap_b32 v242, v243
    s_waitcnt lgkmcnt(6)
    v_mfma_f32_16x16x32_bf16 v[228:231], v[180:183], v[176:179], v[228:231]
    v_xor_b32 v246, s46, v248
    ds_read_b128 v[176:179], v246 offset:0
    ds_read_b128 v[180:183], v246 offset:8192
    v_max3_f32 v240, v240, v70, v71
    v_max_f32 v242, v242, v243
    v_mov_b32 v243, v242
    s_waitcnt lgkmcnt(6)
    v_mfma_f32_16x16x32_bf16 v[228:231], v[188:191], v[184:187], v[228:231]
    v_xor_b32 v247, s47, v248
    ds_read_b128 v[184:187], v247 offset:0
    ds_read_b128 v[188:191], v247 offset:8192
    v_max3_f32 v241, v241, v72, v73
    v_max3_f32 v240, v240, v74, v75
    v_max3_f32 v241, v241, v76, v77
    s_waitcnt lgkmcnt(7)
    v_mfma_f32_32x32x16_bf16 v[96:111], v[160:163], v[128:131], 0
    v_xor_b32 v246, s48, v248
    ds_read_b128 v[160:163], v246 offset:0
    v_permlane16_swap_b32 v242, v243
    v_max3_f32 v240, v240, v78, v79
    v_max_f32 v242, v242, v243
    v_max3_f32 v241, v241, v80, v81
    v_sub_f32 v243, v242, v234
    s_waitcnt lgkmcnt(7)
    v_mfma_f32_32x32x16_bf16 v[112:127], v[164:167], v[128:131], 0
    ds_read_b128 v[164:167], v246 offset:8192
    v_max3_f32 v240, v240, v82, v83
    v_max3_f32 v241, v241, v84, v85
    v_max3_f32 v240, v240, v86, v87
    v_max3_f32 v241, v241, v88, v89
    v_max3_f32 v240, v240, v90, v91
    s_waitcnt lgkmcnt(7)
    v_mfma_f32_32x32x16_bf16 v[96:111], v[168:171], v[132:135], v[96:111]
    v_xor_b32 v247, s49, v248
    ds_read_b128 v[168:171], v247 offset:0
    v_max3_f32 v241, v241, v92, v93
    v_max3_f32 v240, v240, v94, v95
    v_max_f32 v240, v240, v241
    v_mov_b32 v241, v240
    s_waitcnt lgkmcnt(7)
    v_mfma_f32_32x32x16_bf16 v[112:127], v[172:175], v[132:135], v[112:127]
    ds_read_b128 v[172:175], v247 offset:8192
    v_permlane32_swap_b32 v240, v241
    v_max_f32 v240, v240, v241
    v_sub_f32 v241, v240, v236
    v_max_f32 v241, v241, v243
    v_cmp_lt_f32 vcc, s38, v241
    s_waitcnt lgkmcnt(7)
    v_mfma_f32_32x32x16_bf16 v[96:111], v[176:179], v[136:139], v[96:111]
    v_xor_b32 v246, s50, v248
    ds_read_b128 v[176:179], v246 offset:0
    s_nop 1
    s_cbranch_vccnz concat_heads__gqa_block_cached__gqa_block_cached__near_ridge_kernel_rs2
concat_heads__gqa_block_cached__gqa_block_cached__near_ridge_kernel_rb2:
    v_fma_f32 v224, v224, s37, -v239
    v_fma_f32 v225, v225, s37, -v239
    v_fma_f32 v226, v226, s37, -v239
    s_waitcnt lgkmcnt(7)
    v_mfma_f32_32x32x16_bf16 v[112:127], v[180:183], v[136:139], v[112:127]
    ds_read_b128 v[180:183], v246 offset:8192
    v_fma_f32 v227, v227, s37, -v239
    v_exp_f32 v224, v224
    v_exp_f32 v225, v225
    v_exp_f32 v226, v226
    v_exp_f32 v227, v227
    s_waitcnt lgkmcnt(7)
    v_mfma_f32_32x32x16_bf16 v[96:111], v[184:187], v[140:143], v[96:111]
    v_xor_b32 v247, s51, v248
    ds_read_b128 v[184:187], v247 offset:0
    v_fma_f32 v64, v64, s37, -v238
    v_fma_f32 v65, v65, s37, -v238
    v_fma_f32 v66, v66, s37, -v238
    v_fma_f32 v67, v67, s37, -v238
    v_fma_f32 v68, v68, s37, -v238
    s_waitcnt lgkmcnt(7)
    v_mfma_f32_32x32x16_bf16 v[112:127], v[188:191], v[140:143], v[112:127]
    ds_read_b128 v[188:191], v247 offset:8192
    v_fma_f32 v69, v69, s37, -v238
    v_fma_f32 v70, v70, s37, -v238
    v_fma_f32 v71, v71, s37, -v238
    v_add_f32 v243, v224, v225
    v_add_f32 v242, v226, v227
    s_waitcnt lgkmcnt(7)
    v_mfma_f32_32x32x16_bf16 v[96:111], v[160:163], v[144:147], v[96:111]
    v_cvt_pk_bf16_f32 v232, v224, v225
    v_cvt_pk_bf16_f32 v233, v226, v227
    v_add_f32 v243, v243, v242
    v_add_f32 v235, v235, v243
    v_exp_f32 v64, v64
    s_waitcnt lgkmcnt(6)
    v_mfma_f32_32x32x16_bf16 v[112:127], v[164:167], v[144:147], v[112:127]
    v_exp_f32 v65, v65
    v_exp_f32 v66, v66
    v_exp_f32 v67, v67
    v_exp_f32 v68, v68
    v_exp_f32 v69, v69
    s_waitcnt lgkmcnt(5)
    v_mfma_f32_32x32x16_bf16 v[96:111], v[168:171], v[148:151], v[96:111]
    s_waitcnt vmcnt(8) lgkmcnt(0)
    s_barrier
    s_add_u32 s40, s35, 81920
    s_add_u32 m0, s36, 16384
    s_nop 0
    buffer_load_dwordx4 v252, s[12:15], s40 offen offset:0 nt lds
    v_xor_b32 v245, 64, v252
    buffer_load_dwordx4 v245, s[12:15], s40 offen offset:1024 nt lds
    v_xor_b32 v244, 128, v252
    buffer_load_dwordx4 v244, s[12:15], s40 offen offset:2048 nt lds
    v_xor_b32 v245, 192, v252
    buffer_load_dwordx4 v245, s[12:15], s40 offen offset:3072 nt lds
    ds_read_b64_tr_b16 v[160:161], v251 offset:16384
    v_xor_b32 v246, 32, v251
    ds_read_b64_tr_b16 v[162:163], v246 offset:16384
    v_xor_b32 v247, 64, v251
    ds_read_b64_tr_b16 v[164:165], v247 offset:16384
    v_xor_b32 v246, 96, v251
    ds_read_b64_tr_b16 v[166:167], v246 offset:16384
    v_xor_b32 v247, 128, v251
    ds_read_b64_tr_b16 v[168:169], v247 offset:16384
    v_xor_b32 v246, 160, v251
    ds_read_b64_tr_b16 v[170:171], v246 offset:16384
    v_exp_f32 v70, v70
    v_exp_f32 v71, v71
    v_add_f32 v237, v237, v64
    v_mov_b32 v241, v65
    v_cvt_pk_bf16_f32 v64, v64, v65
    v_mfma_f32_32x32x16_bf16 v[112:127], v[172:175], v[148:151], v[112:127]
    v_xor_b32 v247, 192, v251
    ds_read_b64_tr_b16 v[172:173], v247 offset:16384
    v_xor_b32 v246, 224, v251
    ds_read_b64_tr_b16 v[174:175], v246 offset:16384
    v_add_f32 v237, v237, v66
    v_add_f32 v241, v241, v67
    v_cvt_pk_bf16_f32 v65, v66, v67
    v_add_f32 v237, v237, v68
    v_add_f32 v241, v241, v69
    v_mfma_f32_32x32x16_bf16 v[96:111], v[176:179], v[152:155], v[96:111]
    ds_read_b64_tr_b16 v[176:177], v249 offset:16384
    ds_read_b64_tr_b16 v[178:179], v249 offset:18432
    v_cvt_pk_bf16_f32 v66, v68, v69
    v_add_f32 v237, v237, v70
    v_add_f32 v241, v241, v71
    v_cvt_pk_bf16_f32 v67, v70, v71
    v_fma_f32 v72, v72, s37, -v238
    v_mfma_f32_32x32x16_bf16 v[112:127], v[180:183], v[152:155], v[112:127]
    v_xor_b32 v247, 64, v249
    ds_read_b64_tr_b16 v[180:181], v247 offset:16384
    ds_read_b64_tr_b16 v[182:183], v247 offset:18432
    v_fma_f32 v73, v73, s37, -v238
    v_fma_f32 v74, v74, s37, -v238
    v_fma_f32 v75, v75, s37, -v238
    v_fma_f32 v76, v76, s37, -v238
    v_fma_f32 v77, v77, s37, -v238
    v_mfma_f32_32x32x16_bf16 v[96:111], v[184:187], v[156:159], v[96:111]
    v_xor_b32 v246, 128, v249
    ds_read_b64_tr_b16 v[184:185], v246 offset:16384
    ds_read_b64_tr_b16 v[186:187], v246 offset:18432
    v_fma_f32 v78, v78, s37, -v238
    v_fma_f32 v79, v79, s37, -v238
    v_exp_f32 v72, v72
    v_exp_f32 v73, v73
    v_exp_f32 v74, v74
    v_mfma_f32_32x32x16_bf16 v[112:127], v[188:191], v[156:159], v[112:127]
    v_xor_b32 v247, 192, v249
    ds_read_b64_tr_b16 v[188:189], v247 offset:16384
    ds_read_b64_tr_b16 v[190:191], v247 offset:18432
    v_exp_f32 v75, v75
    v_exp_f32 v76, v76
    v_exp_f32 v77, v77
    v_exp_f32 v78, v78
    v_exp_f32 v79, v79
    s_waitcnt lgkmcnt(14)
    v_mfma_f32_16x16x16_bf16 v[192:195], v[160:161], v[232:233], v[192:195]
    v_mfma_f32_16x16x16_bf16 v[196:199], v[162:163], v[232:233], v[196:199]
    ds_read_b64_tr_b16 v[160:161], v249 offset:20480
    ds_read_b64_tr_b16 v[162:163], v249 offset:22528
    v_add_f32 v237, v237, v72
    v_add_f32 v241, v241, v73
    v_cvt_pk_bf16_f32 v72, v72, v73
    v_add_f32 v237, v237, v74
    v_add_f32 v241, v241, v75
    s_waitcnt lgkmcnt(14)
    v_mfma_f32_16x16x16_bf16 v[200:203], v[164:165], v[232:233], v[200:203]
    v_mfma_f32_16x16x16_bf16 v[204:207], v[166:167], v[232:233], v[204:207]
    v_xor_b32 v246, 64, v249
    ds_read_b64_tr_b16 v[164:165], v246 offset:20480
    ds_read_b64_tr_b16 v[166:167], v246 offset:22528
    v_cvt_pk_bf16_f32 v73, v74, v75
    v_add_f32 v237, v237, v76
    v_add_f32 v241, v241, v77
    v_cvt_pk_bf16_f32 v74, v76, v77
    v_add_f32 v237, v237, v78
    s_waitcnt lgkmcnt(14)
    v_mfma_f32_16x16x16_bf16 v[208:211], v[168:169], v[232:233], v[208:211]
    v_mfma_f32_16x16x16_bf16 v[212:215], v[170:171], v[232:233], v[212:215]
    v_xor_b32 v247, 128, v249
    ds_read_b64_tr_b16 v[168:169], v247 offset:20480
    ds_read_b64_tr_b16 v[170:171], v247 offset:22528
    v_add_f32 v241, v241, v79
    v_cvt_pk_bf16_f32 v75, v78, v79
    v_fma_f32 v80, v80, s37, -v238
    v_fma_f32 v81, v81, s37, -v238
    v_fma_f32 v82, v82, s37, -v238
    s_waitcnt lgkmcnt(14)
    v_mfma_f32_16x16x16_bf16 v[216:219], v[172:173], v[232:233], v[216:219]
    v_mfma_f32_16x16x16_bf16 v[220:223], v[174:175], v[232:233], v[220:223]
    v_xor_b32 v246, 192, v249
    ds_read_b64_tr_b16 v[172:173], v246 offset:20480
    ds_read_b64_tr_b16 v[174:175], v246 offset:22528
    v_fma_f32 v83, v83, s37, -v238
    v_fma_f32 v84, v84, s37, -v238
    v_fma_f32 v85, v85, s37, -v238
    v_fma_f32 v86, v86, s37, -v238
    v_fma_f32 v87, v87, s37, -v238
    s_waitcnt lgkmcnt(14)
    v_mfma_f32_32x32x16_bf16 v[0:15], v[176:179], v[64:67], v[0:15]
    ds_read_b64_tr_b16 v[176:177], v249 offset:24576
    ds_read_b64_tr_b16 v[178:179], v249 offset:26624
    v_exp_f32 v80, v80
    v_exp_f32 v81, v81
    v_exp_f32 v82, v82
    v_exp_f32 v83, v83
    s_waitcnt lgkmcnt(14)
    v_mfma_f32_32x32x16_bf16 v[16:31], v[180:183], v[64:67], v[16:31]
    v_xor_b32 v247, 64, v249
    ds_read_b64_tr_b16 v[180:181], v247 offset:24576
    ds_read_b64_tr_b16 v[182:183], v247 offset:26624
    v_exp_f32 v84, v84
    v_exp_f32 v85, v85
    v_exp_f32 v86, v86
    v_exp_f32 v87, v87
    s_waitcnt lgkmcnt(14)
    v_mfma_f32_32x32x16_bf16 v[32:47], v[184:187], v[64:67], v[32:47]
    v_xor_b32 v246, 128, v249
    ds_read_b64_tr_b16 v[184:185], v246 offset:24576
    ds_read_b64_tr_b16 v[186:187], v246 offset:26624
    v_add_f32 v237, v237, v80
    v_add_f32 v241, v241, v81
    v_cvt_pk_bf16_f32 v80, v80, v81
    v_add_f32 v237, v237, v82
    s_waitcnt lgkmcnt(14)
    v_mfma_f32_32x32x16_bf16 v[48:63], v[188:191], v[64:67], v[48:63]
    v_xor_b32 v247, 192, v249
    ds_read_b64_tr_b16 v[188:189], v247 offset:24576
    ds_read_b64_tr_b16 v[190:191], v247 offset:26624
    v_add_f32 v241, v241, v83
    v_cvt_pk_bf16_f32 v81, v82, v83
    v_add_f32 v237, v237, v84
    v_add_f32 v241, v241, v85
    s_waitcnt lgkmcnt(14)
    v_mfma_f32_32x32x16_bf16 v[0:15], v[160:163], v[72:75], v[0:15]
    ds_read_b64_tr_b16 v[160:161], v249 offset:28672
    ds_read_b64_tr_b16 v[162:163], v249 offset:30720
    v_cvt_pk_bf16_f32 v82, v84, v85
    v_add_f32 v237, v237, v86
    v_add_f32 v241, v241, v87
    v_cvt_pk_bf16_f32 v83, v86, v87
    s_waitcnt lgkmcnt(14)
    v_mfma_f32_32x32x16_bf16 v[16:31], v[164:167], v[72:75], v[16:31]
    v_xor_b32 v246, 64, v249
    ds_read_b64_tr_b16 v[164:165], v246 offset:28672
    ds_read_b64_tr_b16 v[166:167], v246 offset:30720
    v_fma_f32 v88, v88, s37, -v238
    v_fma_f32 v89, v89, s37, -v238
    v_fma_f32 v90, v90, s37, -v238
    v_fma_f32 v91, v91, s37, -v238
    s_waitcnt lgkmcnt(14)
    v_mfma_f32_32x32x16_bf16 v[32:47], v[168:171], v[72:75], v[32:47]
    v_xor_b32 v247, 128, v249
    ds_read_b64_tr_b16 v[168:169], v247 offset:28672
    ds_read_b64_tr_b16 v[170:171], v247 offset:30720
    v_fma_f32 v92, v92, s37, -v238
    v_fma_f32 v93, v93, s37, -v238
    v_fma_f32 v94, v94, s37, -v238
    v_fma_f32 v95, v95, s37, -v238
    s_waitcnt lgkmcnt(14)
    v_mfma_f32_32x32x16_bf16 v[48:63], v[172:175], v[72:75], v[48:63]
    v_xor_b32 v246, 192, v249
    ds_read_b64_tr_b16 v[172:173], v246 offset:28672
    ds_read_b64_tr_b16 v[174:175], v246 offset:30720
    v_exp_f32 v88, v88
    v_exp_f32 v89, v89
    v_exp_f32 v90, v90
    v_exp_f32 v91, v91
    s_waitcnt lgkmcnt(14)
    v_mfma_f32_32x32x16_bf16 v[0:15], v[176:179], v[80:83], v[0:15]
    v_exp_f32 v92, v92
    v_exp_f32 v93, v93
    v_exp_f32 v94, v94
    v_exp_f32 v95, v95
    s_waitcnt lgkmcnt(12)
    v_mfma_f32_32x32x16_bf16 v[16:31], v[180:183], v[80:83], v[16:31]
    v_add_f32 v237, v237, v88
    v_add_f32 v241, v241, v89
    v_cvt_pk_bf16_f32 v88, v88, v89
    v_add_f32 v237, v237, v90
    s_waitcnt lgkmcnt(10)
    v_mfma_f32_32x32x16_bf16 v[32:47], v[184:187], v[80:83], v[32:47]
    s_waitcnt vmcnt(8) lgkmcnt(0)
    s_barrier
    s_add_u32 s40, s35, 65536
    s_add_u32 m0, s36, 32768
    s_nop 0
    buffer_load_dwordx4 v253, s[16:19], s40 offen offset:0 nt lds
    v_xor_b32 v245, 32, v253
    buffer_load_dwordx4 v245, s[16:19], s40 offen offset:1024 nt lds
    buffer_load_dwordx4 v253, s[16:19], s40 offen offset:2048 nt lds
    v_xor_b32 v245, 32, v253
    buffer_load_dwordx4 v245, s[16:19], s40 offen offset:3072 nt lds
    ds_read_b128 v[176:179], v250 offset:0
    v_add_u32 v247, s43, v250
    ds_read_b128 v[180:183], v247 offset:32768
    v_xor_b32 v246, 64, v250
    ds_read_b128 v[184:187], v246 offset:0
    v_add_f32 v241, v241, v91
    v_cvt_pk_bf16_f32 v89, v90, v91
    v_add_f32 v237, v237, v92
    v_add_f32 v241, v241, v93
    v_mfma_f32_32x32x16_bf16 v[48:63], v[188:191], v[80:83], v[48:63]
    v_add_u32 v247, s43, v246
    ds_read_b128 v[188:191], v247 offset:32768
    v_cvt_pk_bf16_f32 v90, v92, v93
    v_add_f32 v237, v237, v94
    v_add_f32 v241, v241, v95
    v_cvt_pk_bf16_f32 v91, v94, v95
    s_nop 1
    v_mfma_f32_32x32x16_bf16 v[0:15], v[160:163], v[88:91], v[0:15]
    v_xor_b32 v246, 128, v250
    ds_read_b128 v[160:163], v246 offset:0
    v_add_f32 v237, v237, v241
    v_mfma_f32_32x32x16_bf16 v[16:31], v[164:167], v[88:91], v[16:31]
    v_add_u32 v247, s43, v246
    ds_read_b128 v[164:167], v247 offset:32768
    v_mfma_f32_32x32x16_bf16 v[32:47], v[168:171], v[88:91], v[32:47]
    v_xor_b32 v246, 192, v250
    ds_read_b128 v[168:171], v246 offset:0
    v_mfma_f32_32x32x16_bf16 v[48:63], v[172:175], v[88:91], v[48:63]
    v_add_u32 v247, s43, v246
    ds_read_b128 v[172:175], v247 offset:32768
    s_waitcnt lgkmcnt(6)
    v_mfma_f32_16x16x32_bf16 v[224:227], v[180:183], v[176:179], 0
    v_xor_b32 v246, s44, v248
    ds_read_b128 v[176:179], v246 offset:32768
    ds_read_b128 v[180:183], v246 offset:40960
    v_max3_f32 v242, v228, v229, v230
    v_max_f32 v242, v242, v231
    v_mov_b32 v243, v242
    s_waitcnt lgkmcnt(6)
    v_mfma_f32_16x16x32_bf16 v[224:227], v[188:191], v[184:187], v[224:227]
    v_xor_b32 v247, s45, v248
    ds_read_b128 v[184:187], v247 offset:32768
    ds_read_b128 v[188:191], v247 offset:40960
    v_max3_f32 v240, v96, v97, v98
    v_max3_f32 v241, v99, v100, v101
    v_permlane32_swap_b32 v242, v243
    s_waitcnt lgkmcnt(6)
    v_mfma_f32_16x16x32_bf16 v[224:227], v[164:167], v[160:163], v[224:227]
    v_xor_b32 v246, s46, v248
    ds_read_b128 v[160:163], v246 offset:32768
    ds_read_b128 v[164:167], v246 offset:40960
    v_max3_f32 v240, v240, v102, v103
    v_max_f32 v242, v242, v243
    v_mov_b32 v243, v242
    s_waitcnt lgkmcnt(6)
    v_mfma_f32_16x16x32_bf16 v[224:227], v[172:175], v[168:171], v[224:227]
    v_xor_b32 v247, s47, v248
    ds_read_b128 v[168:171], v247 offset:32768
    ds_read_b128 v[172:175], v247 offset:40960
    v_max3_f32 v241, v241, v104, v105
    v_max3_f32 v240, v240, v106, v107
    v_max3_f32 v241, v241, v108, v109
    s_waitcnt lgkmcnt(7)
    v_mfma_f32_32x32x16_bf16 v[64:79], v[176:179], v[128:131], 0
    v_xor_b32 v246, s48, v248
    ds_read_b128 v[176:179], v246 offset:32768
    v_permlane16_swap_b32 v242, v243
    v_max3_f32 v240, v240, v110, v111
    v_max_f32 v242, v242, v243
    v_max3_f32 v241, v241, v112, v113
    v_sub_f32 v243, v242, v234
    s_waitcnt lgkmcnt(7)
    v_mfma_f32_32x32x16_bf16 v[80:95], v[180:183], v[128:131], 0
    ds_read_b128 v[180:183], v246 offset:40960
    v_max3_f32 v240, v240, v114, v115
    v_max3_f32 v241, v241, v116, v117
    v_max3_f32 v240, v240, v118, v119
    v_max3_f32 v241, v241, v120, v121
    v_max3_f32 v240, v240, v122, v123
    s_waitcnt lgkmcnt(7)
    v_mfma_f32_32x32x16_bf16 v[64:79], v[184:187], v[132:135], v[64:79]
    v_xor_b32 v247, s49, v248
    ds_read_b128 v[184:187], v247 offset:32768
    v_max3_f32 v241, v241, v124, v125
    v_max3_f32 v240, v240, v126, v127
    v_max_f32 v240, v240, v241
    v_mov_b32 v241, v240
    s_waitcnt lgkmcnt(7)
    v_mfma_f32_32x32x16_bf16 v[80:95], v[188:191], v[132:135], v[80:95]
    ds_read_b128 v[188:191], v247 offset:40960
    v_permlane32_swap_b32 v240, v241
    v_max_f32 v240, v240, v241
    v_sub_f32 v241, v240, v236
    v_max_f32 v241, v241, v243
    v_cmp_lt_f32 vcc, s38, v241
    s_waitcnt lgkmcnt(7)
    v_mfma_f32_32x32x16_bf16 v[64:79], v[160:163], v[136:139], v[64:79]
    v_xor_b32 v246, s50, v248
    ds_read_b128 v[160:163], v246 offset:32768
    s_nop 1
    s_cbranch_vccnz concat_heads__gqa_block_cached__gqa_block_cached__near_ridge_kernel_rs3
concat_heads__gqa_block_cached__gqa_block_cached__near_ridge_kernel_rb3:
    v_fma_f32 v228, v228, s37, -v239
    v_fma_f32 v229, v229, s37, -v239
    v_fma_f32 v230, v230, s37, -v239
    s_waitcnt lgkmcnt(7)
    v_mfma_f32_32x32x16_bf16 v[80:95], v[164:167], v[136:139], v[80:95]
    ds_read_b128 v[164:167], v246 offset:40960
    v_fma_f32 v231, v231, s37, -v239
    v_exp_f32 v228, v228
    v_exp_f32 v229, v229
    v_exp_f32 v230, v230
    v_exp_f32 v231, v231
    s_waitcnt lgkmcnt(7)
    v_mfma_f32_32x32x16_bf16 v[64:79], v[168:171], v[140:143], v[64:79]
    v_xor_b32 v247, s51, v248
    ds_read_b128 v[168:171], v247 offset:32768
    v_fma_f32 v96, v96, s37, -v238
    v_fma_f32 v97, v97, s37, -v238
    v_fma_f32 v98, v98, s37, -v238
    v_fma_f32 v99, v99, s37, -v238
    v_fma_f32 v100, v100, s37, -v238
    s_waitcnt lgkmcnt(7)
    v_mfma_f32_32x32x16_bf16 v[80:95], v[172:175], v[140:143], v[80:95]
    ds_read_b128 v[172:175], v247 offset:40960
    v_fma_f32 v101, v101, s37, -v238
    v_fma_f32 v102, v102, s37, -v238
    v_fma_f32 v103, v103, s37, -v238
    v_add_f32 v243, v228, v229
    v_add_f32 v242, v230, v231
    s_waitcnt lgkmcnt(7)
    v_mfma_f32_32x32x16_bf16 v[64:79], v[176:179], v[144:147], v[64:79]
    v_cvt_pk_bf16_f32 v232, v228, v229
    v_cvt_pk_bf16_f32 v233, v230, v231
    v_add_f32 v243, v243, v242
    v_add_f32 v235, v235, v243
    v_exp_f32 v96, v96
    s_waitcnt lgkmcnt(6)
    v_mfma_f32_32x32x16_bf16 v[80:95], v[180:183], v[144:147], v[80:95]
    v_exp_f32 v97, v97
    v_exp_f32 v98, v98
    v_exp_f32 v99, v99
    v_exp_f32 v100, v100
    v_exp_f32 v101, v101
    s_waitcnt lgkmcnt(5)
    v_mfma_f32_32x32x16_bf16 v[64:79], v[184:187], v[148:151], v[64:79]
    s_waitcnt vmcnt(8) lgkmcnt(0)
    s_barrier
    s_add_u32 s40, s35, 98304
    s_add_u32 m0, s36, 49152
    s_nop 0
    buffer_load_dwordx4 v252, s[12:15], s40 offen offset:0 nt lds
    v_xor_b32 v245, 64, v252
    buffer_load_dwordx4 v245, s[12:15], s40 offen offset:1024 nt lds
    v_xor_b32 v244, 128, v252
    buffer_load_dwordx4 v244, s[12:15], s40 offen offset:2048 nt lds
    v_xor_b32 v245, 192, v252
    buffer_load_dwordx4 v245, s[12:15], s40 offen offset:3072 nt lds
    ds_read_b64_tr_b16 v[176:177], v251 offset:49152
    v_xor_b32 v246, 32, v251
    ds_read_b64_tr_b16 v[178:179], v246 offset:49152
    v_xor_b32 v247, 64, v251
    ds_read_b64_tr_b16 v[180:181], v247 offset:49152
    v_xor_b32 v246, 96, v251
    ds_read_b64_tr_b16 v[182:183], v246 offset:49152
    v_xor_b32 v247, 128, v251
    ds_read_b64_tr_b16 v[184:185], v247 offset:49152
    v_xor_b32 v246, 160, v251
    ds_read_b64_tr_b16 v[186:187], v246 offset:49152
    v_exp_f32 v102, v102
    v_exp_f32 v103, v103
    v_add_f32 v237, v237, v96
    v_mov_b32 v241, v97
    v_cvt_pk_bf16_f32 v96, v96, v97
    v_mfma_f32_32x32x16_bf16 v[80:95], v[188:191], v[148:151], v[80:95]
    v_xor_b32 v247, 192, v251
    ds_read_b64_tr_b16 v[188:189], v247 offset:49152
    v_xor_b32 v246, 224, v251
    ds_read_b64_tr_b16 v[190:191], v246 offset:49152
    v_add_f32 v237, v237, v98
    v_add_f32 v241, v241, v99
    v_cvt_pk_bf16_f32 v97, v98, v99
    v_add_f32 v237, v237, v100
    v_add_f32 v241, v241, v101
    v_mfma_f32_32x32x16_bf16 v[64:79], v[160:163], v[152:155], v[64:79]
    ds_read_b64_tr_b16 v[160:161], v249 offset:49152
    ds_read_b64_tr_b16 v[162:163], v249 offset:51200
    v_cvt_pk_bf16_f32 v98, v100, v101
    v_add_f32 v237, v237, v102
    v_add_f32 v241, v241, v103
    v_cvt_pk_bf16_f32 v99, v102, v103
    v_fma_f32 v104, v104, s37, -v238
    v_mfma_f32_32x32x16_bf16 v[80:95], v[164:167], v[152:155], v[80:95]
    v_xor_b32 v247, 64, v249
    ds_read_b64_tr_b16 v[164:165], v247 offset:49152
    ds_read_b64_tr_b16 v[166:167], v247 offset:51200
    v_fma_f32 v105, v105, s37, -v238
    v_fma_f32 v106, v106, s37, -v238
    v_fma_f32 v107, v107, s37, -v238
    v_fma_f32 v108, v108, s37, -v238
    v_fma_f32 v109, v109, s37, -v238
    v_mfma_f32_32x32x16_bf16 v[64:79], v[168:171], v[156:159], v[64:79]
    v_xor_b32 v246, 128, v249
    ds_read_b64_tr_b16 v[168:169], v246 offset:49152
    ds_read_b64_tr_b16 v[170:171], v246 offset:51200
    v_fma_f32 v110, v110, s37, -v238
    v_fma_f32 v111, v111, s37, -v238
    v_exp_f32 v104, v104
    v_exp_f32 v105, v105
    v_exp_f32 v106, v106
    v_mfma_f32_32x32x16_bf16 v[80:95], v[172:175], v[156:159], v[80:95]
    v_xor_b32 v247, 192, v249
    ds_read_b64_tr_b16 v[172:173], v247 offset:49152
    ds_read_b64_tr_b16 v[174:175], v247 offset:51200
    v_exp_f32 v107, v107
    v_exp_f32 v108, v108
    v_exp_f32 v109, v109
    v_exp_f32 v110, v110
    v_exp_f32 v111, v111
    s_waitcnt lgkmcnt(14)
    v_mfma_f32_16x16x16_bf16 v[192:195], v[176:177], v[232:233], v[192:195]
    v_mfma_f32_16x16x16_bf16 v[196:199], v[178:179], v[232:233], v[196:199]
    ds_read_b64_tr_b16 v[176:177], v249 offset:53248
    ds_read_b64_tr_b16 v[178:179], v249 offset:55296
    v_add_f32 v237, v237, v104
    v_add_f32 v241, v241, v105
    v_cvt_pk_bf16_f32 v104, v104, v105
    v_add_f32 v237, v237, v106
    v_add_f32 v241, v241, v107
    s_waitcnt lgkmcnt(14)
    v_mfma_f32_16x16x16_bf16 v[200:203], v[180:181], v[232:233], v[200:203]
    v_mfma_f32_16x16x16_bf16 v[204:207], v[182:183], v[232:233], v[204:207]
    v_xor_b32 v246, 64, v249
    ds_read_b64_tr_b16 v[180:181], v246 offset:53248
    ds_read_b64_tr_b16 v[182:183], v246 offset:55296
    v_cvt_pk_bf16_f32 v105, v106, v107
    v_add_f32 v237, v237, v108
    v_add_f32 v241, v241, v109
    v_cvt_pk_bf16_f32 v106, v108, v109
    v_add_f32 v237, v237, v110
    s_waitcnt lgkmcnt(14)
    v_mfma_f32_16x16x16_bf16 v[208:211], v[184:185], v[232:233], v[208:211]
    v_mfma_f32_16x16x16_bf16 v[212:215], v[186:187], v[232:233], v[212:215]
    v_xor_b32 v247, 128, v249
    ds_read_b64_tr_b16 v[184:185], v247 offset:53248
    ds_read_b64_tr_b16 v[186:187], v247 offset:55296
    v_add_f32 v241, v241, v111
    v_cvt_pk_bf16_f32 v107, v110, v111
    v_fma_f32 v112, v112, s37, -v238
    v_fma_f32 v113, v113, s37, -v238
    v_fma_f32 v114, v114, s37, -v238
    s_waitcnt lgkmcnt(14)
    v_mfma_f32_16x16x16_bf16 v[216:219], v[188:189], v[232:233], v[216:219]
    v_mfma_f32_16x16x16_bf16 v[220:223], v[190:191], v[232:233], v[220:223]
    v_xor_b32 v246, 192, v249
    ds_read_b64_tr_b16 v[188:189], v246 offset:53248
    ds_read_b64_tr_b16 v[190:191], v246 offset:55296
    v_fma_f32 v115, v115, s37, -v238
    v_fma_f32 v116, v116, s37, -v238
    v_fma_f32 v117, v117, s37, -v238
    v_fma_f32 v118, v118, s37, -v238
    v_fma_f32 v119, v119, s37, -v238
    s_waitcnt lgkmcnt(14)
    v_mfma_f32_32x32x16_bf16 v[0:15], v[160:163], v[96:99], v[0:15]
    ds_read_b64_tr_b16 v[160:161], v249 offset:57344
    ds_read_b64_tr_b16 v[162:163], v249 offset:59392
    v_exp_f32 v112, v112
    v_exp_f32 v113, v113
    v_exp_f32 v114, v114
    v_exp_f32 v115, v115
    s_waitcnt lgkmcnt(14)
    v_mfma_f32_32x32x16_bf16 v[16:31], v[164:167], v[96:99], v[16:31]
    v_xor_b32 v247, 64, v249
    ds_read_b64_tr_b16 v[164:165], v247 offset:57344
    ds_read_b64_tr_b16 v[166:167], v247 offset:59392
    v_exp_f32 v116, v116
    v_exp_f32 v117, v117
    v_exp_f32 v118, v118
    v_exp_f32 v119, v119
    s_waitcnt lgkmcnt(14)
    v_mfma_f32_32x32x16_bf16 v[32:47], v[168:171], v[96:99], v[32:47]
    v_xor_b32 v246, 128, v249
    ds_read_b64_tr_b16 v[168:169], v246 offset:57344
    ds_read_b64_tr_b16 v[170:171], v246 offset:59392
    v_add_f32 v237, v237, v112
    v_add_f32 v241, v241, v113
    v_cvt_pk_bf16_f32 v112, v112, v113
    v_add_f32 v237, v237, v114
    s_waitcnt lgkmcnt(14)
    v_mfma_f32_32x32x16_bf16 v[48:63], v[172:175], v[96:99], v[48:63]
    v_xor_b32 v247, 192, v249
    ds_read_b64_tr_b16 v[172:173], v247 offset:57344
    ds_read_b64_tr_b16 v[174:175], v247 offset:59392
    v_add_f32 v241, v241, v115
    v_cvt_pk_bf16_f32 v113, v114, v115
    v_add_f32 v237, v237, v116
    v_add_f32 v241, v241, v117
    s_waitcnt lgkmcnt(14)
    v_mfma_f32_32x32x16_bf16 v[0:15], v[176:179], v[104:107], v[0:15]
    ds_read_b64_tr_b16 v[176:177], v249 offset:61440
    ds_read_b64_tr_b16 v[178:179], v249 offset:63488
    v_cvt_pk_bf16_f32 v114, v116, v117
    v_add_f32 v237, v237, v118
    v_add_f32 v241, v241, v119
    v_cvt_pk_bf16_f32 v115, v118, v119
    s_waitcnt lgkmcnt(14)
    v_mfma_f32_32x32x16_bf16 v[16:31], v[180:183], v[104:107], v[16:31]
    v_xor_b32 v246, 64, v249
    ds_read_b64_tr_b16 v[180:181], v246 offset:61440
    ds_read_b64_tr_b16 v[182:183], v246 offset:63488
    v_fma_f32 v120, v120, s37, -v238
    v_fma_f32 v121, v121, s37, -v238
    v_fma_f32 v122, v122, s37, -v238
    v_fma_f32 v123, v123, s37, -v238
    s_waitcnt lgkmcnt(14)
    v_mfma_f32_32x32x16_bf16 v[32:47], v[184:187], v[104:107], v[32:47]
    v_xor_b32 v247, 128, v249
    ds_read_b64_tr_b16 v[184:185], v247 offset:61440
    ds_read_b64_tr_b16 v[186:187], v247 offset:63488
    v_fma_f32 v124, v124, s37, -v238
    v_fma_f32 v125, v125, s37, -v238
    v_fma_f32 v126, v126, s37, -v238
    v_fma_f32 v127, v127, s37, -v238
    s_waitcnt lgkmcnt(14)
    v_mfma_f32_32x32x16_bf16 v[48:63], v[188:191], v[104:107], v[48:63]
    v_xor_b32 v246, 192, v249
    ds_read_b64_tr_b16 v[188:189], v246 offset:61440
    ds_read_b64_tr_b16 v[190:191], v246 offset:63488
    v_exp_f32 v120, v120
    v_exp_f32 v121, v121
    v_exp_f32 v122, v122
    v_exp_f32 v123, v123
    s_waitcnt lgkmcnt(14)
    v_mfma_f32_32x32x16_bf16 v[0:15], v[160:163], v[112:115], v[0:15]
    v_exp_f32 v124, v124
    v_exp_f32 v125, v125
    v_exp_f32 v126, v126
    v_exp_f32 v127, v127
    s_waitcnt lgkmcnt(12)
    v_mfma_f32_32x32x16_bf16 v[16:31], v[164:167], v[112:115], v[16:31]
    v_add_f32 v237, v237, v120
    v_add_f32 v241, v241, v121
    v_cvt_pk_bf16_f32 v120, v120, v121
    v_add_f32 v237, v237, v122
    s_waitcnt lgkmcnt(10)
    v_mfma_f32_32x32x16_bf16 v[32:47], v[168:171], v[112:115], v[32:47]
    s_waitcnt vmcnt(8) lgkmcnt(0)
    s_barrier
    s_add_u32 s40, s35, 81920
    s_add_u32 m0, s36, 65536
    s_nop 0
    buffer_load_dwordx4 v253, s[16:19], s40 offen offset:0 nt lds
    v_xor_b32 v245, 32, v253
    buffer_load_dwordx4 v245, s[16:19], s40 offen offset:1024 nt lds
    buffer_load_dwordx4 v253, s[16:19], s40 offen offset:2048 nt lds
    v_xor_b32 v245, 32, v253
    buffer_load_dwordx4 v245, s[16:19], s40 offen offset:3072 nt lds
    ds_read_b128 v[160:163], v250 offset:0
    v_add_u32 v247, s43, v250
    ds_read_b128 v[164:167], v247 offset:0
    v_xor_b32 v246, 64, v250
    ds_read_b128 v[168:171], v246 offset:0
    v_add_f32 v241, v241, v123
    v_cvt_pk_bf16_f32 v121, v122, v123
    v_add_f32 v237, v237, v124
    v_add_f32 v241, v241, v125
    v_mfma_f32_32x32x16_bf16 v[48:63], v[172:175], v[112:115], v[48:63]
    v_add_u32 v247, s43, v246
    ds_read_b128 v[172:175], v247 offset:0
    v_cvt_pk_bf16_f32 v122, v124, v125
    v_add_f32 v237, v237, v126
    v_add_f32 v241, v241, v127
    v_cvt_pk_bf16_f32 v123, v126, v127
    s_nop 1
    v_mfma_f32_32x32x16_bf16 v[0:15], v[176:179], v[120:123], v[0:15]
    v_xor_b32 v246, 128, v250
    ds_read_b128 v[176:179], v246 offset:0
    v_add_f32 v237, v237, v241
    v_mfma_f32_32x32x16_bf16 v[16:31], v[180:183], v[120:123], v[16:31]
    v_add_u32 v247, s43, v246
    ds_read_b128 v[180:183], v247 offset:0
    v_mfma_f32_32x32x16_bf16 v[32:47], v[184:187], v[120:123], v[32:47]
    v_xor_b32 v246, 192, v250
    ds_read_b128 v[184:187], v246 offset:0
    v_mfma_f32_32x32x16_bf16 v[48:63], v[188:191], v[120:123], v[48:63]
    v_add_u32 v247, s43, v246
    ds_read_b128 v[188:191], v247 offset:0
    s_waitcnt lgkmcnt(6)
    v_mfma_f32_16x16x32_bf16 v[228:231], v[164:167], v[160:163], 0
    v_xor_b32 v246, s44, v248
    ds_read_b128 v[160:163], v246 offset:0
    ds_read_b128 v[164:167], v246 offset:8192
    v_max3_f32 v242, v224, v225, v226
    v_max_f32 v242, v242, v227
    v_mov_b32 v243, v242
    s_waitcnt lgkmcnt(6)
    v_mfma_f32_16x16x32_bf16 v[228:231], v[172:175], v[168:171], v[228:231]
    v_xor_b32 v247, s45, v248
    ds_read_b128 v[168:171], v247 offset:0
    ds_read_b128 v[172:175], v247 offset:8192
    v_max3_f32 v240, v64, v65, v66
    v_max3_f32 v241, v67, v68, v69
    v_permlane32_swap_b32 v242, v243
    s_waitcnt lgkmcnt(6)
    v_mfma_f32_16x16x32_bf16 v[228:231], v[180:183], v[176:179], v[228:231]
    v_xor_b32 v246, s46, v248
    ds_read_b128 v[176:179], v246 offset:0
    ds_read_b128 v[180:183], v246 offset:8192
    v_max3_f32 v240, v240, v70, v71
    v_max_f32 v242, v242, v243
    v_mov_b32 v243, v242
    s_waitcnt lgkmcnt(6)
    v_mfma_f32_16x16x32_bf16 v[228:231], v[188:191], v[184:187], v[228:231]
    v_xor_b32 v247, s47, v248
    ds_read_b128 v[184:187], v247 offset:0
    ds_read_b128 v[188:191], v247 offset:8192
    v_max3_f32 v241, v241, v72, v73
    v_max3_f32 v240, v240, v74, v75
    v_max3_f32 v241, v241, v76, v77
    s_waitcnt lgkmcnt(7)
    v_mfma_f32_32x32x16_bf16 v[96:111], v[160:163], v[128:131], 0
    v_xor_b32 v246, s48, v248
    ds_read_b128 v[160:163], v246 offset:0
    v_permlane16_swap_b32 v242, v243
    v_max3_f32 v240, v240, v78, v79
    v_max_f32 v242, v242, v243
    v_max3_f32 v241, v241, v80, v81
    v_sub_f32 v243, v242, v234
    s_waitcnt lgkmcnt(7)
    v_mfma_f32_32x32x16_bf16 v[112:127], v[164:167], v[128:131], 0
    ds_read_b128 v[164:167], v246 offset:8192
    v_max3_f32 v240, v240, v82, v83
    v_max3_f32 v241, v241, v84, v85
    v_max3_f32 v240, v240, v86, v87
    v_max3_f32 v241, v241, v88, v89
    v_max3_f32 v240, v240, v90, v91
    s_waitcnt lgkmcnt(7)
    v_mfma_f32_32x32x16_bf16 v[96:111], v[168:171], v[132:135], v[96:111]
    v_xor_b32 v247, s49, v248
    ds_read_b128 v[168:171], v247 offset:0
    v_max3_f32 v241, v241, v92, v93
    v_max3_f32 v240, v240, v94, v95
    v_max_f32 v240, v240, v241
    v_mov_b32 v241, v240
    s_waitcnt lgkmcnt(7)
    v_mfma_f32_32x32x16_bf16 v[112:127], v[172:175], v[132:135], v[112:127]
    ds_read_b128 v[172:175], v247 offset:8192
    v_permlane32_swap_b32 v240, v241
    v_max_f32 v240, v240, v241
    v_sub_f32 v241, v240, v236
    v_max_f32 v241, v241, v243
    v_cmp_lt_f32 vcc, s38, v241
    s_waitcnt lgkmcnt(7)
    v_mfma_f32_32x32x16_bf16 v[96:111], v[176:179], v[136:139], v[96:111]
    v_xor_b32 v246, s50, v248
    ds_read_b128 v[176:179], v246 offset:0
    s_nop 1
    s_cbranch_vccnz concat_heads__gqa_block_cached__gqa_block_cached__near_ridge_kernel_rs4
concat_heads__gqa_block_cached__gqa_block_cached__near_ridge_kernel_rb4:
    v_fma_f32 v224, v224, s37, -v239
    v_fma_f32 v225, v225, s37, -v239
    v_fma_f32 v226, v226, s37, -v239
    s_waitcnt lgkmcnt(7)
    v_mfma_f32_32x32x16_bf16 v[112:127], v[180:183], v[136:139], v[112:127]
    ds_read_b128 v[180:183], v246 offset:8192
    v_fma_f32 v227, v227, s37, -v239
    v_exp_f32 v224, v224
    v_exp_f32 v225, v225
    v_exp_f32 v226, v226
    v_exp_f32 v227, v227
    s_waitcnt lgkmcnt(7)
    v_mfma_f32_32x32x16_bf16 v[96:111], v[184:187], v[140:143], v[96:111]
    v_xor_b32 v247, s51, v248
    ds_read_b128 v[184:187], v247 offset:0
    v_fma_f32 v64, v64, s37, -v238
    v_fma_f32 v65, v65, s37, -v238
    v_fma_f32 v66, v66, s37, -v238
    v_fma_f32 v67, v67, s37, -v238
    v_fma_f32 v68, v68, s37, -v238
    s_waitcnt lgkmcnt(7)
    v_mfma_f32_32x32x16_bf16 v[112:127], v[188:191], v[140:143], v[112:127]
    ds_read_b128 v[188:191], v247 offset:8192
    v_fma_f32 v69, v69, s37, -v238
    v_fma_f32 v70, v70, s37, -v238
    v_fma_f32 v71, v71, s37, -v238
    v_add_f32 v243, v224, v225
    v_add_f32 v242, v226, v227
    s_waitcnt lgkmcnt(7)
    v_mfma_f32_32x32x16_bf16 v[96:111], v[160:163], v[144:147], v[96:111]
    v_cvt_pk_bf16_f32 v232, v224, v225
    v_cvt_pk_bf16_f32 v233, v226, v227
    v_add_f32 v243, v243, v242
    v_add_f32 v235, v235, v243
    v_exp_f32 v64, v64
    s_waitcnt lgkmcnt(6)
    v_mfma_f32_32x32x16_bf16 v[112:127], v[164:167], v[144:147], v[112:127]
    v_exp_f32 v65, v65
    v_exp_f32 v66, v66
    v_exp_f32 v67, v67
    v_exp_f32 v68, v68
    v_exp_f32 v69, v69
    s_waitcnt lgkmcnt(5)
    v_mfma_f32_32x32x16_bf16 v[96:111], v[168:171], v[148:151], v[96:111]
    s_waitcnt vmcnt(8) lgkmcnt(0)
    s_barrier
    s_add_u32 s40, s35, 114688
    s_add_u32 m0, s36, 16384
    s_nop 0
    buffer_load_dwordx4 v252, s[12:15], s40 offen offset:0 nt lds
    v_xor_b32 v245, 64, v252
    buffer_load_dwordx4 v245, s[12:15], s40 offen offset:1024 nt lds
    v_xor_b32 v244, 128, v252
    buffer_load_dwordx4 v244, s[12:15], s40 offen offset:2048 nt lds
    v_xor_b32 v245, 192, v252
    buffer_load_dwordx4 v245, s[12:15], s40 offen offset:3072 nt lds
    ds_read_b64_tr_b16 v[160:161], v251 offset:16384
    v_xor_b32 v246, 32, v251
    ds_read_b64_tr_b16 v[162:163], v246 offset:16384
    v_xor_b32 v247, 64, v251
    ds_read_b64_tr_b16 v[164:165], v247 offset:16384
    v_xor_b32 v246, 96, v251
    ds_read_b64_tr_b16 v[166:167], v246 offset:16384
    v_xor_b32 v247, 128, v251
    ds_read_b64_tr_b16 v[168:169], v247 offset:16384
    v_xor_b32 v246, 160, v251
    ds_read_b64_tr_b16 v[170:171], v246 offset:16384
    v_exp_f32 v70, v70
    v_exp_f32 v71, v71
    v_add_f32 v237, v237, v64
    v_mov_b32 v241, v65
    v_cvt_pk_bf16_f32 v64, v64, v65
    v_mfma_f32_32x32x16_bf16 v[112:127], v[172:175], v[148:151], v[112:127]
    v_xor_b32 v247, 192, v251
    ds_read_b64_tr_b16 v[172:173], v247 offset:16384
    v_xor_b32 v246, 224, v251
    ds_read_b64_tr_b16 v[174:175], v246 offset:16384
    v_add_f32 v237, v237, v66
    v_add_f32 v241, v241, v67
    v_cvt_pk_bf16_f32 v65, v66, v67
    v_add_f32 v237, v237, v68
    v_add_f32 v241, v241, v69
    v_mfma_f32_32x32x16_bf16 v[96:111], v[176:179], v[152:155], v[96:111]
    ds_read_b64_tr_b16 v[176:177], v249 offset:16384
    ds_read_b64_tr_b16 v[178:179], v249 offset:18432
    v_cvt_pk_bf16_f32 v66, v68, v69
    v_add_f32 v237, v237, v70
    v_add_f32 v241, v241, v71
    v_cvt_pk_bf16_f32 v67, v70, v71
    v_fma_f32 v72, v72, s37, -v238
    v_mfma_f32_32x32x16_bf16 v[112:127], v[180:183], v[152:155], v[112:127]
    v_xor_b32 v247, 64, v249
    ds_read_b64_tr_b16 v[180:181], v247 offset:16384
    ds_read_b64_tr_b16 v[182:183], v247 offset:18432
    v_fma_f32 v73, v73, s37, -v238
    v_fma_f32 v74, v74, s37, -v238
    v_fma_f32 v75, v75, s37, -v238
    v_fma_f32 v76, v76, s37, -v238
    v_fma_f32 v77, v77, s37, -v238
    v_mfma_f32_32x32x16_bf16 v[96:111], v[184:187], v[156:159], v[96:111]
    v_xor_b32 v246, 128, v249
    ds_read_b64_tr_b16 v[184:185], v246 offset:16384
    ds_read_b64_tr_b16 v[186:187], v246 offset:18432
    v_fma_f32 v78, v78, s37, -v238
    v_fma_f32 v79, v79, s37, -v238
    v_exp_f32 v72, v72
    v_exp_f32 v73, v73
    v_exp_f32 v74, v74
    v_mfma_f32_32x32x16_bf16 v[112:127], v[188:191], v[156:159], v[112:127]
    v_xor_b32 v247, 192, v249
    ds_read_b64_tr_b16 v[188:189], v247 offset:16384
    ds_read_b64_tr_b16 v[190:191], v247 offset:18432
    v_exp_f32 v75, v75
    v_exp_f32 v76, v76
    v_exp_f32 v77, v77
    v_exp_f32 v78, v78
    v_exp_f32 v79, v79
    s_waitcnt lgkmcnt(14)
    v_mfma_f32_16x16x16_bf16 v[192:195], v[160:161], v[232:233], v[192:195]
    v_mfma_f32_16x16x16_bf16 v[196:199], v[162:163], v[232:233], v[196:199]
    ds_read_b64_tr_b16 v[160:161], v249 offset:20480
    ds_read_b64_tr_b16 v[162:163], v249 offset:22528
    v_add_f32 v237, v237, v72
    v_add_f32 v241, v241, v73
    v_cvt_pk_bf16_f32 v72, v72, v73
    v_add_f32 v237, v237, v74
    v_add_f32 v241, v241, v75
    s_waitcnt lgkmcnt(14)
    v_mfma_f32_16x16x16_bf16 v[200:203], v[164:165], v[232:233], v[200:203]
    v_mfma_f32_16x16x16_bf16 v[204:207], v[166:167], v[232:233], v[204:207]
    v_xor_b32 v246, 64, v249
    ds_read_b64_tr_b16 v[164:165], v246 offset:20480
    ds_read_b64_tr_b16 v[166:167], v246 offset:22528
    v_cvt_pk_bf16_f32 v73, v74, v75
    v_add_f32 v237, v237, v76
    v_add_f32 v241, v241, v77
    v_cvt_pk_bf16_f32 v74, v76, v77
    v_add_f32 v237, v237, v78
    s_waitcnt lgkmcnt(14)
    v_mfma_f32_16x16x16_bf16 v[208:211], v[168:169], v[232:233], v[208:211]
    v_mfma_f32_16x16x16_bf16 v[212:215], v[170:171], v[232:233], v[212:215]
    v_xor_b32 v247, 128, v249
    ds_read_b64_tr_b16 v[168:169], v247 offset:20480
    ds_read_b64_tr_b16 v[170:171], v247 offset:22528
    v_add_f32 v241, v241, v79
    v_cvt_pk_bf16_f32 v75, v78, v79
    v_fma_f32 v80, v80, s37, -v238
    v_fma_f32 v81, v81, s37, -v238
    v_fma_f32 v82, v82, s37, -v238
    s_waitcnt lgkmcnt(14)
    v_mfma_f32_16x16x16_bf16 v[216:219], v[172:173], v[232:233], v[216:219]
    v_mfma_f32_16x16x16_bf16 v[220:223], v[174:175], v[232:233], v[220:223]
    v_xor_b32 v246, 192, v249
    ds_read_b64_tr_b16 v[172:173], v246 offset:20480
    ds_read_b64_tr_b16 v[174:175], v246 offset:22528
    v_fma_f32 v83, v83, s37, -v238
    v_fma_f32 v84, v84, s37, -v238
    v_fma_f32 v85, v85, s37, -v238
    v_fma_f32 v86, v86, s37, -v238
    v_fma_f32 v87, v87, s37, -v238
    s_waitcnt lgkmcnt(14)
    v_mfma_f32_32x32x16_bf16 v[0:15], v[176:179], v[64:67], v[0:15]
    ds_read_b64_tr_b16 v[176:177], v249 offset:24576
    ds_read_b64_tr_b16 v[178:179], v249 offset:26624
    v_exp_f32 v80, v80
    v_exp_f32 v81, v81
    v_exp_f32 v82, v82
    v_exp_f32 v83, v83
    s_waitcnt lgkmcnt(14)
    v_mfma_f32_32x32x16_bf16 v[16:31], v[180:183], v[64:67], v[16:31]
    v_xor_b32 v247, 64, v249
    ds_read_b64_tr_b16 v[180:181], v247 offset:24576
    ds_read_b64_tr_b16 v[182:183], v247 offset:26624
    v_exp_f32 v84, v84
    v_exp_f32 v85, v85
    v_exp_f32 v86, v86
    v_exp_f32 v87, v87
    s_waitcnt lgkmcnt(14)
    v_mfma_f32_32x32x16_bf16 v[32:47], v[184:187], v[64:67], v[32:47]
    v_xor_b32 v246, 128, v249
    ds_read_b64_tr_b16 v[184:185], v246 offset:24576
    ds_read_b64_tr_b16 v[186:187], v246 offset:26624
    v_add_f32 v237, v237, v80
    v_add_f32 v241, v241, v81
    v_cvt_pk_bf16_f32 v80, v80, v81
    v_add_f32 v237, v237, v82
    s_waitcnt lgkmcnt(14)
    v_mfma_f32_32x32x16_bf16 v[48:63], v[188:191], v[64:67], v[48:63]
    v_xor_b32 v247, 192, v249
    ds_read_b64_tr_b16 v[188:189], v247 offset:24576
    ds_read_b64_tr_b16 v[190:191], v247 offset:26624
    v_add_f32 v241, v241, v83
    v_cvt_pk_bf16_f32 v81, v82, v83
    v_add_f32 v237, v237, v84
    v_add_f32 v241, v241, v85
    s_waitcnt lgkmcnt(14)
    v_mfma_f32_32x32x16_bf16 v[0:15], v[160:163], v[72:75], v[0:15]
    ds_read_b64_tr_b16 v[160:161], v249 offset:28672
    ds_read_b64_tr_b16 v[162:163], v249 offset:30720
    v_cvt_pk_bf16_f32 v82, v84, v85
    v_add_f32 v237, v237, v86
    v_add_f32 v241, v241, v87
    v_cvt_pk_bf16_f32 v83, v86, v87
    s_waitcnt lgkmcnt(14)
    v_mfma_f32_32x32x16_bf16 v[16:31], v[164:167], v[72:75], v[16:31]
    v_xor_b32 v246, 64, v249
    ds_read_b64_tr_b16 v[164:165], v246 offset:28672
    ds_read_b64_tr_b16 v[166:167], v246 offset:30720
    v_fma_f32 v88, v88, s37, -v238
    v_fma_f32 v89, v89, s37, -v238
    v_fma_f32 v90, v90, s37, -v238
    v_fma_f32 v91, v91, s37, -v238
    s_waitcnt lgkmcnt(14)
    v_mfma_f32_32x32x16_bf16 v[32:47], v[168:171], v[72:75], v[32:47]
    v_xor_b32 v247, 128, v249
    ds_read_b64_tr_b16 v[168:169], v247 offset:28672
    ds_read_b64_tr_b16 v[170:171], v247 offset:30720
    v_fma_f32 v92, v92, s37, -v238
    v_fma_f32 v93, v93, s37, -v238
    v_fma_f32 v94, v94, s37, -v238
    v_fma_f32 v95, v95, s37, -v238
    s_waitcnt lgkmcnt(14)
    v_mfma_f32_32x32x16_bf16 v[48:63], v[172:175], v[72:75], v[48:63]
    v_xor_b32 v246, 192, v249
    ds_read_b64_tr_b16 v[172:173], v246 offset:28672
    ds_read_b64_tr_b16 v[174:175], v246 offset:30720
    v_exp_f32 v88, v88
    v_exp_f32 v89, v89
    v_exp_f32 v90, v90
    v_exp_f32 v91, v91
    s_waitcnt lgkmcnt(14)
    v_mfma_f32_32x32x16_bf16 v[0:15], v[176:179], v[80:83], v[0:15]
    v_exp_f32 v92, v92
    v_exp_f32 v93, v93
    v_exp_f32 v94, v94
    v_exp_f32 v95, v95
    s_waitcnt lgkmcnt(12)
    v_mfma_f32_32x32x16_bf16 v[16:31], v[180:183], v[80:83], v[16:31]
    v_add_f32 v237, v237, v88
    v_add_f32 v241, v241, v89
    v_cvt_pk_bf16_f32 v88, v88, v89
    v_add_f32 v237, v237, v90
    s_waitcnt lgkmcnt(10)
    v_mfma_f32_32x32x16_bf16 v[32:47], v[184:187], v[80:83], v[32:47]
    s_waitcnt vmcnt(8) lgkmcnt(0)
    s_barrier
    s_add_u32 s40, s35, 98304
    s_add_u32 m0, s36, 32768
    s_nop 0
    buffer_load_dwordx4 v253, s[16:19], s40 offen offset:0 nt lds
    v_xor_b32 v245, 32, v253
    buffer_load_dwordx4 v245, s[16:19], s40 offen offset:1024 nt lds
    buffer_load_dwordx4 v253, s[16:19], s40 offen offset:2048 nt lds
    v_xor_b32 v245, 32, v253
    buffer_load_dwordx4 v245, s[16:19], s40 offen offset:3072 nt lds
    ds_read_b128 v[176:179], v250 offset:0
    v_add_u32 v247, s43, v250
    ds_read_b128 v[180:183], v247 offset:32768
    v_xor_b32 v246, 64, v250
    ds_read_b128 v[184:187], v246 offset:0
    v_add_f32 v241, v241, v91
    v_cvt_pk_bf16_f32 v89, v90, v91
    v_add_f32 v237, v237, v92
    v_add_f32 v241, v241, v93
    v_mfma_f32_32x32x16_bf16 v[48:63], v[188:191], v[80:83], v[48:63]
    v_add_u32 v247, s43, v246
    ds_read_b128 v[188:191], v247 offset:32768
    v_cvt_pk_bf16_f32 v90, v92, v93
    v_add_f32 v237, v237, v94
    v_add_f32 v241, v241, v95
    v_cvt_pk_bf16_f32 v91, v94, v95
    s_nop 1
    v_mfma_f32_32x32x16_bf16 v[0:15], v[160:163], v[88:91], v[0:15]
    v_xor_b32 v246, 128, v250
    ds_read_b128 v[160:163], v246 offset:0
    v_add_f32 v237, v237, v241
    v_mfma_f32_32x32x16_bf16 v[16:31], v[164:167], v[88:91], v[16:31]
    v_add_u32 v247, s43, v246
    ds_read_b128 v[164:167], v247 offset:32768
    v_mfma_f32_32x32x16_bf16 v[32:47], v[168:171], v[88:91], v[32:47]
    v_xor_b32 v246, 192, v250
    ds_read_b128 v[168:171], v246 offset:0
    v_mfma_f32_32x32x16_bf16 v[48:63], v[172:175], v[88:91], v[48:63]
    v_add_u32 v247, s43, v246
    ds_read_b128 v[172:175], v247 offset:32768
    s_waitcnt lgkmcnt(6)
    v_mfma_f32_16x16x32_bf16 v[224:227], v[180:183], v[176:179], 0
    v_xor_b32 v246, s44, v248
    ds_read_b128 v[176:179], v246 offset:32768
    ds_read_b128 v[180:183], v246 offset:40960
    v_max3_f32 v242, v228, v229, v230
    v_max_f32 v242, v242, v231
    v_mov_b32 v243, v242
    s_waitcnt lgkmcnt(6)
    v_mfma_f32_16x16x32_bf16 v[224:227], v[188:191], v[184:187], v[224:227]
    v_xor_b32 v247, s45, v248
    ds_read_b128 v[184:187], v247 offset:32768
    ds_read_b128 v[188:191], v247 offset:40960
    v_max3_f32 v240, v96, v97, v98
    v_max3_f32 v241, v99, v100, v101
    v_permlane32_swap_b32 v242, v243
    s_waitcnt lgkmcnt(6)
    v_mfma_f32_16x16x32_bf16 v[224:227], v[164:167], v[160:163], v[224:227]
    v_xor_b32 v246, s46, v248
    ds_read_b128 v[160:163], v246 offset:32768
    ds_read_b128 v[164:167], v246 offset:40960
    v_max3_f32 v240, v240, v102, v103
    v_max_f32 v242, v242, v243
    v_mov_b32 v243, v242
    s_waitcnt lgkmcnt(6)
    v_mfma_f32_16x16x32_bf16 v[224:227], v[172:175], v[168:171], v[224:227]
    v_xor_b32 v247, s47, v248
    ds_read_b128 v[168:171], v247 offset:32768
    ds_read_b128 v[172:175], v247 offset:40960
    v_max3_f32 v241, v241, v104, v105
    v_max3_f32 v240, v240, v106, v107
    v_max3_f32 v241, v241, v108, v109
    s_waitcnt lgkmcnt(7)
    v_mfma_f32_32x32x16_bf16 v[64:79], v[176:179], v[128:131], 0
    v_xor_b32 v246, s48, v248
    ds_read_b128 v[176:179], v246 offset:32768
    v_permlane16_swap_b32 v242, v243
    v_max3_f32 v240, v240, v110, v111
    v_max_f32 v242, v242, v243
    v_max3_f32 v241, v241, v112, v113
    v_sub_f32 v243, v242, v234
    s_waitcnt lgkmcnt(7)
    v_mfma_f32_32x32x16_bf16 v[80:95], v[180:183], v[128:131], 0
    ds_read_b128 v[180:183], v246 offset:40960
    v_max3_f32 v240, v240, v114, v115
    v_max3_f32 v241, v241, v116, v117
    v_max3_f32 v240, v240, v118, v119
    v_max3_f32 v241, v241, v120, v121
    v_max3_f32 v240, v240, v122, v123
    s_waitcnt lgkmcnt(7)
    v_mfma_f32_32x32x16_bf16 v[64:79], v[184:187], v[132:135], v[64:79]
    v_xor_b32 v247, s49, v248
    ds_read_b128 v[184:187], v247 offset:32768
    v_max3_f32 v241, v241, v124, v125
    v_max3_f32 v240, v240, v126, v127
    v_max_f32 v240, v240, v241
    v_mov_b32 v241, v240
    s_waitcnt lgkmcnt(7)
    v_mfma_f32_32x32x16_bf16 v[80:95], v[188:191], v[132:135], v[80:95]
    ds_read_b128 v[188:191], v247 offset:40960
    v_permlane32_swap_b32 v240, v241
    v_max_f32 v240, v240, v241
    v_sub_f32 v241, v240, v236
    v_max_f32 v241, v241, v243
    v_cmp_lt_f32 vcc, s38, v241
    s_waitcnt lgkmcnt(7)
    v_mfma_f32_32x32x16_bf16 v[64:79], v[160:163], v[136:139], v[64:79]
    v_xor_b32 v246, s50, v248
    ds_read_b128 v[160:163], v246 offset:32768
    s_nop 1
    s_cbranch_vccnz concat_heads__gqa_block_cached__gqa_block_cached__near_ridge_kernel_rs5
concat_heads__gqa_block_cached__gqa_block_cached__near_ridge_kernel_rb5:
    v_fma_f32 v228, v228, s37, -v239
    v_fma_f32 v229, v229, s37, -v239
    v_fma_f32 v230, v230, s37, -v239
    s_waitcnt lgkmcnt(7)
    v_mfma_f32_32x32x16_bf16 v[80:95], v[164:167], v[136:139], v[80:95]
    ds_read_b128 v[164:167], v246 offset:40960
    v_fma_f32 v231, v231, s37, -v239
    v_exp_f32 v228, v228
    v_exp_f32 v229, v229
    v_exp_f32 v230, v230
    v_exp_f32 v231, v231
    s_waitcnt lgkmcnt(7)
    v_mfma_f32_32x32x16_bf16 v[64:79], v[168:171], v[140:143], v[64:79]
    v_xor_b32 v247, s51, v248
    ds_read_b128 v[168:171], v247 offset:32768
    v_fma_f32 v96, v96, s37, -v238
    v_fma_f32 v97, v97, s37, -v238
    v_fma_f32 v98, v98, s37, -v238
    v_fma_f32 v99, v99, s37, -v238
    v_fma_f32 v100, v100, s37, -v238
    s_waitcnt lgkmcnt(7)
    v_mfma_f32_32x32x16_bf16 v[80:95], v[172:175], v[140:143], v[80:95]
    ds_read_b128 v[172:175], v247 offset:40960
    v_fma_f32 v101, v101, s37, -v238
    v_fma_f32 v102, v102, s37, -v238
    v_fma_f32 v103, v103, s37, -v238
    v_add_f32 v243, v228, v229
    v_add_f32 v242, v230, v231
    s_waitcnt lgkmcnt(7)
    v_mfma_f32_32x32x16_bf16 v[64:79], v[176:179], v[144:147], v[64:79]
    v_cvt_pk_bf16_f32 v232, v228, v229
    v_cvt_pk_bf16_f32 v233, v230, v231
    v_add_f32 v243, v243, v242
    v_add_f32 v235, v235, v243
    v_exp_f32 v96, v96
    s_waitcnt lgkmcnt(6)
    v_mfma_f32_32x32x16_bf16 v[80:95], v[180:183], v[144:147], v[80:95]
    v_exp_f32 v97, v97
    v_exp_f32 v98, v98
    v_exp_f32 v99, v99
    v_exp_f32 v100, v100
    v_exp_f32 v101, v101
    s_waitcnt lgkmcnt(5)
    v_mfma_f32_32x32x16_bf16 v[64:79], v[184:187], v[148:151], v[64:79]
    s_waitcnt vmcnt(8) lgkmcnt(0)
    s_barrier
    s_add_u32 s40, s35, 114688
    s_add_u32 m0, s36, 49152
    s_nop 0
    buffer_load_dwordx4 v253, s[16:19], s40 offen offset:0 nt lds
    v_xor_b32 v245, 32, v253
    buffer_load_dwordx4 v245, s[16:19], s40 offen offset:1024 nt lds
    buffer_load_dwordx4 v253, s[16:19], s40 offen offset:2048 nt lds
    v_xor_b32 v245, 32, v253
    buffer_load_dwordx4 v245, s[16:19], s40 offen offset:3072 nt lds
    ds_read_b64_tr_b16 v[176:177], v251 offset:49152
    v_xor_b32 v246, 32, v251
    ds_read_b64_tr_b16 v[178:179], v246 offset:49152
    v_xor_b32 v247, 64, v251
    ds_read_b64_tr_b16 v[180:181], v247 offset:49152
    v_xor_b32 v246, 96, v251
    ds_read_b64_tr_b16 v[182:183], v246 offset:49152
    v_xor_b32 v247, 128, v251
    ds_read_b64_tr_b16 v[184:185], v247 offset:49152
    v_xor_b32 v246, 160, v251
    ds_read_b64_tr_b16 v[186:187], v246 offset:49152
    v_exp_f32 v102, v102
    v_exp_f32 v103, v103
    v_add_f32 v237, v237, v96
    v_mov_b32 v241, v97
    v_cvt_pk_bf16_f32 v96, v96, v97
    v_mfma_f32_32x32x16_bf16 v[80:95], v[188:191], v[148:151], v[80:95]
    v_xor_b32 v247, 192, v251
    ds_read_b64_tr_b16 v[188:189], v247 offset:49152
    v_xor_b32 v246, 224, v251
    ds_read_b64_tr_b16 v[190:191], v246 offset:49152
    v_add_f32 v237, v237, v98
    v_add_f32 v241, v241, v99
    v_cvt_pk_bf16_f32 v97, v98, v99
    v_add_f32 v237, v237, v100
    v_add_f32 v241, v241, v101
    v_mfma_f32_32x32x16_bf16 v[64:79], v[160:163], v[152:155], v[64:79]
    ds_read_b64_tr_b16 v[160:161], v249 offset:49152
    ds_read_b64_tr_b16 v[162:163], v249 offset:51200
    v_cvt_pk_bf16_f32 v98, v100, v101
    v_add_f32 v237, v237, v102
    v_add_f32 v241, v241, v103
    v_cvt_pk_bf16_f32 v99, v102, v103
    v_fma_f32 v104, v104, s37, -v238
    v_mfma_f32_32x32x16_bf16 v[80:95], v[164:167], v[152:155], v[80:95]
    v_xor_b32 v247, 64, v249
    ds_read_b64_tr_b16 v[164:165], v247 offset:49152
    ds_read_b64_tr_b16 v[166:167], v247 offset:51200
    v_fma_f32 v105, v105, s37, -v238
    v_fma_f32 v106, v106, s37, -v238
    v_fma_f32 v107, v107, s37, -v238
    v_fma_f32 v108, v108, s37, -v238
    v_fma_f32 v109, v109, s37, -v238
    v_mfma_f32_32x32x16_bf16 v[64:79], v[168:171], v[156:159], v[64:79]
    v_xor_b32 v246, 128, v249
    ds_read_b64_tr_b16 v[168:169], v246 offset:49152
    ds_read_b64_tr_b16 v[170:171], v246 offset:51200
    v_fma_f32 v110, v110, s37, -v238
    v_fma_f32 v111, v111, s37, -v238
    v_exp_f32 v104, v104
    v_exp_f32 v105, v105
    v_exp_f32 v106, v106
    v_mfma_f32_32x32x16_bf16 v[80:95], v[172:175], v[156:159], v[80:95]
    v_xor_b32 v247, 192, v249
    ds_read_b64_tr_b16 v[172:173], v247 offset:49152
    ds_read_b64_tr_b16 v[174:175], v247 offset:51200
    v_exp_f32 v107, v107
    v_exp_f32 v108, v108
    v_exp_f32 v109, v109
    v_exp_f32 v110, v110
    v_exp_f32 v111, v111
    s_waitcnt lgkmcnt(14)
    v_mfma_f32_16x16x16_bf16 v[192:195], v[176:177], v[232:233], v[192:195]
    v_mfma_f32_16x16x16_bf16 v[196:199], v[178:179], v[232:233], v[196:199]
    ds_read_b64_tr_b16 v[176:177], v249 offset:53248
    ds_read_b64_tr_b16 v[178:179], v249 offset:55296
    v_add_f32 v237, v237, v104
    v_add_f32 v241, v241, v105
    v_cvt_pk_bf16_f32 v104, v104, v105
    v_add_f32 v237, v237, v106
    v_add_f32 v241, v241, v107
    s_waitcnt lgkmcnt(14)
    v_mfma_f32_16x16x16_bf16 v[200:203], v[180:181], v[232:233], v[200:203]
    v_mfma_f32_16x16x16_bf16 v[204:207], v[182:183], v[232:233], v[204:207]
    v_xor_b32 v246, 64, v249
    ds_read_b64_tr_b16 v[180:181], v246 offset:53248
    ds_read_b64_tr_b16 v[182:183], v246 offset:55296
    v_cvt_pk_bf16_f32 v105, v106, v107
    v_add_f32 v237, v237, v108
    v_add_f32 v241, v241, v109
    v_cvt_pk_bf16_f32 v106, v108, v109
    v_add_f32 v237, v237, v110
    s_waitcnt lgkmcnt(14)
    v_mfma_f32_16x16x16_bf16 v[208:211], v[184:185], v[232:233], v[208:211]
    v_mfma_f32_16x16x16_bf16 v[212:215], v[186:187], v[232:233], v[212:215]
    v_xor_b32 v247, 128, v249
    ds_read_b64_tr_b16 v[184:185], v247 offset:53248
    ds_read_b64_tr_b16 v[186:187], v247 offset:55296
    v_add_f32 v241, v241, v111
    v_cvt_pk_bf16_f32 v107, v110, v111
    v_fma_f32 v112, v112, s37, -v238
    v_fma_f32 v113, v113, s37, -v238
    v_fma_f32 v114, v114, s37, -v238
    s_waitcnt lgkmcnt(14)
    v_mfma_f32_16x16x16_bf16 v[216:219], v[188:189], v[232:233], v[216:219]
    v_mfma_f32_16x16x16_bf16 v[220:223], v[190:191], v[232:233], v[220:223]
    v_xor_b32 v246, 192, v249
    ds_read_b64_tr_b16 v[188:189], v246 offset:53248
    ds_read_b64_tr_b16 v[190:191], v246 offset:55296
    v_fma_f32 v115, v115, s37, -v238
    v_fma_f32 v116, v116, s37, -v238
    v_fma_f32 v117, v117, s37, -v238
    v_fma_f32 v118, v118, s37, -v238
    v_fma_f32 v119, v119, s37, -v238
    s_waitcnt lgkmcnt(14)
    v_mfma_f32_32x32x16_bf16 v[0:15], v[160:163], v[96:99], v[0:15]
    ds_read_b64_tr_b16 v[160:161], v249 offset:57344
    ds_read_b64_tr_b16 v[162:163], v249 offset:59392
    v_exp_f32 v112, v112
    v_exp_f32 v113, v113
    v_exp_f32 v114, v114
    v_exp_f32 v115, v115
    s_waitcnt lgkmcnt(14)
    v_mfma_f32_32x32x16_bf16 v[16:31], v[164:167], v[96:99], v[16:31]
    v_xor_b32 v247, 64, v249
    ds_read_b64_tr_b16 v[164:165], v247 offset:57344
    ds_read_b64_tr_b16 v[166:167], v247 offset:59392
    v_exp_f32 v116, v116
    v_exp_f32 v117, v117
    v_exp_f32 v118, v118
    v_exp_f32 v119, v119
    s_waitcnt lgkmcnt(14)
    v_mfma_f32_32x32x16_bf16 v[32:47], v[168:171], v[96:99], v[32:47]
    v_xor_b32 v246, 128, v249
    ds_read_b64_tr_b16 v[168:169], v246 offset:57344
    ds_read_b64_tr_b16 v[170:171], v246 offset:59392
    v_add_f32 v237, v237, v112
    v_add_f32 v241, v241, v113
    v_cvt_pk_bf16_f32 v112, v112, v113
    v_add_f32 v237, v237, v114
    s_waitcnt lgkmcnt(14)
    v_mfma_f32_32x32x16_bf16 v[48:63], v[172:175], v[96:99], v[48:63]
    v_xor_b32 v247, 192, v249
    ds_read_b64_tr_b16 v[172:173], v247 offset:57344
    ds_read_b64_tr_b16 v[174:175], v247 offset:59392
    v_add_f32 v241, v241, v115
    v_cvt_pk_bf16_f32 v113, v114, v115
    v_add_f32 v237, v237, v116
    v_add_f32 v241, v241, v117
    s_waitcnt lgkmcnt(14)
    v_mfma_f32_32x32x16_bf16 v[0:15], v[176:179], v[104:107], v[0:15]
    ds_read_b64_tr_b16 v[176:177], v249 offset:61440
    ds_read_b64_tr_b16 v[178:179], v249 offset:63488
    v_cvt_pk_bf16_f32 v114, v116, v117
    v_add_f32 v237, v237, v118
    v_add_f32 v241, v241, v119
    v_cvt_pk_bf16_f32 v115, v118, v119
    s_waitcnt lgkmcnt(14)
    v_mfma_f32_32x32x16_bf16 v[16:31], v[180:183], v[104:107], v[16:31]
    v_xor_b32 v246, 64, v249
    ds_read_b64_tr_b16 v[180:181], v246 offset:61440
    ds_read_b64_tr_b16 v[182:183], v246 offset:63488
    v_fma_f32 v120, v120, s37, -v238
    v_fma_f32 v121, v121, s37, -v238
    v_fma_f32 v122, v122, s37, -v238
    v_fma_f32 v123, v123, s37, -v238
    s_waitcnt lgkmcnt(14)
    v_mfma_f32_32x32x16_bf16 v[32:47], v[184:187], v[104:107], v[32:47]
    v_xor_b32 v247, 128, v249
    ds_read_b64_tr_b16 v[184:185], v247 offset:61440
    ds_read_b64_tr_b16 v[186:187], v247 offset:63488
    v_fma_f32 v124, v124, s37, -v238
    v_fma_f32 v125, v125, s37, -v238
    v_fma_f32 v126, v126, s37, -v238
    v_fma_f32 v127, v127, s37, -v238
    s_waitcnt lgkmcnt(14)
    v_mfma_f32_32x32x16_bf16 v[48:63], v[188:191], v[104:107], v[48:63]
    v_xor_b32 v246, 192, v249
    ds_read_b64_tr_b16 v[188:189], v246 offset:61440
    ds_read_b64_tr_b16 v[190:191], v246 offset:63488
    v_exp_f32 v120, v120
    v_exp_f32 v121, v121
    v_exp_f32 v122, v122
    v_exp_f32 v123, v123
    s_waitcnt lgkmcnt(14)
    v_mfma_f32_32x32x16_bf16 v[0:15], v[160:163], v[112:115], v[0:15]
    v_exp_f32 v124, v124
    v_exp_f32 v125, v125
    v_exp_f32 v126, v126
    v_exp_f32 v127, v127
    s_waitcnt lgkmcnt(12)
    v_mfma_f32_32x32x16_bf16 v[16:31], v[164:167], v[112:115], v[16:31]
    v_add_f32 v237, v237, v120
    v_add_f32 v241, v241, v121
    v_cvt_pk_bf16_f32 v120, v120, v121
    v_add_f32 v237, v237, v122
    s_waitcnt lgkmcnt(10)
    v_mfma_f32_32x32x16_bf16 v[32:47], v[168:171], v[112:115], v[32:47]
    s_waitcnt vmcnt(8) lgkmcnt(0)
    s_barrier
    ds_read_b128 v[160:163], v250 offset:0
    v_add_u32 v247, s43, v250
    ds_read_b128 v[164:167], v247 offset:0
    v_xor_b32 v246, 64, v250
    ds_read_b128 v[168:171], v246 offset:0
    v_add_f32 v241, v241, v123
    v_cvt_pk_bf16_f32 v121, v122, v123
    v_add_f32 v237, v237, v124
    v_add_f32 v241, v241, v125
    v_mfma_f32_32x32x16_bf16 v[48:63], v[172:175], v[112:115], v[48:63]
    v_add_u32 v247, s43, v246
    ds_read_b128 v[172:175], v247 offset:0
    v_cvt_pk_bf16_f32 v122, v124, v125
    v_add_f32 v237, v237, v126
    v_add_f32 v241, v241, v127
    v_cvt_pk_bf16_f32 v123, v126, v127
    s_nop 1
    v_mfma_f32_32x32x16_bf16 v[0:15], v[176:179], v[120:123], v[0:15]
    v_xor_b32 v246, 128, v250
    ds_read_b128 v[176:179], v246 offset:0
    v_add_f32 v237, v237, v241
    v_mfma_f32_32x32x16_bf16 v[16:31], v[180:183], v[120:123], v[16:31]
    v_add_u32 v247, s43, v246
    ds_read_b128 v[180:183], v247 offset:0
    v_mfma_f32_32x32x16_bf16 v[32:47], v[184:187], v[120:123], v[32:47]
    v_xor_b32 v246, 192, v250
    ds_read_b128 v[184:187], v246 offset:0
    v_mfma_f32_32x32x16_bf16 v[48:63], v[188:191], v[120:123], v[48:63]
    v_add_u32 v247, s43, v246
    ds_read_b128 v[188:191], v247 offset:0
    s_waitcnt lgkmcnt(6)
    v_mfma_f32_16x16x32_bf16 v[228:231], v[164:167], v[160:163], 0
    v_xor_b32 v246, s44, v248
    ds_read_b128 v[160:163], v246 offset:0
    ds_read_b128 v[164:167], v246 offset:8192
    v_max3_f32 v242, v224, v225, v226
    v_max_f32 v242, v242, v227
    v_mov_b32 v243, v242
    s_waitcnt lgkmcnt(6)
    v_mfma_f32_16x16x32_bf16 v[228:231], v[172:175], v[168:171], v[228:231]
    v_xor_b32 v247, s45, v248
    ds_read_b128 v[168:171], v247 offset:0
    ds_read_b128 v[172:175], v247 offset:8192
    v_max3_f32 v240, v64, v65, v66
    v_max3_f32 v241, v67, v68, v69
    v_permlane32_swap_b32 v242, v243
    s_waitcnt lgkmcnt(6)
    v_mfma_f32_16x16x32_bf16 v[228:231], v[180:183], v[176:179], v[228:231]
    v_xor_b32 v246, s46, v248
    ds_read_b128 v[176:179], v246 offset:0
    ds_read_b128 v[180:183], v246 offset:8192
    v_max3_f32 v240, v240, v70, v71
    v_max_f32 v242, v242, v243
    v_mov_b32 v243, v242
    s_waitcnt lgkmcnt(6)
    v_mfma_f32_16x16x32_bf16 v[228:231], v[188:191], v[184:187], v[228:231]
    v_xor_b32 v247, s47, v248
    ds_read_b128 v[184:187], v247 offset:0
    ds_read_b128 v[188:191], v247 offset:8192
    v_max3_f32 v241, v241, v72, v73
    v_max3_f32 v240, v240, v74, v75
    v_max3_f32 v241, v241, v76, v77
    s_waitcnt lgkmcnt(7)
    v_mfma_f32_32x32x16_bf16 v[96:111], v[160:163], v[128:131], 0
    v_xor_b32 v246, s48, v248
    ds_read_b128 v[160:163], v246 offset:0
    v_permlane16_swap_b32 v242, v243
    v_max3_f32 v240, v240, v78, v79
    v_max_f32 v242, v242, v243
    v_max3_f32 v241, v241, v80, v81
    v_sub_f32 v243, v242, v234
    s_waitcnt lgkmcnt(7)
    v_mfma_f32_32x32x16_bf16 v[112:127], v[164:167], v[128:131], 0
    ds_read_b128 v[164:167], v246 offset:8192
    v_max3_f32 v240, v240, v82, v83
    v_max3_f32 v241, v241, v84, v85
    v_max3_f32 v240, v240, v86, v87
    v_max3_f32 v241, v241, v88, v89
    v_max3_f32 v240, v240, v90, v91
    s_waitcnt lgkmcnt(7)
    v_mfma_f32_32x32x16_bf16 v[96:111], v[168:171], v[132:135], v[96:111]
    v_xor_b32 v247, s49, v248
    ds_read_b128 v[168:171], v247 offset:0
    v_max3_f32 v241, v241, v92, v93
    v_max3_f32 v240, v240, v94, v95
    v_max_f32 v240, v240, v241
    v_mov_b32 v241, v240
    s_waitcnt lgkmcnt(7)
    v_mfma_f32_32x32x16_bf16 v[112:127], v[172:175], v[132:135], v[112:127]
    ds_read_b128 v[172:175], v247 offset:8192
    v_permlane32_swap_b32 v240, v241
    v_max_f32 v240, v240, v241
    v_sub_f32 v241, v240, v236
    v_max_f32 v241, v241, v243
    v_cmp_lt_f32 vcc, s38, v241
    s_waitcnt lgkmcnt(7)
    v_mfma_f32_32x32x16_bf16 v[96:111], v[176:179], v[136:139], v[96:111]
    v_xor_b32 v246, s50, v248
    ds_read_b128 v[176:179], v246 offset:0
    s_nop 1
    s_cbranch_vccnz concat_heads__gqa_block_cached__gqa_block_cached__near_ridge_kernel_rs6
concat_heads__gqa_block_cached__gqa_block_cached__near_ridge_kernel_rb6:
    v_fma_f32 v224, v224, s37, -v239
    v_fma_f32 v225, v225, s37, -v239
    v_fma_f32 v226, v226, s37, -v239
    s_waitcnt lgkmcnt(7)
    v_mfma_f32_32x32x16_bf16 v[112:127], v[180:183], v[136:139], v[112:127]
    ds_read_b128 v[180:183], v246 offset:8192
    v_fma_f32 v227, v227, s37, -v239
    v_exp_f32 v224, v224
    v_exp_f32 v225, v225
    v_exp_f32 v226, v226
    v_exp_f32 v227, v227
    s_waitcnt lgkmcnt(7)
    v_mfma_f32_32x32x16_bf16 v[96:111], v[184:187], v[140:143], v[96:111]
    v_xor_b32 v247, s51, v248
    ds_read_b128 v[184:187], v247 offset:0
    v_fma_f32 v64, v64, s37, -v238
    v_fma_f32 v65, v65, s37, -v238
    v_fma_f32 v66, v66, s37, -v238
    v_fma_f32 v67, v67, s37, -v238
    v_fma_f32 v68, v68, s37, -v238
    s_waitcnt lgkmcnt(7)
    v_mfma_f32_32x32x16_bf16 v[112:127], v[188:191], v[140:143], v[112:127]
    ds_read_b128 v[188:191], v247 offset:8192
    v_fma_f32 v69, v69, s37, -v238
    v_fma_f32 v70, v70, s37, -v238
    v_fma_f32 v71, v71, s37, -v238
    v_add_f32 v243, v224, v225
    v_add_f32 v242, v226, v227
    s_waitcnt lgkmcnt(7)
    v_mfma_f32_32x32x16_bf16 v[96:111], v[160:163], v[144:147], v[96:111]
    v_cvt_pk_bf16_f32 v232, v224, v225
    v_cvt_pk_bf16_f32 v233, v226, v227
    v_add_f32 v243, v243, v242
    v_add_f32 v235, v235, v243
    v_exp_f32 v64, v64
    s_waitcnt lgkmcnt(6)
    v_mfma_f32_32x32x16_bf16 v[112:127], v[164:167], v[144:147], v[112:127]
    v_exp_f32 v65, v65
    v_exp_f32 v66, v66
    v_exp_f32 v67, v67
    v_exp_f32 v68, v68
    v_exp_f32 v69, v69
    s_waitcnt lgkmcnt(5)
    v_mfma_f32_32x32x16_bf16 v[96:111], v[168:171], v[148:151], v[96:111]
    s_waitcnt vmcnt(4) lgkmcnt(0)
    s_barrier
    ds_read_b64_tr_b16 v[160:161], v251 offset:16384
    v_xor_b32 v246, 32, v251
    ds_read_b64_tr_b16 v[162:163], v246 offset:16384
    v_xor_b32 v247, 64, v251
    ds_read_b64_tr_b16 v[164:165], v247 offset:16384
    v_xor_b32 v246, 96, v251
    ds_read_b64_tr_b16 v[166:167], v246 offset:16384
    v_xor_b32 v247, 128, v251
    ds_read_b64_tr_b16 v[168:169], v247 offset:16384
    v_xor_b32 v246, 160, v251
    ds_read_b64_tr_b16 v[170:171], v246 offset:16384
    v_exp_f32 v70, v70
    v_exp_f32 v71, v71
    v_add_f32 v237, v237, v64
    v_mov_b32 v241, v65
    v_cvt_pk_bf16_f32 v64, v64, v65
    v_mfma_f32_32x32x16_bf16 v[112:127], v[172:175], v[148:151], v[112:127]
    v_xor_b32 v247, 192, v251
    ds_read_b64_tr_b16 v[172:173], v247 offset:16384
    v_xor_b32 v246, 224, v251
    ds_read_b64_tr_b16 v[174:175], v246 offset:16384
    v_add_f32 v237, v237, v66
    v_add_f32 v241, v241, v67
    v_cvt_pk_bf16_f32 v65, v66, v67
    v_add_f32 v237, v237, v68
    v_add_f32 v241, v241, v69
    v_mfma_f32_32x32x16_bf16 v[96:111], v[176:179], v[152:155], v[96:111]
    ds_read_b64_tr_b16 v[176:177], v249 offset:16384
    ds_read_b64_tr_b16 v[178:179], v249 offset:18432
    v_cvt_pk_bf16_f32 v66, v68, v69
    v_add_f32 v237, v237, v70
    v_add_f32 v241, v241, v71
    v_cvt_pk_bf16_f32 v67, v70, v71
    v_fma_f32 v72, v72, s37, -v238
    v_mfma_f32_32x32x16_bf16 v[112:127], v[180:183], v[152:155], v[112:127]
    v_xor_b32 v247, 64, v249
    ds_read_b64_tr_b16 v[180:181], v247 offset:16384
    ds_read_b64_tr_b16 v[182:183], v247 offset:18432
    v_fma_f32 v73, v73, s37, -v238
    v_fma_f32 v74, v74, s37, -v238
    v_fma_f32 v75, v75, s37, -v238
    v_fma_f32 v76, v76, s37, -v238
    v_fma_f32 v77, v77, s37, -v238
    v_mfma_f32_32x32x16_bf16 v[96:111], v[184:187], v[156:159], v[96:111]
    v_xor_b32 v246, 128, v249
    ds_read_b64_tr_b16 v[184:185], v246 offset:16384
    ds_read_b64_tr_b16 v[186:187], v246 offset:18432
    v_fma_f32 v78, v78, s37, -v238
    v_fma_f32 v79, v79, s37, -v238
    v_exp_f32 v72, v72
    v_exp_f32 v73, v73
    v_exp_f32 v74, v74
    v_mfma_f32_32x32x16_bf16 v[112:127], v[188:191], v[156:159], v[112:127]
    v_xor_b32 v247, 192, v249
    ds_read_b64_tr_b16 v[188:189], v247 offset:16384
    ds_read_b64_tr_b16 v[190:191], v247 offset:18432
    v_exp_f32 v75, v75
    v_exp_f32 v76, v76
    v_exp_f32 v77, v77
    v_exp_f32 v78, v78
    v_exp_f32 v79, v79
    s_waitcnt lgkmcnt(14)
    v_mfma_f32_16x16x16_bf16 v[192:195], v[160:161], v[232:233], v[192:195]
    v_mfma_f32_16x16x16_bf16 v[196:199], v[162:163], v[232:233], v[196:199]
    ds_read_b64_tr_b16 v[160:161], v249 offset:20480
    ds_read_b64_tr_b16 v[162:163], v249 offset:22528
    v_add_f32 v237, v237, v72
    v_add_f32 v241, v241, v73
    v_cvt_pk_bf16_f32 v72, v72, v73
    v_add_f32 v237, v237, v74
    v_add_f32 v241, v241, v75
    s_waitcnt lgkmcnt(14)
    v_mfma_f32_16x16x16_bf16 v[200:203], v[164:165], v[232:233], v[200:203]
    v_mfma_f32_16x16x16_bf16 v[204:207], v[166:167], v[232:233], v[204:207]
    v_xor_b32 v246, 64, v249
    ds_read_b64_tr_b16 v[164:165], v246 offset:20480
    ds_read_b64_tr_b16 v[166:167], v246 offset:22528
    v_cvt_pk_bf16_f32 v73, v74, v75
    v_add_f32 v237, v237, v76
    v_add_f32 v241, v241, v77
    v_cvt_pk_bf16_f32 v74, v76, v77
    v_add_f32 v237, v237, v78
    s_waitcnt lgkmcnt(14)
    v_mfma_f32_16x16x16_bf16 v[208:211], v[168:169], v[232:233], v[208:211]
    v_mfma_f32_16x16x16_bf16 v[212:215], v[170:171], v[232:233], v[212:215]
    v_xor_b32 v247, 128, v249
    ds_read_b64_tr_b16 v[168:169], v247 offset:20480
    ds_read_b64_tr_b16 v[170:171], v247 offset:22528
    v_add_f32 v241, v241, v79
    v_cvt_pk_bf16_f32 v75, v78, v79
    v_fma_f32 v80, v80, s37, -v238
    v_fma_f32 v81, v81, s37, -v238
    v_fma_f32 v82, v82, s37, -v238
    s_waitcnt lgkmcnt(14)
    v_mfma_f32_16x16x16_bf16 v[216:219], v[172:173], v[232:233], v[216:219]
    v_mfma_f32_16x16x16_bf16 v[220:223], v[174:175], v[232:233], v[220:223]
    v_xor_b32 v246, 192, v249
    ds_read_b64_tr_b16 v[172:173], v246 offset:20480
    ds_read_b64_tr_b16 v[174:175], v246 offset:22528
    v_fma_f32 v83, v83, s37, -v238
    v_fma_f32 v84, v84, s37, -v238
    v_fma_f32 v85, v85, s37, -v238
    v_fma_f32 v86, v86, s37, -v238
    v_fma_f32 v87, v87, s37, -v238
    s_waitcnt lgkmcnt(14)
    v_mfma_f32_32x32x16_bf16 v[0:15], v[176:179], v[64:67], v[0:15]
    ds_read_b64_tr_b16 v[176:177], v249 offset:24576
    ds_read_b64_tr_b16 v[178:179], v249 offset:26624
    v_exp_f32 v80, v80
    v_exp_f32 v81, v81
    v_exp_f32 v82, v82
    v_exp_f32 v83, v83
    s_waitcnt lgkmcnt(14)
    v_mfma_f32_32x32x16_bf16 v[16:31], v[180:183], v[64:67], v[16:31]
    v_xor_b32 v247, 64, v249
    ds_read_b64_tr_b16 v[180:181], v247 offset:24576
    ds_read_b64_tr_b16 v[182:183], v247 offset:26624
    v_exp_f32 v84, v84
    v_exp_f32 v85, v85
    v_exp_f32 v86, v86
    v_exp_f32 v87, v87
    s_waitcnt lgkmcnt(14)
    v_mfma_f32_32x32x16_bf16 v[32:47], v[184:187], v[64:67], v[32:47]
    v_xor_b32 v246, 128, v249
    ds_read_b64_tr_b16 v[184:185], v246 offset:24576
    ds_read_b64_tr_b16 v[186:187], v246 offset:26624
    v_add_f32 v237, v237, v80
    v_add_f32 v241, v241, v81
    v_cvt_pk_bf16_f32 v80, v80, v81
    v_add_f32 v237, v237, v82
    s_waitcnt lgkmcnt(14)
    v_mfma_f32_32x32x16_bf16 v[48:63], v[188:191], v[64:67], v[48:63]
    v_xor_b32 v247, 192, v249
    ds_read_b64_tr_b16 v[188:189], v247 offset:24576
    ds_read_b64_tr_b16 v[190:191], v247 offset:26624
    v_add_f32 v241, v241, v83
    v_cvt_pk_bf16_f32 v81, v82, v83
    v_add_f32 v237, v237, v84
    v_add_f32 v241, v241, v85
    s_waitcnt lgkmcnt(14)
    v_mfma_f32_32x32x16_bf16 v[0:15], v[160:163], v[72:75], v[0:15]
    ds_read_b64_tr_b16 v[160:161], v249 offset:28672
    ds_read_b64_tr_b16 v[162:163], v249 offset:30720
    v_cvt_pk_bf16_f32 v82, v84, v85
    v_add_f32 v237, v237, v86
    v_add_f32 v241, v241, v87
    v_cvt_pk_bf16_f32 v83, v86, v87
    s_waitcnt lgkmcnt(14)
    v_mfma_f32_32x32x16_bf16 v[16:31], v[164:167], v[72:75], v[16:31]
    v_xor_b32 v246, 64, v249
    ds_read_b64_tr_b16 v[164:165], v246 offset:28672
    ds_read_b64_tr_b16 v[166:167], v246 offset:30720
    v_fma_f32 v88, v88, s37, -v238
    v_fma_f32 v89, v89, s37, -v238
    v_fma_f32 v90, v90, s37, -v238
    v_fma_f32 v91, v91, s37, -v238
    s_waitcnt lgkmcnt(14)
    v_mfma_f32_32x32x16_bf16 v[32:47], v[168:171], v[72:75], v[32:47]
    v_xor_b32 v247, 128, v249
    ds_read_b64_tr_b16 v[168:169], v247 offset:28672
    ds_read_b64_tr_b16 v[170:171], v247 offset:30720
    v_fma_f32 v92, v92, s37, -v238
    v_fma_f32 v93, v93, s37, -v238
    v_fma_f32 v94, v94, s37, -v238
    v_fma_f32 v95, v95, s37, -v238
    s_waitcnt lgkmcnt(14)
    v_mfma_f32_32x32x16_bf16 v[48:63], v[172:175], v[72:75], v[48:63]
    v_xor_b32 v246, 192, v249
    ds_read_b64_tr_b16 v[172:173], v246 offset:28672
    ds_read_b64_tr_b16 v[174:175], v246 offset:30720
    v_exp_f32 v88, v88
    v_exp_f32 v89, v89
    v_exp_f32 v90, v90
    v_exp_f32 v91, v91
    s_waitcnt lgkmcnt(14)
    v_mfma_f32_32x32x16_bf16 v[0:15], v[176:179], v[80:83], v[0:15]
    v_exp_f32 v92, v92
    v_exp_f32 v93, v93
    v_exp_f32 v94, v94
    v_exp_f32 v95, v95
    s_waitcnt lgkmcnt(12)
    v_mfma_f32_32x32x16_bf16 v[16:31], v[180:183], v[80:83], v[16:31]
    v_add_f32 v237, v237, v88
    v_add_f32 v241, v241, v89
    v_cvt_pk_bf16_f32 v88, v88, v89
    v_add_f32 v237, v237, v90
    s_waitcnt lgkmcnt(10)
    v_mfma_f32_32x32x16_bf16 v[32:47], v[184:187], v[80:83], v[32:47]
    s_waitcnt vmcnt(0) lgkmcnt(0)
    s_barrier
    ds_read_b64_tr_b16 v[176:177], v251 offset:32768
    v_xor_b32 v247, 32, v251
    ds_read_b64_tr_b16 v[178:179], v247 offset:32768
    v_xor_b32 v246, 64, v251
    ds_read_b64_tr_b16 v[180:181], v246 offset:32768
    v_xor_b32 v247, 96, v251
    ds_read_b64_tr_b16 v[182:183], v247 offset:32768
    v_xor_b32 v246, 128, v251
    ds_read_b64_tr_b16 v[184:185], v246 offset:32768
    v_xor_b32 v247, 160, v251
    ds_read_b64_tr_b16 v[186:187], v247 offset:32768
    v_add_f32 v241, v241, v91
    v_cvt_pk_bf16_f32 v89, v90, v91
    v_add_f32 v237, v237, v92
    v_add_f32 v241, v241, v93
    v_mfma_f32_32x32x16_bf16 v[48:63], v[188:191], v[80:83], v[48:63]
    v_xor_b32 v246, 192, v251
    ds_read_b64_tr_b16 v[188:189], v246 offset:32768
    v_xor_b32 v247, 224, v251
    ds_read_b64_tr_b16 v[190:191], v247 offset:32768
    v_cvt_pk_bf16_f32 v90, v92, v93
    v_add_f32 v237, v237, v94
    v_add_f32 v241, v241, v95
    v_cvt_pk_bf16_f32 v91, v94, v95
    s_nop 1
    v_mfma_f32_32x32x16_bf16 v[0:15], v[160:163], v[88:91], v[0:15]
    ds_read_b64_tr_b16 v[160:161], v249 offset:32768
    ds_read_b64_tr_b16 v[162:163], v249 offset:34816
    v_add_f32 v237, v237, v241
    v_mfma_f32_32x32x16_bf16 v[16:31], v[164:167], v[88:91], v[16:31]
    v_xor_b32 v246, 64, v249
    ds_read_b64_tr_b16 v[164:165], v246 offset:32768
    ds_read_b64_tr_b16 v[166:167], v246 offset:34816
    v_mfma_f32_32x32x16_bf16 v[32:47], v[168:171], v[88:91], v[32:47]
    v_xor_b32 v247, 128, v249
    ds_read_b64_tr_b16 v[168:169], v247 offset:32768
    ds_read_b64_tr_b16 v[170:171], v247 offset:34816
    v_mfma_f32_32x32x16_bf16 v[48:63], v[172:175], v[88:91], v[48:63]
    v_xor_b32 v246, 192, v249
    ds_read_b64_tr_b16 v[172:173], v246 offset:32768
    ds_read_b64_tr_b16 v[174:175], v246 offset:34816
    v_max3_f32 v242, v228, v229, v230
    v_max_f32 v242, v242, v231
    v_mov_b32 v243, v242
    v_max3_f32 v240, v96, v97, v98
    v_max3_f32 v241, v99, v100, v101
    v_permlane32_swap_b32 v242, v243
    v_max3_f32 v240, v240, v102, v103
    v_max_f32 v242, v242, v243
    v_mov_b32 v243, v242
    v_max3_f32 v241, v241, v104, v105
    v_max3_f32 v240, v240, v106, v107
    v_max3_f32 v241, v241, v108, v109
    v_permlane16_swap_b32 v242, v243
    v_max3_f32 v240, v240, v110, v111
    v_max_f32 v242, v242, v243
    v_max3_f32 v241, v241, v112, v113
    v_sub_f32 v243, v242, v234
    v_max3_f32 v240, v240, v114, v115
    v_max3_f32 v241, v241, v116, v117
    v_max3_f32 v240, v240, v118, v119
    v_max3_f32 v241, v241, v120, v121
    v_max3_f32 v240, v240, v122, v123
    v_max3_f32 v241, v241, v124, v125
    v_max3_f32 v240, v240, v126, v127
    v_max_f32 v240, v240, v241
    v_mov_b32 v241, v240
    s_nop 1
    v_permlane32_swap_b32 v240, v241
    v_max_f32 v240, v240, v241
    v_sub_f32 v241, v240, v236
    v_max_f32 v241, v241, v243
    v_cmp_lt_f32 vcc, s38, v241
    s_nop 1
    s_cbranch_vccnz concat_heads__gqa_block_cached__gqa_block_cached__near_ridge_kernel_rs7
concat_heads__gqa_block_cached__gqa_block_cached__near_ridge_kernel_rb7:
    v_fma_f32 v228, v228, s37, -v239
    v_fma_f32 v229, v229, s37, -v239
    v_fma_f32 v230, v230, s37, -v239
    v_fma_f32 v231, v231, s37, -v239
    v_exp_f32 v228, v228
    v_exp_f32 v229, v229
    v_exp_f32 v230, v230
    v_exp_f32 v231, v231
    v_fma_f32 v96, v96, s37, -v238
    v_fma_f32 v97, v97, s37, -v238
    v_fma_f32 v98, v98, s37, -v238
    v_fma_f32 v99, v99, s37, -v238
    v_fma_f32 v100, v100, s37, -v238
    v_fma_f32 v101, v101, s37, -v238
    v_fma_f32 v102, v102, s37, -v238
    v_fma_f32 v103, v103, s37, -v238
    v_add_f32 v243, v228, v229
    v_add_f32 v242, v230, v231
    v_cvt_pk_bf16_f32 v232, v228, v229
    v_cvt_pk_bf16_f32 v233, v230, v231
    v_add_f32 v243, v243, v242
    v_add_f32 v235, v235, v243
    s_waitcnt lgkmcnt(14)
    v_mfma_f32_16x16x16_bf16 v[192:195], v[176:177], v[232:233], v[192:195]
    v_mfma_f32_16x16x16_bf16 v[196:199], v[178:179], v[232:233], v[196:199]
    ds_read_b64_tr_b16 v[176:177], v249 offset:36864
    ds_read_b64_tr_b16 v[178:179], v249 offset:38912
    v_exp_f32 v96, v96
    v_exp_f32 v97, v97
    v_exp_f32 v98, v98
    v_exp_f32 v99, v99
    v_exp_f32 v100, v100
    v_exp_f32 v101, v101
    v_exp_f32 v102, v102
    s_waitcnt lgkmcnt(14)
    v_mfma_f32_16x16x16_bf16 v[200:203], v[180:181], v[232:233], v[200:203]
    v_mfma_f32_16x16x16_bf16 v[204:207], v[182:183], v[232:233], v[204:207]
    v_xor_b32 v247, 64, v249
    ds_read_b64_tr_b16 v[180:181], v247 offset:36864
    ds_read_b64_tr_b16 v[182:183], v247 offset:38912
    v_exp_f32 v103, v103
    v_add_f32 v237, v237, v96
    v_mov_b32 v241, v97
    v_cvt_pk_bf16_f32 v96, v96, v97
    v_add_f32 v237, v237, v98
    v_add_f32 v241, v241, v99
    v_cvt_pk_bf16_f32 v97, v98, v99
    s_waitcnt lgkmcnt(14)
    v_mfma_f32_16x16x16_bf16 v[208:211], v[184:185], v[232:233], v[208:211]
    v_mfma_f32_16x16x16_bf16 v[212:215], v[186:187], v[232:233], v[212:215]
    v_xor_b32 v246, 128, v249
    ds_read_b64_tr_b16 v[184:185], v246 offset:36864
    ds_read_b64_tr_b16 v[186:187], v246 offset:38912
    v_add_f32 v237, v237, v100
    v_add_f32 v241, v241, v101
    v_cvt_pk_bf16_f32 v98, v100, v101
    v_add_f32 v237, v237, v102
    v_add_f32 v241, v241, v103
    v_cvt_pk_bf16_f32 v99, v102, v103
    v_fma_f32 v104, v104, s37, -v238
    s_waitcnt lgkmcnt(14)
    v_mfma_f32_16x16x16_bf16 v[216:219], v[188:189], v[232:233], v[216:219]
    v_mfma_f32_16x16x16_bf16 v[220:223], v[190:191], v[232:233], v[220:223]
    v_xor_b32 v247, 192, v249
    ds_read_b64_tr_b16 v[188:189], v247 offset:36864
    ds_read_b64_tr_b16 v[190:191], v247 offset:38912
    v_fma_f32 v105, v105, s37, -v238
    v_fma_f32 v106, v106, s37, -v238
    v_fma_f32 v107, v107, s37, -v238
    v_fma_f32 v108, v108, s37, -v238
    v_fma_f32 v109, v109, s37, -v238
    v_fma_f32 v110, v110, s37, -v238
    v_fma_f32 v111, v111, s37, -v238
    s_waitcnt lgkmcnt(14)
    v_mfma_f32_32x32x16_bf16 v[0:15], v[160:163], v[96:99], v[0:15]
    ds_read_b64_tr_b16 v[160:161], v249 offset:40960
    ds_read_b64_tr_b16 v[162:163], v249 offset:43008
    v_exp_f32 v104, v104
    v_exp_f32 v105, v105
    v_exp_f32 v106, v106
    v_exp_f32 v107, v107
    v_exp_f32 v108, v108
    v_exp_f32 v109, v109
    v_exp_f32 v110, v110
    s_waitcnt lgkmcnt(14)
    v_mfma_f32_32x32x16_bf16 v[16:31], v[164:167], v[96:99], v[16:31]
    v_xor_b32 v246, 64, v249
    ds_read_b64_tr_b16 v[164:165], v246 offset:40960
    ds_read_b64_tr_b16 v[166:167], v246 offset:43008
    v_exp_f32 v111, v111
    v_add_f32 v237, v237, v104
    v_add_f32 v241, v241, v105
    v_cvt_pk_bf16_f32 v104, v104, v105
    v_add_f32 v237, v237, v106
    v_add_f32 v241, v241, v107
    v_cvt_pk_bf16_f32 v105, v106, v107
    s_waitcnt lgkmcnt(14)
    v_mfma_f32_32x32x16_bf16 v[32:47], v[168:171], v[96:99], v[32:47]
    v_xor_b32 v247, 128, v249
    ds_read_b64_tr_b16 v[168:169], v247 offset:40960
    ds_read_b64_tr_b16 v[170:171], v247 offset:43008
    v_add_f32 v237, v237, v108
    v_add_f32 v241, v241, v109
    v_cvt_pk_bf16_f32 v106, v108, v109
    v_add_f32 v237, v237, v110
    v_add_f32 v241, v241, v111
    v_cvt_pk_bf16_f32 v107, v110, v111
    v_fma_f32 v112, v112, s37, -v238
    s_waitcnt lgkmcnt(14)
    v_mfma_f32_32x32x16_bf16 v[48:63], v[172:175], v[96:99], v[48:63]
    v_xor_b32 v246, 192, v249
    ds_read_b64_tr_b16 v[172:173], v246 offset:40960
    ds_read_b64_tr_b16 v[174:175], v246 offset:43008
    v_fma_f32 v113, v113, s37, -v238
    v_fma_f32 v114, v114, s37, -v238
    v_fma_f32 v115, v115, s37, -v238
    v_fma_f32 v116, v116, s37, -v238
    v_fma_f32 v117, v117, s37, -v238
    v_fma_f32 v118, v118, s37, -v238
    v_fma_f32 v119, v119, s37, -v238
    s_waitcnt lgkmcnt(14)
    v_mfma_f32_32x32x16_bf16 v[0:15], v[176:179], v[104:107], v[0:15]
    ds_read_b64_tr_b16 v[176:177], v249 offset:45056
    ds_read_b64_tr_b16 v[178:179], v249 offset:47104
    v_exp_f32 v112, v112
    v_exp_f32 v113, v113
    v_exp_f32 v114, v114
    v_exp_f32 v115, v115
    v_exp_f32 v116, v116
    v_exp_f32 v117, v117
    s_waitcnt lgkmcnt(14)
    v_mfma_f32_32x32x16_bf16 v[16:31], v[180:183], v[104:107], v[16:31]
    v_xor_b32 v247, 64, v249
    ds_read_b64_tr_b16 v[180:181], v247 offset:45056
    ds_read_b64_tr_b16 v[182:183], v247 offset:47104
    v_exp_f32 v118, v118
    v_exp_f32 v119, v119
    v_add_f32 v237, v237, v112
    v_add_f32 v241, v241, v113
    v_cvt_pk_bf16_f32 v112, v112, v113
    v_add_f32 v237, v237, v114
    s_waitcnt lgkmcnt(14)
    v_mfma_f32_32x32x16_bf16 v[32:47], v[184:187], v[104:107], v[32:47]
    v_xor_b32 v246, 128, v249
    ds_read_b64_tr_b16 v[184:185], v246 offset:45056
    ds_read_b64_tr_b16 v[186:187], v246 offset:47104
    v_add_f32 v241, v241, v115
    v_cvt_pk_bf16_f32 v113, v114, v115
    v_add_f32 v237, v237, v116
    v_add_f32 v241, v241, v117
    v_cvt_pk_bf16_f32 v114, v116, v117
    v_add_f32 v237, v237, v118
    s_waitcnt lgkmcnt(14)
    v_mfma_f32_32x32x16_bf16 v[48:63], v[188:191], v[104:107], v[48:63]
    v_xor_b32 v247, 192, v249
    ds_read_b64_tr_b16 v[188:189], v247 offset:45056
    ds_read_b64_tr_b16 v[190:191], v247 offset:47104
    v_add_f32 v241, v241, v119
    v_cvt_pk_bf16_f32 v115, v118, v119
    v_fma_f32 v120, v120, s37, -v238
    v_fma_f32 v121, v121, s37, -v238
    v_fma_f32 v122, v122, s37, -v238
    v_fma_f32 v123, v123, s37, -v238
    s_waitcnt lgkmcnt(14)
    v_mfma_f32_32x32x16_bf16 v[0:15], v[160:163], v[112:115], v[0:15]
    v_fma_f32 v124, v124, s37, -v238
    v_fma_f32 v125, v125, s37, -v238
    v_fma_f32 v126, v126, s37, -v238
    v_fma_f32 v127, v127, s37, -v238
    v_exp_f32 v120, v120
    v_exp_f32 v121, v121
    s_waitcnt lgkmcnt(12)
    v_mfma_f32_32x32x16_bf16 v[16:31], v[164:167], v[112:115], v[16:31]
    v_exp_f32 v122, v122
    v_exp_f32 v123, v123
    v_exp_f32 v124, v124
    v_exp_f32 v125, v125
    v_exp_f32 v126, v126
    v_exp_f32 v127, v127
    s_waitcnt lgkmcnt(10)
    v_mfma_f32_32x32x16_bf16 v[32:47], v[168:171], v[112:115], v[32:47]
    v_add_f32 v237, v237, v120
    v_add_f32 v241, v241, v121
    v_cvt_pk_bf16_f32 v120, v120, v121
    v_add_f32 v237, v237, v122
    v_add_f32 v241, v241, v123
    v_cvt_pk_bf16_f32 v121, v122, v123
    s_waitcnt lgkmcnt(8)
    v_mfma_f32_32x32x16_bf16 v[48:63], v[172:175], v[112:115], v[48:63]
    v_add_f32 v237, v237, v124
    v_add_f32 v241, v241, v125
    v_cvt_pk_bf16_f32 v122, v124, v125
    v_add_f32 v237, v237, v126
    v_add_f32 v241, v241, v127
    v_cvt_pk_bf16_f32 v123, v126, v127
    s_waitcnt lgkmcnt(6)
    s_nop 0
    v_mfma_f32_32x32x16_bf16 v[0:15], v[176:179], v[120:123], v[0:15]
    v_add_f32 v237, v237, v241
    s_waitcnt lgkmcnt(4)
    v_mfma_f32_32x32x16_bf16 v[16:31], v[180:183], v[120:123], v[16:31]
    s_waitcnt lgkmcnt(2)
    v_mfma_f32_32x32x16_bf16 v[32:47], v[184:187], v[120:123], v[32:47]
    s_waitcnt lgkmcnt(0)
    v_mfma_f32_32x32x16_bf16 v[48:63], v[188:191], v[120:123], v[48:63]
    s_waitcnt lgkmcnt(0)
    s_barrier
    s_cmp_ge_u32 s2, 512
    s_cbranch_scc1 concat_heads__gqa_block_cached__gqa_block_cached__near_ridge_kernel_nopf
    s_cmp_lt_u32 s2, 256
    s_cselect_b32 s20, s72, s82
    s_cselect_b32 s21, s73, s83
    s_mov_b32 s22, 5242880
    s_mov_b32 s23, 0x00020000
    s_and_b32 s3, s2, 255
    s_mul_i32 s3, s3, 20480
    s_mul_i32 s4, s28, 5120
    s_add_u32 s3, s3, s4
    s_add_u32 s4, s3, 4096
    v_lshlrev_b32 v240, 4, v254
    buffer_load_dwordx4 v[128:131], v240, s[20:23], s3 offen offset:0
    buffer_load_dwordx4 v[132:135], v240, s[20:23], s3 offen offset:1024
    buffer_load_dwordx4 v[136:139], v240, s[20:23], s3 offen offset:2048
    buffer_load_dwordx4 v[140:143], v240, s[20:23], s3 offen offset:3072
    buffer_load_dwordx4 v[144:147], v240, s[20:23], s4 offen offset:0
concat_heads__gqa_block_cached__gqa_block_cached__near_ridge_kernel_nopf:
    s_nop 1
    v_mov_b32 v240, v235
    v_mov_b32 v241, v237
    s_nop 0
    v_permlane32_swap_b32 v235, v240
    v_permlane32_swap_b32 v237, v241
    v_add_f32 v235, v235, v240
    v_add_f32 v237, v237, v241
    v_mov_b32 v240, v235
    v_rcp_f32 v237, v237
    s_nop 0
    v_permlane16_swap_b32 v235, v240
    v_add_f32 v235, v235, v240
    v_and_b32 v240, 15, v254
    v_lshrrev_b32 v241, 4, v254
    s_mul_i32 s3, s28, 8448
    s_add_u32 s3, s3, 16384
    s_movk_i32 s4, 528
    v_mul_lo_u32 v242, v240, s4
    v_lshl_add_u32 v243, v241, 4, v242
    v_add_u32 v243, s3, v243
    ds_write_b128 v243, v[192:195] offset:0
    ds_write_b128 v243, v[196:199] offset:64
    ds_write_b128 v243, v[200:203] offset:128
    ds_write_b128 v243, v[204:207] offset:192
    ds_write_b128 v243, v[208:211] offset:256
    ds_write_b128 v243, v[212:215] offset:320
    ds_write_b128 v243, v[216:219] offset:384
    ds_write_b128 v243, v[220:223] offset:448
    s_lshl_b32 s3, s28, 7
    s_add_u32 s3, s3, 4096
    v_lshlrev_b32 v243, 3, v240
    v_add_u32 v245, s3, v243
    v_mov_b32 v234, v239
    ds_write_b64 v245, v[234:235] offset:0
    s_mul_i32 s3, s29, 72
    s_lshl_b32 s4, s30, 2
    s_add_u32 s4, s4, s3
    s_add_u32 s4, s4, s28
    s_lshl_b32 s4, s4, 18
    s_lshl_b32 s5, s31, 13
    s_add_u32 s40, s4, s5
    s_add_u32 s41, s40, 4096
    s_lshr_b32 s4, s30, 1
    s_add_u32 s4, s4, s3
    s_add_u32 s4, s4, 64
    s_lshl_b32 s4, s4, 18
    s_add_u32 s42, s4, s5
    v_lshlrev_b32 v255, 4, v254
    v_mul_f32 v0, v0, v237
    v_mul_f32 v1, v1, v237
    v_mul_f32 v2, v2, v237
    v_mul_f32 v3, v3, v237
    v_mul_f32 v4, v4, v237
    v_mul_f32 v5, v5, v237
    v_mul_f32 v6, v6, v237
    v_mul_f32 v7, v7, v237
    v_cvt_pk_bf16_f32 v0, v0, v1
    v_cvt_pk_bf16_f32 v1, v2, v3
    v_cvt_pk_bf16_f32 v2, v4, v5
    v_cvt_pk_bf16_f32 v3, v6, v7
    buffer_store_dwordx4 v[0:3], v255, s[24:27], s40 offen offset:0
    v_mul_f32 v8, v8, v237
    v_mul_f32 v9, v9, v237
    v_mul_f32 v10, v10, v237
    v_mul_f32 v11, v11, v237
    v_mul_f32 v12, v12, v237
    v_mul_f32 v13, v13, v237
    v_mul_f32 v14, v14, v237
    v_mul_f32 v15, v15, v237
    v_cvt_pk_bf16_f32 v8, v8, v9
    v_cvt_pk_bf16_f32 v9, v10, v11
    v_cvt_pk_bf16_f32 v10, v12, v13
    v_cvt_pk_bf16_f32 v11, v14, v15
    buffer_store_dwordx4 v[8:11], v255, s[24:27], s40 offen offset:1024
    v_mul_f32 v16, v16, v237
    v_mul_f32 v17, v17, v237
    v_mul_f32 v18, v18, v237
    v_mul_f32 v19, v19, v237
    v_mul_f32 v20, v20, v237
    v_mul_f32 v21, v21, v237
    v_mul_f32 v22, v22, v237
    v_mul_f32 v23, v23, v237
    v_cvt_pk_bf16_f32 v16, v16, v17
    v_cvt_pk_bf16_f32 v17, v18, v19
    v_cvt_pk_bf16_f32 v18, v20, v21
    v_cvt_pk_bf16_f32 v19, v22, v23
    buffer_store_dwordx4 v[16:19], v255, s[24:27], s40 offen offset:2048
    v_mul_f32 v24, v24, v237
    v_mul_f32 v25, v25, v237
    v_mul_f32 v26, v26, v237
    v_mul_f32 v27, v27, v237
    v_mul_f32 v28, v28, v237
    v_mul_f32 v29, v29, v237
    v_mul_f32 v30, v30, v237
    v_mul_f32 v31, v31, v237
    v_cvt_pk_bf16_f32 v24, v24, v25
    v_cvt_pk_bf16_f32 v25, v26, v27
    v_cvt_pk_bf16_f32 v26, v28, v29
    v_cvt_pk_bf16_f32 v27, v30, v31
    buffer_store_dwordx4 v[24:27], v255, s[24:27], s40 offen offset:3072
    v_mul_f32 v32, v32, v237
    v_mul_f32 v33, v33, v237
    v_mul_f32 v34, v34, v237
    v_mul_f32 v35, v35, v237
    v_mul_f32 v36, v36, v237
    v_mul_f32 v37, v37, v237
    v_mul_f32 v38, v38, v237
    v_mul_f32 v39, v39, v237
    v_cvt_pk_bf16_f32 v32, v32, v33
    v_cvt_pk_bf16_f32 v33, v34, v35
    v_cvt_pk_bf16_f32 v34, v36, v37
    v_cvt_pk_bf16_f32 v35, v38, v39
    buffer_store_dwordx4 v[32:35], v255, s[24:27], s41 offen offset:0
    v_mul_f32 v40, v40, v237
    v_mul_f32 v41, v41, v237
    v_mul_f32 v42, v42, v237
    v_mul_f32 v43, v43, v237
    v_mul_f32 v44, v44, v237
    v_mul_f32 v45, v45, v237
    v_mul_f32 v46, v46, v237
    v_mul_f32 v47, v47, v237
    v_cvt_pk_bf16_f32 v40, v40, v41
    v_cvt_pk_bf16_f32 v41, v42, v43
    v_cvt_pk_bf16_f32 v42, v44, v45
    v_cvt_pk_bf16_f32 v43, v46, v47
    buffer_store_dwordx4 v[40:43], v255, s[24:27], s41 offen offset:1024
    v_mul_f32 v48, v48, v237
    v_mul_f32 v49, v49, v237
    v_mul_f32 v50, v50, v237
    v_mul_f32 v51, v51, v237
    v_mul_f32 v52, v52, v237
    v_mul_f32 v53, v53, v237
    v_mul_f32 v54, v54, v237
    v_mul_f32 v55, v55, v237
    v_cvt_pk_bf16_f32 v48, v48, v49
    v_cvt_pk_bf16_f32 v49, v50, v51
    v_cvt_pk_bf16_f32 v50, v52, v53
    v_cvt_pk_bf16_f32 v51, v54, v55
    buffer_store_dwordx4 v[48:51], v255, s[24:27], s41 offen offset:2048
    v_mul_f32 v56, v56, v237
    v_mul_f32 v57, v57, v237
    v_mul_f32 v58, v58, v237
    v_mul_f32 v59, v59, v237
    v_mul_f32 v60, v60, v237
    v_mul_f32 v61, v61, v237
    v_mul_f32 v62, v62, v237
    v_mul_f32 v63, v63, v237
    v_cvt_pk_bf16_f32 v56, v56, v57
    v_cvt_pk_bf16_f32 v57, v58, v59
    v_cvt_pk_bf16_f32 v58, v60, v61
    v_cvt_pk_bf16_f32 v59, v62, v63
    buffer_store_dwordx4 v[56:59], v255, s[24:27], s41 offen offset:3072
    s_waitcnt lgkmcnt(0)
    s_barrier
    v_lshlrev_b32 v243, 3, v240
    v_add_u32 v243, 4096, v243
    ds_read_b64 v[64:65], v243 offset:0
    ds_read_b64 v[66:67], v243 offset:128
    ds_read_b64 v[68:69], v243 offset:256
    ds_read_b64 v[70:71], v243 offset:384
    s_lshl_b32 s3, s28, 7
    v_lshl_add_u32 v242, v241, 5, v242
    v_add_u32 v242, s3, v242
    ds_read_b128 v[160:163], v242 offset:16384
    ds_read_b128 v[164:167], v242 offset:16400
    ds_read_b128 v[168:171], v242 offset:24832
    ds_read_b128 v[172:175], v242 offset:24848
    ds_read_b128 v[176:179], v242 offset:33280
    ds_read_b128 v[180:183], v242 offset:33296
    ds_read_b128 v[184:187], v242 offset:41728
    ds_read_b128 v[188:191], v242 offset:41744
    s_waitcnt lgkmcnt(8)
    v_max3_f32 v72, v64, v66, v68
    v_max_f32 v72, v72, v70
    v_sub_f32 v64, v64, v72
    v_sub_f32 v66, v66, v72
    v_sub_f32 v68, v68, v72
    v_sub_f32 v70, v70, v72
    v_exp_f32 v64, v64
    v_exp_f32 v66, v66
    v_exp_f32 v68, v68
    v_exp_f32 v70, v70
    v_mul_f32 v73, v64, v65
    v_fmac_f32 v73, v66, v67
    v_fmac_f32 v73, v68, v69
    v_fmac_f32 v73, v70, v71
    v_rcp_f32 v73, v73
    s_nop 0
    v_mul_f32 v64, v64, v73
    v_mul_f32 v66, v66, v73
    v_mul_f32 v68, v68, v73
    v_mul_f32 v70, v70, v73
    s_waitcnt lgkmcnt(0)
    v_mul_f32 v160, v160, v64
    v_fmac_f32 v160, v168, v66
    v_fmac_f32 v160, v176, v68
    v_fmac_f32 v160, v184, v70
    v_mul_f32 v161, v161, v64
    v_fmac_f32 v161, v169, v66
    v_fmac_f32 v161, v177, v68
    v_fmac_f32 v161, v185, v70
    v_mul_f32 v162, v162, v64
    v_fmac_f32 v162, v170, v66
    v_fmac_f32 v162, v178, v68
    v_fmac_f32 v162, v186, v70
    v_mul_f32 v163, v163, v64
    v_fmac_f32 v163, v171, v66
    v_fmac_f32 v163, v179, v68
    v_fmac_f32 v163, v187, v70
    v_mul_f32 v164, v164, v64
    v_fmac_f32 v164, v172, v66
    v_fmac_f32 v164, v180, v68
    v_fmac_f32 v164, v188, v70
    v_mul_f32 v165, v165, v64
    v_fmac_f32 v165, v173, v66
    v_fmac_f32 v165, v181, v68
    v_fmac_f32 v165, v189, v70
    v_mul_f32 v166, v166, v64
    v_fmac_f32 v166, v174, v66
    v_fmac_f32 v166, v182, v68
    v_fmac_f32 v166, v190, v70
    v_mul_f32 v167, v167, v64
    v_fmac_f32 v167, v175, v66
    v_fmac_f32 v167, v183, v68
    v_fmac_f32 v167, v191, v70
    v_cvt_pk_bf16_f32 v160, v160, v161
    v_cvt_pk_bf16_f32 v161, v162, v163
    v_cvt_pk_bf16_f32 v162, v164, v165
    v_cvt_pk_bf16_f32 v163, v166, v167
    s_and_b32 s3, s30, 1
    s_lshl_b32 s3, s3, 8
    s_lshl_b32 s4, s28, 11
    s_add_u32 s3, s3, s4
    v_lshlrev_b32 v242, 9, v241
    v_lshl_add_u32 v242, v240, 4, v242
    v_add_u32 v242, s3, v242
    buffer_store_dwordx4 v[160:163], v242, s[24:27], s42 offen offset:0
concat_heads__gqa_block_cached__gqa_block_cached__near_ridge_kernel_end:
    s_endpgm
concat_heads__gqa_block_cached__gqa_block_cached__near_ridge_kernel_rs1:
    s_nop 15
    v_max_f32 v240, v240, v236
    v_max_f32 v242, v242, v234
    v_sub_f32 v241, v236, v240
    v_sub_f32 v243, v234, v242
    v_mul_f32 v241, s37, v241
    v_mul_f32 v243, s37, v243
    v_exp_f32 v241, v241
    v_exp_f32 v243, v243
    v_mov_b32 v236, v240
    v_mov_b32 v234, v242
    v_mul_f32 v238, s37, v240
    v_mul_f32 v239, s37, v242
    v_mul_f32 v237, v237, v241
    v_mul_f32 v235, v235, v243
    v_mul_f32 v0, v0, v241
    v_mul_f32 v1, v1, v241
    v_mul_f32 v2, v2, v241
    v_mul_f32 v3, v3, v241
    v_mul_f32 v4, v4, v241
    v_mul_f32 v5, v5, v241
    v_mul_f32 v6, v6, v241
    v_mul_f32 v7, v7, v241
    v_mul_f32 v8, v8, v241
    v_mul_f32 v9, v9, v241
    v_mul_f32 v10, v10, v241
    v_mul_f32 v11, v11, v241
    v_mul_f32 v12, v12, v241
    v_mul_f32 v13, v13, v241
    v_mul_f32 v14, v14, v241
    v_mul_f32 v15, v15, v241
    v_mul_f32 v16, v16, v241
    v_mul_f32 v17, v17, v241
    v_mul_f32 v18, v18, v241
    v_mul_f32 v19, v19, v241
    v_mul_f32 v20, v20, v241
    v_mul_f32 v21, v21, v241
    v_mul_f32 v22, v22, v241
    v_mul_f32 v23, v23, v241
    v_mul_f32 v24, v24, v241
    v_mul_f32 v25, v25, v241
    v_mul_f32 v26, v26, v241
    v_mul_f32 v27, v27, v241
    v_mul_f32 v28, v28, v241
    v_mul_f32 v29, v29, v241
    v_mul_f32 v30, v30, v241
    v_mul_f32 v31, v31, v241
    v_mul_f32 v32, v32, v241
    v_mul_f32 v33, v33, v241
    v_mul_f32 v34, v34, v241
    v_mul_f32 v35, v35, v241
    v_mul_f32 v36, v36, v241
    v_mul_f32 v37, v37, v241
    v_mul_f32 v38, v38, v241
    v_mul_f32 v39, v39, v241
    v_mul_f32 v40, v40, v241
    v_mul_f32 v41, v41, v241
    v_mul_f32 v42, v42, v241
    v_mul_f32 v43, v43, v241
    v_mul_f32 v44, v44, v241
    v_mul_f32 v45, v45, v241
    v_mul_f32 v46, v46, v241
    v_mul_f32 v47, v47, v241
    v_mul_f32 v48, v48, v241
    v_mul_f32 v49, v49, v241
    v_mul_f32 v50, v50, v241
    v_mul_f32 v51, v51, v241
    v_mul_f32 v52, v52, v241
    v_mul_f32 v53, v53, v241
    v_mul_f32 v54, v54, v241
    v_mul_f32 v55, v55, v241
    v_mul_f32 v56, v56, v241
    v_mul_f32 v57, v57, v241
    v_mul_f32 v58, v58, v241
    v_mul_f32 v59, v59, v241
    v_mul_f32 v60, v60, v241
    v_mul_f32 v61, v61, v241
    v_mul_f32 v62, v62, v241
    v_mul_f32 v63, v63, v241
    v_mul_f32 v192, v192, v243
    v_mul_f32 v193, v193, v243
    v_mul_f32 v194, v194, v243
    v_mul_f32 v195, v195, v243
    v_mul_f32 v196, v196, v243
    v_mul_f32 v197, v197, v243
    v_mul_f32 v198, v198, v243
    v_mul_f32 v199, v199, v243
    v_mul_f32 v200, v200, v243
    v_mul_f32 v201, v201, v243
    v_mul_f32 v202, v202, v243
    v_mul_f32 v203, v203, v243
    v_mul_f32 v204, v204, v243
    v_mul_f32 v205, v205, v243
    v_mul_f32 v206, v206, v243
    v_mul_f32 v207, v207, v243
    v_mul_f32 v208, v208, v243
    v_mul_f32 v209, v209, v243
    v_mul_f32 v210, v210, v243
    v_mul_f32 v211, v211, v243
    v_mul_f32 v212, v212, v243
    v_mul_f32 v213, v213, v243
    v_mul_f32 v214, v214, v243
    v_mul_f32 v215, v215, v243
    v_mul_f32 v216, v216, v243
    v_mul_f32 v217, v217, v243
    v_mul_f32 v218, v218, v243
    v_mul_f32 v219, v219, v243
    v_mul_f32 v220, v220, v243
    v_mul_f32 v221, v221, v243
    v_mul_f32 v222, v222, v243
    v_mul_f32 v223, v223, v243
    s_nop 3
    s_branch concat_heads__gqa_block_cached__gqa_block_cached__near_ridge_kernel_rb1
concat_heads__gqa_block_cached__gqa_block_cached__near_ridge_kernel_rs2:
    s_nop 15
    v_max_f32 v240, v240, v236
    v_max_f32 v242, v242, v234
    v_sub_f32 v241, v236, v240
    v_sub_f32 v243, v234, v242
    v_mul_f32 v241, s37, v241
    v_mul_f32 v243, s37, v243
    v_exp_f32 v241, v241
    v_exp_f32 v243, v243
    v_mov_b32 v236, v240
    v_mov_b32 v234, v242
    v_mul_f32 v238, s37, v240
    v_mul_f32 v239, s37, v242
    v_mul_f32 v237, v237, v241
    v_mul_f32 v235, v235, v243
    v_mul_f32 v0, v0, v241
    v_mul_f32 v1, v1, v241
    v_mul_f32 v2, v2, v241
    v_mul_f32 v3, v3, v241
    v_mul_f32 v4, v4, v241
    v_mul_f32 v5, v5, v241
    v_mul_f32 v6, v6, v241
    v_mul_f32 v7, v7, v241
    v_mul_f32 v8, v8, v241
    v_mul_f32 v9, v9, v241
    v_mul_f32 v10, v10, v241
    v_mul_f32 v11, v11, v241
    v_mul_f32 v12, v12, v241
    v_mul_f32 v13, v13, v241
    v_mul_f32 v14, v14, v241
    v_mul_f32 v15, v15, v241
    v_mul_f32 v16, v16, v241
    v_mul_f32 v17, v17, v241
    v_mul_f32 v18, v18, v241
    v_mul_f32 v19, v19, v241
    v_mul_f32 v20, v20, v241
    v_mul_f32 v21, v21, v241
    v_mul_f32 v22, v22, v241
    v_mul_f32 v23, v23, v241
    v_mul_f32 v24, v24, v241
    v_mul_f32 v25, v25, v241
    v_mul_f32 v26, v26, v241
    v_mul_f32 v27, v27, v241
    v_mul_f32 v28, v28, v241
    v_mul_f32 v29, v29, v241
    v_mul_f32 v30, v30, v241
    v_mul_f32 v31, v31, v241
    v_mul_f32 v32, v32, v241
    v_mul_f32 v33, v33, v241
    v_mul_f32 v34, v34, v241
    v_mul_f32 v35, v35, v241
    v_mul_f32 v36, v36, v241
    v_mul_f32 v37, v37, v241
    v_mul_f32 v38, v38, v241
    v_mul_f32 v39, v39, v241
    v_mul_f32 v40, v40, v241
    v_mul_f32 v41, v41, v241
    v_mul_f32 v42, v42, v241
    v_mul_f32 v43, v43, v241
    v_mul_f32 v44, v44, v241
    v_mul_f32 v45, v45, v241
    v_mul_f32 v46, v46, v241
    v_mul_f32 v47, v47, v241
    v_mul_f32 v48, v48, v241
    v_mul_f32 v49, v49, v241
    v_mul_f32 v50, v50, v241
    v_mul_f32 v51, v51, v241
    v_mul_f32 v52, v52, v241
    v_mul_f32 v53, v53, v241
    v_mul_f32 v54, v54, v241
    v_mul_f32 v55, v55, v241
    v_mul_f32 v56, v56, v241
    v_mul_f32 v57, v57, v241
    v_mul_f32 v58, v58, v241
    v_mul_f32 v59, v59, v241
    v_mul_f32 v60, v60, v241
    v_mul_f32 v61, v61, v241
    v_mul_f32 v62, v62, v241
    v_mul_f32 v63, v63, v241
    v_mul_f32 v192, v192, v243
    v_mul_f32 v193, v193, v243
    v_mul_f32 v194, v194, v243
    v_mul_f32 v195, v195, v243
    v_mul_f32 v196, v196, v243
    v_mul_f32 v197, v197, v243
    v_mul_f32 v198, v198, v243
    v_mul_f32 v199, v199, v243
    v_mul_f32 v200, v200, v243
    v_mul_f32 v201, v201, v243
    v_mul_f32 v202, v202, v243
    v_mul_f32 v203, v203, v243
    v_mul_f32 v204, v204, v243
    v_mul_f32 v205, v205, v243
    v_mul_f32 v206, v206, v243
    v_mul_f32 v207, v207, v243
    v_mul_f32 v208, v208, v243
    v_mul_f32 v209, v209, v243
    v_mul_f32 v210, v210, v243
    v_mul_f32 v211, v211, v243
    v_mul_f32 v212, v212, v243
    v_mul_f32 v213, v213, v243
    v_mul_f32 v214, v214, v243
    v_mul_f32 v215, v215, v243
    v_mul_f32 v216, v216, v243
    v_mul_f32 v217, v217, v243
    v_mul_f32 v218, v218, v243
    v_mul_f32 v219, v219, v243
    v_mul_f32 v220, v220, v243
    v_mul_f32 v221, v221, v243
    v_mul_f32 v222, v222, v243
    v_mul_f32 v223, v223, v243
    s_nop 3
    s_branch concat_heads__gqa_block_cached__gqa_block_cached__near_ridge_kernel_rb2
concat_heads__gqa_block_cached__gqa_block_cached__near_ridge_kernel_rs3:
    s_nop 15
    v_max_f32 v240, v240, v236
    v_max_f32 v242, v242, v234
    v_sub_f32 v241, v236, v240
    v_sub_f32 v243, v234, v242
    v_mul_f32 v241, s37, v241
    v_mul_f32 v243, s37, v243
    v_exp_f32 v241, v241
    v_exp_f32 v243, v243
    v_mov_b32 v236, v240
    v_mov_b32 v234, v242
    v_mul_f32 v238, s37, v240
    v_mul_f32 v239, s37, v242
    v_mul_f32 v237, v237, v241
    v_mul_f32 v235, v235, v243
    v_mul_f32 v0, v0, v241
    v_mul_f32 v1, v1, v241
    v_mul_f32 v2, v2, v241
    v_mul_f32 v3, v3, v241
    v_mul_f32 v4, v4, v241
    v_mul_f32 v5, v5, v241
    v_mul_f32 v6, v6, v241
    v_mul_f32 v7, v7, v241
    v_mul_f32 v8, v8, v241
    v_mul_f32 v9, v9, v241
    v_mul_f32 v10, v10, v241
    v_mul_f32 v11, v11, v241
    v_mul_f32 v12, v12, v241
    v_mul_f32 v13, v13, v241
    v_mul_f32 v14, v14, v241
    v_mul_f32 v15, v15, v241
    v_mul_f32 v16, v16, v241
    v_mul_f32 v17, v17, v241
    v_mul_f32 v18, v18, v241
    v_mul_f32 v19, v19, v241
    v_mul_f32 v20, v20, v241
    v_mul_f32 v21, v21, v241
    v_mul_f32 v22, v22, v241
    v_mul_f32 v23, v23, v241
    v_mul_f32 v24, v24, v241
    v_mul_f32 v25, v25, v241
    v_mul_f32 v26, v26, v241
    v_mul_f32 v27, v27, v241
    v_mul_f32 v28, v28, v241
    v_mul_f32 v29, v29, v241
    v_mul_f32 v30, v30, v241
    v_mul_f32 v31, v31, v241
    v_mul_f32 v32, v32, v241
    v_mul_f32 v33, v33, v241
    v_mul_f32 v34, v34, v241
    v_mul_f32 v35, v35, v241
    v_mul_f32 v36, v36, v241
    v_mul_f32 v37, v37, v241
    v_mul_f32 v38, v38, v241
    v_mul_f32 v39, v39, v241
    v_mul_f32 v40, v40, v241
    v_mul_f32 v41, v41, v241
    v_mul_f32 v42, v42, v241
    v_mul_f32 v43, v43, v241
    v_mul_f32 v44, v44, v241
    v_mul_f32 v45, v45, v241
    v_mul_f32 v46, v46, v241
    v_mul_f32 v47, v47, v241
    v_mul_f32 v48, v48, v241
    v_mul_f32 v49, v49, v241
    v_mul_f32 v50, v50, v241
    v_mul_f32 v51, v51, v241
    v_mul_f32 v52, v52, v241
    v_mul_f32 v53, v53, v241
    v_mul_f32 v54, v54, v241
    v_mul_f32 v55, v55, v241
    v_mul_f32 v56, v56, v241
    v_mul_f32 v57, v57, v241
    v_mul_f32 v58, v58, v241
    v_mul_f32 v59, v59, v241
    v_mul_f32 v60, v60, v241
    v_mul_f32 v61, v61, v241
    v_mul_f32 v62, v62, v241
    v_mul_f32 v63, v63, v241
    v_mul_f32 v192, v192, v243
    v_mul_f32 v193, v193, v243
    v_mul_f32 v194, v194, v243
    v_mul_f32 v195, v195, v243
    v_mul_f32 v196, v196, v243
    v_mul_f32 v197, v197, v243
    v_mul_f32 v198, v198, v243
    v_mul_f32 v199, v199, v243
    v_mul_f32 v200, v200, v243
    v_mul_f32 v201, v201, v243
    v_mul_f32 v202, v202, v243
    v_mul_f32 v203, v203, v243
    v_mul_f32 v204, v204, v243
    v_mul_f32 v205, v205, v243
    v_mul_f32 v206, v206, v243
    v_mul_f32 v207, v207, v243
    v_mul_f32 v208, v208, v243
    v_mul_f32 v209, v209, v243
    v_mul_f32 v210, v210, v243
    v_mul_f32 v211, v211, v243
    v_mul_f32 v212, v212, v243
    v_mul_f32 v213, v213, v243
    v_mul_f32 v214, v214, v243
    v_mul_f32 v215, v215, v243
    v_mul_f32 v216, v216, v243
    v_mul_f32 v217, v217, v243
    v_mul_f32 v218, v218, v243
    v_mul_f32 v219, v219, v243
    v_mul_f32 v220, v220, v243
    v_mul_f32 v221, v221, v243
    v_mul_f32 v222, v222, v243
    v_mul_f32 v223, v223, v243
    s_nop 3
    s_branch concat_heads__gqa_block_cached__gqa_block_cached__near_ridge_kernel_rb3
concat_heads__gqa_block_cached__gqa_block_cached__near_ridge_kernel_rs4:
    s_nop 15
    v_max_f32 v240, v240, v236
    v_max_f32 v242, v242, v234
    v_sub_f32 v241, v236, v240
    v_sub_f32 v243, v234, v242
    v_mul_f32 v241, s37, v241
    v_mul_f32 v243, s37, v243
    v_exp_f32 v241, v241
    v_exp_f32 v243, v243
    v_mov_b32 v236, v240
    v_mov_b32 v234, v242
    v_mul_f32 v238, s37, v240
    v_mul_f32 v239, s37, v242
    v_mul_f32 v237, v237, v241
    v_mul_f32 v235, v235, v243
    v_mul_f32 v0, v0, v241
    v_mul_f32 v1, v1, v241
    v_mul_f32 v2, v2, v241
    v_mul_f32 v3, v3, v241
    v_mul_f32 v4, v4, v241
    v_mul_f32 v5, v5, v241
    v_mul_f32 v6, v6, v241
    v_mul_f32 v7, v7, v241
    v_mul_f32 v8, v8, v241
    v_mul_f32 v9, v9, v241
    v_mul_f32 v10, v10, v241
    v_mul_f32 v11, v11, v241
    v_mul_f32 v12, v12, v241
    v_mul_f32 v13, v13, v241
    v_mul_f32 v14, v14, v241
    v_mul_f32 v15, v15, v241
    v_mul_f32 v16, v16, v241
    v_mul_f32 v17, v17, v241
    v_mul_f32 v18, v18, v241
    v_mul_f32 v19, v19, v241
    v_mul_f32 v20, v20, v241
    v_mul_f32 v21, v21, v241
    v_mul_f32 v22, v22, v241
    v_mul_f32 v23, v23, v241
    v_mul_f32 v24, v24, v241
    v_mul_f32 v25, v25, v241
    v_mul_f32 v26, v26, v241
    v_mul_f32 v27, v27, v241
    v_mul_f32 v28, v28, v241
    v_mul_f32 v29, v29, v241
    v_mul_f32 v30, v30, v241
    v_mul_f32 v31, v31, v241
    v_mul_f32 v32, v32, v241
    v_mul_f32 v33, v33, v241
    v_mul_f32 v34, v34, v241
    v_mul_f32 v35, v35, v241
    v_mul_f32 v36, v36, v241
    v_mul_f32 v37, v37, v241
    v_mul_f32 v38, v38, v241
    v_mul_f32 v39, v39, v241
    v_mul_f32 v40, v40, v241
    v_mul_f32 v41, v41, v241
    v_mul_f32 v42, v42, v241
    v_mul_f32 v43, v43, v241
    v_mul_f32 v44, v44, v241
    v_mul_f32 v45, v45, v241
    v_mul_f32 v46, v46, v241
    v_mul_f32 v47, v47, v241
    v_mul_f32 v48, v48, v241
    v_mul_f32 v49, v49, v241
    v_mul_f32 v50, v50, v241
    v_mul_f32 v51, v51, v241
    v_mul_f32 v52, v52, v241
    v_mul_f32 v53, v53, v241
    v_mul_f32 v54, v54, v241
    v_mul_f32 v55, v55, v241
    v_mul_f32 v56, v56, v241
    v_mul_f32 v57, v57, v241
    v_mul_f32 v58, v58, v241
    v_mul_f32 v59, v59, v241
    v_mul_f32 v60, v60, v241
    v_mul_f32 v61, v61, v241
    v_mul_f32 v62, v62, v241
    v_mul_f32 v63, v63, v241
    v_mul_f32 v192, v192, v243
    v_mul_f32 v193, v193, v243
    v_mul_f32 v194, v194, v243
    v_mul_f32 v195, v195, v243
    v_mul_f32 v196, v196, v243
    v_mul_f32 v197, v197, v243
    v_mul_f32 v198, v198, v243
    v_mul_f32 v199, v199, v243
    v_mul_f32 v200, v200, v243
    v_mul_f32 v201, v201, v243
    v_mul_f32 v202, v202, v243
    v_mul_f32 v203, v203, v243
    v_mul_f32 v204, v204, v243
    v_mul_f32 v205, v205, v243
    v_mul_f32 v206, v206, v243
    v_mul_f32 v207, v207, v243
    v_mul_f32 v208, v208, v243
    v_mul_f32 v209, v209, v243
    v_mul_f32 v210, v210, v243
    v_mul_f32 v211, v211, v243
    v_mul_f32 v212, v212, v243
    v_mul_f32 v213, v213, v243
    v_mul_f32 v214, v214, v243
    v_mul_f32 v215, v215, v243
    v_mul_f32 v216, v216, v243
    v_mul_f32 v217, v217, v243
    v_mul_f32 v218, v218, v243
    v_mul_f32 v219, v219, v243
    v_mul_f32 v220, v220, v243
    v_mul_f32 v221, v221, v243
    v_mul_f32 v222, v222, v243
    v_mul_f32 v223, v223, v243
    s_nop 3
    s_branch concat_heads__gqa_block_cached__gqa_block_cached__near_ridge_kernel_rb4
concat_heads__gqa_block_cached__gqa_block_cached__near_ridge_kernel_rs5:
    s_nop 15
    v_max_f32 v240, v240, v236
    v_max_f32 v242, v242, v234
    v_sub_f32 v241, v236, v240
    v_sub_f32 v243, v234, v242
    v_mul_f32 v241, s37, v241
    v_mul_f32 v243, s37, v243
    v_exp_f32 v241, v241
    v_exp_f32 v243, v243
    v_mov_b32 v236, v240
    v_mov_b32 v234, v242
    v_mul_f32 v238, s37, v240
    v_mul_f32 v239, s37, v242
    v_mul_f32 v237, v237, v241
    v_mul_f32 v235, v235, v243
    v_mul_f32 v0, v0, v241
    v_mul_f32 v1, v1, v241
    v_mul_f32 v2, v2, v241
    v_mul_f32 v3, v3, v241
    v_mul_f32 v4, v4, v241
    v_mul_f32 v5, v5, v241
    v_mul_f32 v6, v6, v241
    v_mul_f32 v7, v7, v241
    v_mul_f32 v8, v8, v241
    v_mul_f32 v9, v9, v241
    v_mul_f32 v10, v10, v241
    v_mul_f32 v11, v11, v241
    v_mul_f32 v12, v12, v241
    v_mul_f32 v13, v13, v241
    v_mul_f32 v14, v14, v241
    v_mul_f32 v15, v15, v241
    v_mul_f32 v16, v16, v241
    v_mul_f32 v17, v17, v241
    v_mul_f32 v18, v18, v241
    v_mul_f32 v19, v19, v241
    v_mul_f32 v20, v20, v241
    v_mul_f32 v21, v21, v241
    v_mul_f32 v22, v22, v241
    v_mul_f32 v23, v23, v241
    v_mul_f32 v24, v24, v241
    v_mul_f32 v25, v25, v241
    v_mul_f32 v26, v26, v241
    v_mul_f32 v27, v27, v241
    v_mul_f32 v28, v28, v241
    v_mul_f32 v29, v29, v241
    v_mul_f32 v30, v30, v241
    v_mul_f32 v31, v31, v241
    v_mul_f32 v32, v32, v241
    v_mul_f32 v33, v33, v241
    v_mul_f32 v34, v34, v241
    v_mul_f32 v35, v35, v241
    v_mul_f32 v36, v36, v241
    v_mul_f32 v37, v37, v241
    v_mul_f32 v38, v38, v241
    v_mul_f32 v39, v39, v241
    v_mul_f32 v40, v40, v241
    v_mul_f32 v41, v41, v241
    v_mul_f32 v42, v42, v241
    v_mul_f32 v43, v43, v241
    v_mul_f32 v44, v44, v241
    v_mul_f32 v45, v45, v241
    v_mul_f32 v46, v46, v241
    v_mul_f32 v47, v47, v241
    v_mul_f32 v48, v48, v241
    v_mul_f32 v49, v49, v241
    v_mul_f32 v50, v50, v241
    v_mul_f32 v51, v51, v241
    v_mul_f32 v52, v52, v241
    v_mul_f32 v53, v53, v241
    v_mul_f32 v54, v54, v241
    v_mul_f32 v55, v55, v241
    v_mul_f32 v56, v56, v241
    v_mul_f32 v57, v57, v241
    v_mul_f32 v58, v58, v241
    v_mul_f32 v59, v59, v241
    v_mul_f32 v60, v60, v241
    v_mul_f32 v61, v61, v241
    v_mul_f32 v62, v62, v241
    v_mul_f32 v63, v63, v241
    v_mul_f32 v192, v192, v243
    v_mul_f32 v193, v193, v243
    v_mul_f32 v194, v194, v243
    v_mul_f32 v195, v195, v243
    v_mul_f32 v196, v196, v243
    v_mul_f32 v197, v197, v243
    v_mul_f32 v198, v198, v243
    v_mul_f32 v199, v199, v243
    v_mul_f32 v200, v200, v243
    v_mul_f32 v201, v201, v243
    v_mul_f32 v202, v202, v243
    v_mul_f32 v203, v203, v243
    v_mul_f32 v204, v204, v243
    v_mul_f32 v205, v205, v243
    v_mul_f32 v206, v206, v243
    v_mul_f32 v207, v207, v243
    v_mul_f32 v208, v208, v243
    v_mul_f32 v209, v209, v243
    v_mul_f32 v210, v210, v243
    v_mul_f32 v211, v211, v243
    v_mul_f32 v212, v212, v243
    v_mul_f32 v213, v213, v243
    v_mul_f32 v214, v214, v243
    v_mul_f32 v215, v215, v243
    v_mul_f32 v216, v216, v243
    v_mul_f32 v217, v217, v243
    v_mul_f32 v218, v218, v243
    v_mul_f32 v219, v219, v243
    v_mul_f32 v220, v220, v243
    v_mul_f32 v221, v221, v243
    v_mul_f32 v222, v222, v243
    v_mul_f32 v223, v223, v243
    s_nop 3
    s_branch concat_heads__gqa_block_cached__gqa_block_cached__near_ridge_kernel_rb5
concat_heads__gqa_block_cached__gqa_block_cached__near_ridge_kernel_rs6:
    s_nop 15
    v_max_f32 v240, v240, v236
    v_max_f32 v242, v242, v234
    v_sub_f32 v241, v236, v240
    v_sub_f32 v243, v234, v242
    v_mul_f32 v241, s37, v241
    v_mul_f32 v243, s37, v243
    v_exp_f32 v241, v241
    v_exp_f32 v243, v243
    v_mov_b32 v236, v240
    v_mov_b32 v234, v242
    v_mul_f32 v238, s37, v240
    v_mul_f32 v239, s37, v242
    v_mul_f32 v237, v237, v241
    v_mul_f32 v235, v235, v243
    v_mul_f32 v0, v0, v241
    v_mul_f32 v1, v1, v241
    v_mul_f32 v2, v2, v241
    v_mul_f32 v3, v3, v241
    v_mul_f32 v4, v4, v241
    v_mul_f32 v5, v5, v241
    v_mul_f32 v6, v6, v241
    v_mul_f32 v7, v7, v241
    v_mul_f32 v8, v8, v241
    v_mul_f32 v9, v9, v241
    v_mul_f32 v10, v10, v241
    v_mul_f32 v11, v11, v241
    v_mul_f32 v12, v12, v241
    v_mul_f32 v13, v13, v241
    v_mul_f32 v14, v14, v241
    v_mul_f32 v15, v15, v241
    v_mul_f32 v16, v16, v241
    v_mul_f32 v17, v17, v241
    v_mul_f32 v18, v18, v241
    v_mul_f32 v19, v19, v241
    v_mul_f32 v20, v20, v241
    v_mul_f32 v21, v21, v241
    v_mul_f32 v22, v22, v241
    v_mul_f32 v23, v23, v241
    v_mul_f32 v24, v24, v241
    v_mul_f32 v25, v25, v241
    v_mul_f32 v26, v26, v241
    v_mul_f32 v27, v27, v241
    v_mul_f32 v28, v28, v241
    v_mul_f32 v29, v29, v241
    v_mul_f32 v30, v30, v241
    v_mul_f32 v31, v31, v241
    v_mul_f32 v32, v32, v241
    v_mul_f32 v33, v33, v241
    v_mul_f32 v34, v34, v241
    v_mul_f32 v35, v35, v241
    v_mul_f32 v36, v36, v241
    v_mul_f32 v37, v37, v241
    v_mul_f32 v38, v38, v241
    v_mul_f32 v39, v39, v241
    v_mul_f32 v40, v40, v241
    v_mul_f32 v41, v41, v241
    v_mul_f32 v42, v42, v241
    v_mul_f32 v43, v43, v241
    v_mul_f32 v44, v44, v241
    v_mul_f32 v45, v45, v241
    v_mul_f32 v46, v46, v241
    v_mul_f32 v47, v47, v241
    v_mul_f32 v48, v48, v241
    v_mul_f32 v49, v49, v241
    v_mul_f32 v50, v50, v241
    v_mul_f32 v51, v51, v241
    v_mul_f32 v52, v52, v241
    v_mul_f32 v53, v53, v241
    v_mul_f32 v54, v54, v241
    v_mul_f32 v55, v55, v241
    v_mul_f32 v56, v56, v241
    v_mul_f32 v57, v57, v241
    v_mul_f32 v58, v58, v241
    v_mul_f32 v59, v59, v241
    v_mul_f32 v60, v60, v241
    v_mul_f32 v61, v61, v241
    v_mul_f32 v62, v62, v241
    v_mul_f32 v63, v63, v241
    v_mul_f32 v192, v192, v243
    v_mul_f32 v193, v193, v243
    v_mul_f32 v194, v194, v243
    v_mul_f32 v195, v195, v243
    v_mul_f32 v196, v196, v243
    v_mul_f32 v197, v197, v243
    v_mul_f32 v198, v198, v243
    v_mul_f32 v199, v199, v243
    v_mul_f32 v200, v200, v243
    v_mul_f32 v201, v201, v243
    v_mul_f32 v202, v202, v243
    v_mul_f32 v203, v203, v243
    v_mul_f32 v204, v204, v243
    v_mul_f32 v205, v205, v243
    v_mul_f32 v206, v206, v243
    v_mul_f32 v207, v207, v243
    v_mul_f32 v208, v208, v243
    v_mul_f32 v209, v209, v243
    v_mul_f32 v210, v210, v243
    v_mul_f32 v211, v211, v243
    v_mul_f32 v212, v212, v243
    v_mul_f32 v213, v213, v243
    v_mul_f32 v214, v214, v243
    v_mul_f32 v215, v215, v243
    v_mul_f32 v216, v216, v243
    v_mul_f32 v217, v217, v243
    v_mul_f32 v218, v218, v243
    v_mul_f32 v219, v219, v243
    v_mul_f32 v220, v220, v243
    v_mul_f32 v221, v221, v243
    v_mul_f32 v222, v222, v243
    v_mul_f32 v223, v223, v243
    s_nop 3
    s_branch concat_heads__gqa_block_cached__gqa_block_cached__near_ridge_kernel_rb6
concat_heads__gqa_block_cached__gqa_block_cached__near_ridge_kernel_rs7:
    s_nop 15
    v_max_f32 v240, v240, v236
    v_max_f32 v242, v242, v234
    v_sub_f32 v241, v236, v240
    v_sub_f32 v243, v234, v242
    v_mul_f32 v241, s37, v241
    v_mul_f32 v243, s37, v243
    v_exp_f32 v241, v241
    v_exp_f32 v243, v243
    v_mov_b32 v236, v240
    v_mov_b32 v234, v242
    v_mul_f32 v238, s37, v240
    v_mul_f32 v239, s37, v242
    v_mul_f32 v237, v237, v241
    v_mul_f32 v235, v235, v243
    v_mul_f32 v0, v0, v241
    v_mul_f32 v1, v1, v241
    v_mul_f32 v2, v2, v241
    v_mul_f32 v3, v3, v241
    v_mul_f32 v4, v4, v241
    v_mul_f32 v5, v5, v241
    v_mul_f32 v6, v6, v241
    v_mul_f32 v7, v7, v241
    v_mul_f32 v8, v8, v241
    v_mul_f32 v9, v9, v241
    v_mul_f32 v10, v10, v241
    v_mul_f32 v11, v11, v241
    v_mul_f32 v12, v12, v241
    v_mul_f32 v13, v13, v241
    v_mul_f32 v14, v14, v241
    v_mul_f32 v15, v15, v241
    v_mul_f32 v16, v16, v241
    v_mul_f32 v17, v17, v241
    v_mul_f32 v18, v18, v241
    v_mul_f32 v19, v19, v241
    v_mul_f32 v20, v20, v241
    v_mul_f32 v21, v21, v241
    v_mul_f32 v22, v22, v241
    v_mul_f32 v23, v23, v241
    v_mul_f32 v24, v24, v241
    v_mul_f32 v25, v25, v241
    v_mul_f32 v26, v26, v241
    v_mul_f32 v27, v27, v241
    v_mul_f32 v28, v28, v241
    v_mul_f32 v29, v29, v241
    v_mul_f32 v30, v30, v241
    v_mul_f32 v31, v31, v241
    v_mul_f32 v32, v32, v241
    v_mul_f32 v33, v33, v241
    v_mul_f32 v34, v34, v241
    v_mul_f32 v35, v35, v241
    v_mul_f32 v36, v36, v241
    v_mul_f32 v37, v37, v241
    v_mul_f32 v38, v38, v241
    v_mul_f32 v39, v39, v241
    v_mul_f32 v40, v40, v241
    v_mul_f32 v41, v41, v241
    v_mul_f32 v42, v42, v241
    v_mul_f32 v43, v43, v241
    v_mul_f32 v44, v44, v241
    v_mul_f32 v45, v45, v241
    v_mul_f32 v46, v46, v241
    v_mul_f32 v47, v47, v241
    v_mul_f32 v48, v48, v241
    v_mul_f32 v49, v49, v241
    v_mul_f32 v50, v50, v241
    v_mul_f32 v51, v51, v241
    v_mul_f32 v52, v52, v241
    v_mul_f32 v53, v53, v241
    v_mul_f32 v54, v54, v241
    v_mul_f32 v55, v55, v241
    v_mul_f32 v56, v56, v241
    v_mul_f32 v57, v57, v241
    v_mul_f32 v58, v58, v241
    v_mul_f32 v59, v59, v241
    v_mul_f32 v60, v60, v241
    v_mul_f32 v61, v61, v241
    v_mul_f32 v62, v62, v241
    v_mul_f32 v63, v63, v241
    v_mul_f32 v192, v192, v243
    v_mul_f32 v193, v193, v243
    v_mul_f32 v194, v194, v243
    v_mul_f32 v195, v195, v243
    v_mul_f32 v196, v196, v243
    v_mul_f32 v197, v197, v243
    v_mul_f32 v198, v198, v243
    v_mul_f32 v199, v199, v243
    v_mul_f32 v200, v200, v243
    v_mul_f32 v201, v201, v243
    v_mul_f32 v202, v202, v243
    v_mul_f32 v203, v203, v243
    v_mul_f32 v204, v204, v243
    v_mul_f32 v205, v205, v243
    v_mul_f32 v206, v206, v243
    v_mul_f32 v207, v207, v243
    v_mul_f32 v208, v208, v243
    v_mul_f32 v209, v209, v243
    v_mul_f32 v210, v210, v243
    v_mul_f32 v211, v211, v243
    v_mul_f32 v212, v212, v243
    v_mul_f32 v213, v213, v243
    v_mul_f32 v214, v214, v243
    v_mul_f32 v215, v215, v243
    v_mul_f32 v216, v216, v243
    v_mul_f32 v217, v217, v243
    v_mul_f32 v218, v218, v243
    v_mul_f32 v219, v219, v243
    v_mul_f32 v220, v220, v243
    v_mul_f32 v221, v221, v243
    v_mul_f32 v222, v222, v243
    v_mul_f32 v223, v223, v243
    s_nop 3
    s_branch concat_heads__gqa_block_cached__gqa_block_cached__near_ridge_kernel_rb7
.globl oproj_kernel
.p2align 8
.type oproj_kernel,@function
oproj_kernel:
    s_cmp_ge_u32 s2, 240
    s_cbranch_scc1 oproj_kernel_end
    s_load_dwordx16 s[64:79], s[0:1], 0
    s_load_dwordx4 s[80:83], s[0:1], 64
    s_load_dwordx2 s[84:85], s[0:1], 80
    s_load_dwordx2 s[86:87], s[0:1], 96
    v_and_b32 v210, 63, v0
    v_lshrrev_b32 v212, 6, v0
    s_nop 0
    v_readfirstlane_b32 s28, v212
    s_and_b32 s3, s2, 7
    s_lshr_b32 s4, s2, 3
    s_lshr_b32 s29, s3, 2
    s_and_b32 s3, s3, 3
    s_mul_i32 s3, s3, 6
    s_mul_i32 s5, s4, 205
    s_lshr_b32 s5, s5, 10
    s_add_u32 s30, s3, s5
    s_mul_i32 s5, s5, 5
    s_sub_u32 s31, s4, s5
    s_mul_i32 s3, s28, 1310720
    s_lshl_b32 s4, s31, 8
    s_add_u32 s34, s3, s4
    s_mul_i32 s36, s28, 32768
    s_mul_i32 s3, s29, 72
    s_mul_i32 s4, s30, 3
    s_add_u32 s3, s3, s4
    s_lshl_b32 s3, s3, 18
    s_lshl_b32 s4, s28, 16
    s_add_u32 s40, s3, s4
    s_add_u32 s41, s40, 262144
    s_add_u32 s42, s40, 524288
    v_lshrrev_b32 v212, 4, v210
    v_and_b32 v213, 15, v210
    v_lshrrev_b32 v215, 5, v210
    s_movk_i32 s3, 1280
    v_mul_lo_u32 v221, v212, s3
    v_lshlrev_b32 v214, 2, v212
    v_xor_b32 v214, v214, v213
    v_lshl_add_u32 v208, v214, 4, v221
    v_lshlrev_b32 v214, 2, v212
    v_xor_b32 v214, v214, v213
    v_xor_b32 v214, 2, v214
    v_lshl_add_u32 v209, v214, 4, v221
    v_lshlrev_b32 v211, 4, v210
    s_waitcnt lgkmcnt(0)
    s_cmp_eq_u32 s29, 0
    s_cselect_b32 s8, s72, s82
    s_cselect_b32 s9, s73, s83
    s_mov_b32 s10, 5242880
    s_mov_b32 s11, 0x00020000
    s_mov_b32 s12, s86
    s_and_b32 s13, s87, 0xffff
    s_mov_b32 s14, 37748736
    s_mov_b32 s15, 0x00020000
    s_mov_b32 s16, s84
    s_and_b32 s17, s85, 0xffff
    s_mov_b32 s18, 5898240
    s_mov_b32 s19, 0x00020000
    s_add_u32 s43, s34, 0
    s_add_u32 m0, s36, 0
    s_nop 0
    buffer_load_dwordx4 v208, s[8:11], s43 offen offset:0 lds
    s_add_u32 s43, s34, 5120
    s_add_u32 m0, s36, 1024
    s_nop 0
    buffer_load_dwordx4 v209, s[8:11], s43 offen offset:0 lds
    s_add_u32 s43, s34, 10240
    s_add_u32 m0, s36, 2048
    s_nop 0
    buffer_load_dwordx4 v208, s[8:11], s43 offen offset:0 lds
    s_add_u32 s43, s34, 15360
    s_add_u32 m0, s36, 3072
    s_nop 0
    buffer_load_dwordx4 v209, s[8:11], s43 offen offset:0 lds
    s_add_u32 s44, s40, 0
    buffer_load_dwordx4 v[0:3], v211, s[12:15], s44 offen offset:0
    s_add_u32 s45, s41, 0
    buffer_load_dwordx4 v[4:7], v211, s[12:15], s45 offen offset:0
    s_add_u32 s46, s42, 0
    buffer_load_dwordx4 v[8:11], v211, s[12:15], s46 offen offset:0
    s_add_u32 s43, s34, 20480
    s_add_u32 m0, s36, 4096
    s_nop 0
    buffer_load_dwordx4 v208, s[8:11], s43 offen offset:0 lds
    s_add_u32 s43, s34, 25600
    s_add_u32 m0, s36, 5120
    s_nop 0
    buffer_load_dwordx4 v209, s[8:11], s43 offen offset:0 lds
    s_add_u32 s43, s34, 30720
    s_add_u32 m0, s36, 6144
    s_nop 0
    buffer_load_dwordx4 v208, s[8:11], s43 offen offset:0 lds
    s_add_u32 s43, s34, 35840
    s_add_u32 m0, s36, 7168
    s_nop 0
    buffer_load_dwordx4 v209, s[8:11], s43 offen offset:0 lds
    s_add_u32 s44, s40, 0
    buffer_load_dwordx4 v[12:15], v211, s[12:15], s44 offen offset:1024
    s_add_u32 s45, s41, 0
    buffer_load_dwordx4 v[16:19], v211, s[12:15], s45 offen offset:1024
    s_add_u32 s46, s42, 0
    buffer_load_dwordx4 v[20:23], v211, s[12:15], s46 offen offset:1024
    s_add_u32 s43, s34, 40960
    s_add_u32 m0, s36, 8192
    s_nop 0
    buffer_load_dwordx4 v208, s[8:11], s43 offen offset:0 lds
    s_add_u32 s43, s34, 46080
    s_add_u32 m0, s36, 9216
    s_nop 0
    buffer_load_dwordx4 v209, s[8:11], s43 offen offset:0 lds
    s_add_u32 s43, s34, 51200
    s_add_u32 m0, s36, 10240
    s_nop 0
    buffer_load_dwordx4 v208, s[8:11], s43 offen offset:0 lds
    s_add_u32 s43, s34, 56320
    s_add_u32 m0, s36, 11264
    s_nop 0
    buffer_load_dwordx4 v209, s[8:11], s43 offen offset:0 lds
    s_add_u32 s44, s40, 0
    buffer_load_dwordx4 v[24:27], v211, s[12:15], s44 offen offset:2048
    s_add_u32 s45, s41, 0
    buffer_load_dwordx4 v[28:31], v211, s[12:15], s45 offen offset:2048
    s_add_u32 s46, s42, 0
    buffer_load_dwordx4 v[32:35], v211, s[12:15], s46 offen offset:2048
    s_add_u32 s43, s34, 61440
    s_add_u32 m0, s36, 12288
    s_nop 0
    buffer_load_dwordx4 v208, s[8:11], s43 offen offset:0 lds
    s_add_u32 s43, s34, 66560
    s_add_u32 m0, s36, 13312
    s_nop 0
    buffer_load_dwordx4 v209, s[8:11], s43 offen offset:0 lds
    s_add_u32 s43, s34, 71680
    s_add_u32 m0, s36, 14336
    s_nop 0
    buffer_load_dwordx4 v208, s[8:11], s43 offen offset:0 lds
    s_add_u32 s43, s34, 76800
    s_add_u32 m0, s36, 15360
    s_nop 0
    buffer_load_dwordx4 v209, s[8:11], s43 offen offset:0 lds
    s_add_u32 s44, s40, 0
    buffer_load_dwordx4 v[36:39], v211, s[12:15], s44 offen offset:3072
    s_add_u32 s45, s41, 0
    buffer_load_dwordx4 v[40:43], v211, s[12:15], s45 offen offset:3072
    s_add_u32 s46, s42, 0
    buffer_load_dwordx4 v[44:47], v211, s[12:15], s46 offen offset:3072
    s_add_u32 s43, s34, 81920
    s_add_u32 m0, s36, 16384
    s_nop 0
    buffer_load_dwordx4 v208, s[8:11], s43 offen offset:0 lds
    s_add_u32 s43, s34, 87040
    s_add_u32 m0, s36, 17408
    s_nop 0
    buffer_load_dwordx4 v209, s[8:11], s43 offen offset:0 lds
    s_add_u32 s43, s34, 92160
    s_add_u32 m0, s36, 18432
    s_nop 0
    buffer_load_dwordx4 v208, s[8:11], s43 offen offset:0 lds
    s_add_u32 s43, s34, 97280
    s_add_u32 m0, s36, 19456
    s_nop 0
    buffer_load_dwordx4 v209, s[8:11], s43 offen offset:0 lds
    s_add_u32 s44, s40, 4096
    buffer_load_dwordx4 v[48:51], v211, s[12:15], s44 offen offset:0
    s_add_u32 s45, s41, 4096
    buffer_load_dwordx4 v[52:55], v211, s[12:15], s45 offen offset:0
    s_add_u32 s46, s42, 4096
    buffer_load_dwordx4 v[56:59], v211, s[12:15], s46 offen offset:0
    s_add_u32 s43, s34, 102400
    s_add_u32 m0, s36, 20480
    s_nop 0
    buffer_load_dwordx4 v208, s[8:11], s43 offen offset:0 lds
    s_add_u32 s43, s34, 107520
    s_add_u32 m0, s36, 21504
    s_nop 0
    buffer_load_dwordx4 v209, s[8:11], s43 offen offset:0 lds
    s_add_u32 s43, s34, 112640
    s_add_u32 m0, s36, 22528
    s_nop 0
    buffer_load_dwordx4 v208, s[8:11], s43 offen offset:0 lds
    s_add_u32 s43, s34, 117760
    s_add_u32 m0, s36, 23552
    s_nop 0
    buffer_load_dwordx4 v209, s[8:11], s43 offen offset:0 lds
    s_add_u32 s44, s40, 4096
    buffer_load_dwordx4 v[60:63], v211, s[12:15], s44 offen offset:1024
    s_add_u32 s45, s41, 4096
    buffer_load_dwordx4 v[64:67], v211, s[12:15], s45 offen offset:1024
    s_add_u32 s46, s42, 4096
    buffer_load_dwordx4 v[68:71], v211, s[12:15], s46 offen offset:1024
    s_add_u32 s43, s34, 122880
    s_add_u32 m0, s36, 24576
    s_nop 0
    buffer_load_dwordx4 v208, s[8:11], s43 offen offset:0 lds
    s_add_u32 s43, s34, 128000
    s_add_u32 m0, s36, 25600
    s_nop 0
    buffer_load_dwordx4 v209, s[8:11], s43 offen offset:0 lds
    s_add_u32 s43, s34, 133120
    s_add_u32 m0, s36, 26624
    s_nop 0
    buffer_load_dwordx4 v208, s[8:11], s43 offen offset:0 lds
    s_add_u32 s43, s34, 138240
    s_add_u32 m0, s36, 27648
    s_nop 0
    buffer_load_dwordx4 v209, s[8:11], s43 offen offset:0 lds
    s_add_u32 s44, s40, 4096
    buffer_load_dwordx4 v[72:75], v211, s[12:15], s44 offen offset:2048
    s_add_u32 s45, s41, 4096
    buffer_load_dwordx4 v[76:79], v211, s[12:15], s45 offen offset:2048
    s_add_u32 s46, s42, 4096
    buffer_load_dwordx4 v[80:83], v211, s[12:15], s46 offen offset:2048
    v_accvgpr_write_b32 a0, 0
    v_accvgpr_write_b32 a1, 0
    v_accvgpr_write_b32 a2, 0
    v_accvgpr_write_b32 a3, 0
    v_accvgpr_write_b32 a4, 0
    v_accvgpr_write_b32 a5, 0
    v_accvgpr_write_b32 a6, 0
    v_accvgpr_write_b32 a7, 0
    v_accvgpr_write_b32 a8, 0
    v_accvgpr_write_b32 a9, 0
    v_accvgpr_write_b32 a10, 0
    v_accvgpr_write_b32 a11, 0
    v_accvgpr_write_b32 a12, 0
    v_accvgpr_write_b32 a13, 0
    v_accvgpr_write_b32 a14, 0
    v_accvgpr_write_b32 a15, 0
    v_accvgpr_write_b32 a16, 0
    v_accvgpr_write_b32 a17, 0
    v_accvgpr_write_b32 a18, 0
    v_accvgpr_write_b32 a19, 0
    v_accvgpr_write_b32 a20, 0
    v_accvgpr_write_b32 a21, 0
    v_accvgpr_write_b32 a22, 0
    v_accvgpr_write_b32 a23, 0
    v_accvgpr_write_b32 a24, 0
    v_accvgpr_write_b32 a25, 0
    v_accvgpr_write_b32 a26, 0
    v_accvgpr_write_b32 a27, 0
    v_accvgpr_write_b32 a28, 0
    v_accvgpr_write_b32 a29, 0
    v_accvgpr_write_b32 a30, 0
    v_accvgpr_write_b32 a31, 0
    v_accvgpr_write_b32 a32, 0
    v_accvgpr_write_b32 a33, 0
    v_accvgpr_write_b32 a34, 0
    v_accvgpr_write_b32 a35, 0
    v_accvgpr_write_b32 a36, 0
    v_accvgpr_write_b32 a37, 0
    v_accvgpr_write_b32 a38, 0
    v_accvgpr_write_b32 a39, 0
    v_accvgpr_write_b32 a40, 0
    v_accvgpr_write_b32 a41, 0
    v_accvgpr_write_b32 a42, 0
    v_accvgpr_write_b32 a43, 0
    v_accvgpr_write_b32 a44, 0
    v_accvgpr_write_b32 a45, 0
    v_accvgpr_write_b32 a46, 0
    v_accvgpr_write_b32 a47, 0
    v_accvgpr_write_b32 a48, 0
    v_accvgpr_write_b32 a49, 0
    v_accvgpr_write_b32 a50, 0
    v_accvgpr_write_b32 a51, 0
    v_accvgpr_write_b32 a52, 0
    v_accvgpr_write_b32 a53, 0
    v_accvgpr_write_b32 a54, 0
    v_accvgpr_write_b32 a55, 0
    v_accvgpr_write_b32 a56, 0
    v_accvgpr_write_b32 a57, 0
    v_accvgpr_write_b32 a58, 0
    v_accvgpr_write_b32 a59, 0
    v_accvgpr_write_b32 a60, 0
    v_accvgpr_write_b32 a61, 0
    v_accvgpr_write_b32 a62, 0
    v_accvgpr_write_b32 a63, 0
    v_accvgpr_write_b32 a64, 0
    v_accvgpr_write_b32 a65, 0
    v_accvgpr_write_b32 a66, 0
    v_accvgpr_write_b32 a67, 0
    v_accvgpr_write_b32 a68, 0
    v_accvgpr_write_b32 a69, 0
    v_accvgpr_write_b32 a70, 0
    v_accvgpr_write_b32 a71, 0
    v_accvgpr_write_b32 a72, 0
    v_accvgpr_write_b32 a73, 0
    v_accvgpr_write_b32 a74, 0
    v_accvgpr_write_b32 a75, 0
    v_accvgpr_write_b32 a76, 0
    v_accvgpr_write_b32 a77, 0
    v_accvgpr_write_b32 a78, 0
    v_accvgpr_write_b32 a79, 0
    v_accvgpr_write_b32 a80, 0
    v_accvgpr_write_b32 a81, 0
    v_accvgpr_write_b32 a82, 0
    v_accvgpr_write_b32 a83, 0
    v_accvgpr_write_b32 a84, 0
    v_accvgpr_write_b32 a85, 0
    v_accvgpr_write_b32 a86, 0
    v_accvgpr_write_b32 a87, 0
    v_accvgpr_write_b32 a88, 0
    v_accvgpr_write_b32 a89, 0
    v_accvgpr_write_b32 a90, 0
    v_accvgpr_write_b32 a91, 0
    v_accvgpr_write_b32 a92, 0
    v_accvgpr_write_b32 a93, 0
    v_accvgpr_write_b32 a94, 0
    v_accvgpr_write_b32 a95, 0
    v_accvgpr_write_b32 a96, 0
    v_accvgpr_write_b32 a97, 0
    v_accvgpr_write_b32 a98, 0
    v_accvgpr_write_b32 a99, 0
    v_accvgpr_write_b32 a100, 0
    v_accvgpr_write_b32 a101, 0
    v_accvgpr_write_b32 a102, 0
    v_accvgpr_write_b32 a103, 0
    v_accvgpr_write_b32 a104, 0
    v_accvgpr_write_b32 a105, 0
    v_accvgpr_write_b32 a106, 0
    v_accvgpr_write_b32 a107, 0
    v_accvgpr_write_b32 a108, 0
    v_accvgpr_write_b32 a109, 0
    v_accvgpr_write_b32 a110, 0
    v_accvgpr_write_b32 a111, 0
    v_accvgpr_write_b32 a112, 0
    v_accvgpr_write_b32 a113, 0
    v_accvgpr_write_b32 a114, 0
    v_accvgpr_write_b32 a115, 0
    v_accvgpr_write_b32 a116, 0
    v_accvgpr_write_b32 a117, 0
    v_accvgpr_write_b32 a118, 0
    v_accvgpr_write_b32 a119, 0
    v_accvgpr_write_b32 a120, 0
    v_accvgpr_write_b32 a121, 0
    v_accvgpr_write_b32 a122, 0
    v_accvgpr_write_b32 a123, 0
    v_accvgpr_write_b32 a124, 0
    v_accvgpr_write_b32 a125, 0
    v_accvgpr_write_b32 a126, 0
    v_accvgpr_write_b32 a127, 0
    v_accvgpr_write_b32 a128, 0
    v_accvgpr_write_b32 a129, 0
    v_accvgpr_write_b32 a130, 0
    v_accvgpr_write_b32 a131, 0
    v_accvgpr_write_b32 a132, 0
    v_accvgpr_write_b32 a133, 0
    v_accvgpr_write_b32 a134, 0
    v_accvgpr_write_b32 a135, 0
    v_accvgpr_write_b32 a136, 0
    v_accvgpr_write_b32 a137, 0
    v_accvgpr_write_b32 a138, 0
    v_accvgpr_write_b32 a139, 0
    v_accvgpr_write_b32 a140, 0
    v_accvgpr_write_b32 a141, 0
    v_accvgpr_write_b32 a142, 0
    v_accvgpr_write_b32 a143, 0
    v_accvgpr_write_b32 a144, 0
    v_accvgpr_write_b32 a145, 0
    v_accvgpr_write_b32 a146, 0
    v_accvgpr_write_b32 a147, 0
    v_accvgpr_write_b32 a148, 0
    v_accvgpr_write_b32 a149, 0
    v_accvgpr_write_b32 a150, 0
    v_accvgpr_write_b32 a151, 0
    v_accvgpr_write_b32 a152, 0
    v_accvgpr_write_b32 a153, 0
    v_accvgpr_write_b32 a154, 0
    v_accvgpr_write_b32 a155, 0
    v_accvgpr_write_b32 a156, 0
    v_accvgpr_write_b32 a157, 0
    v_accvgpr_write_b32 a158, 0
    v_accvgpr_write_b32 a159, 0
    v_accvgpr_write_b32 a160, 0
    v_accvgpr_write_b32 a161, 0
    v_accvgpr_write_b32 a162, 0
    v_accvgpr_write_b32 a163, 0
    v_accvgpr_write_b32 a164, 0
    v_accvgpr_write_b32 a165, 0
    v_accvgpr_write_b32 a166, 0
    v_accvgpr_write_b32 a167, 0
    v_accvgpr_write_b32 a168, 0
    v_accvgpr_write_b32 a169, 0
    v_accvgpr_write_b32 a170, 0
    v_accvgpr_write_b32 a171, 0
    v_accvgpr_write_b32 a172, 0
    v_accvgpr_write_b32 a173, 0
    v_accvgpr_write_b32 a174, 0
    v_accvgpr_write_b32 a175, 0
    v_accvgpr_write_b32 a176, 0
    v_accvgpr_write_b32 a177, 0
    v_accvgpr_write_b32 a178, 0
    v_accvgpr_write_b32 a179, 0
    v_accvgpr_write_b32 a180, 0
    v_accvgpr_write_b32 a181, 0
    v_accvgpr_write_b32 a182, 0
    v_accvgpr_write_b32 a183, 0
    v_accvgpr_write_b32 a184, 0
    v_accvgpr_write_b32 a185, 0
    v_accvgpr_write_b32 a186, 0
    v_accvgpr_write_b32 a187, 0
    v_accvgpr_write_b32 a188, 0
    v_accvgpr_write_b32 a189, 0
    v_accvgpr_write_b32 a190, 0
    v_accvgpr_write_b32 a191, 0
    v_lshrrev_b32 v216, 2, v213
    v_and_b32 v217, 3, v210
    v_and_b32 v218, 1, v212
    v_and_b32 v219, 1, v217
    v_lshl_add_u32 v219, v218, 1, v219
    v_lshrrev_b32 v220, 1, v217
    v_lshlrev_b32 v220, 3, v220
    v_add_u32 v220, s36, v220
    v_xor_b32 v221, 0, v216
    v_xor_b32 v222, 0, v219
    v_lshl_add_u32 v222, v221, 2, v222
    v_lshl_add_u32 v222, v222, 4, v220
    v_lshl_add_u32 v222, v216, 8, v222
    v_lshl_add_u32 v200, v215, 11, v222
    v_xor_b32 v222, 2, v219
    v_lshl_add_u32 v222, v221, 2, v222
    v_lshl_add_u32 v222, v222, 4, v220
    v_lshl_add_u32 v222, v216, 8, v222
    v_lshl_add_u32 v201, v215, 11, v222
    v_add_u32 v201, 1024, v201
    v_xor_b32 v221, 1, v216
    v_xor_b32 v222, 0, v219
    v_lshl_add_u32 v222, v221, 2, v222
    v_lshl_add_u32 v222, v222, 4, v220
    v_lshl_add_u32 v222, v216, 8, v222
    v_lshl_add_u32 v202, v215, 11, v222
    v_xor_b32 v222, 2, v219
    v_lshl_add_u32 v222, v221, 2, v222
    v_lshl_add_u32 v222, v222, 4, v220
    v_lshl_add_u32 v222, v216, 8, v222
    v_lshl_add_u32 v203, v215, 11, v222
    v_add_u32 v203, 1024, v203
    v_xor_b32 v221, 2, v216
    v_xor_b32 v222, 0, v219
    v_lshl_add_u32 v222, v221, 2, v222
    v_lshl_add_u32 v222, v222, 4, v220
    v_lshl_add_u32 v222, v216, 8, v222
    v_lshl_add_u32 v204, v215, 11, v222
    v_xor_b32 v222, 2, v219
    v_lshl_add_u32 v222, v221, 2, v222
    v_lshl_add_u32 v222, v222, 4, v220
    v_lshl_add_u32 v222, v216, 8, v222
    v_lshl_add_u32 v205, v215, 11, v222
    v_add_u32 v205, 1024, v205
    v_xor_b32 v221, 3, v216
    v_xor_b32 v222, 0, v219
    v_lshl_add_u32 v222, v221, 2, v222
    v_lshl_add_u32 v222, v222, 4, v220
    v_lshl_add_u32 v222, v216, 8, v222
    v_lshl_add_u32 v206, v215, 11, v222
    v_xor_b32 v222, 2, v219
    v_lshl_add_u32 v222, v221, 2, v222
    v_lshl_add_u32 v222, v222, 4, v220
    v_lshl_add_u32 v222, v216, 8, v222
    v_lshl_add_u32 v207, v215, 11, v222
    v_add_u32 v207, 1024, v207
    s_waitcnt vmcnt(45)
    ds_read_b64_tr_b16 v[160:161], v200 offset:0
    ds_read_b64_tr_b16 v[162:163], v201 offset:0
    ds_read_b64_tr_b16 v[164:165], v202 offset:0
    ds_read_b64_tr_b16 v[166:167], v203 offset:0
    ds_read_b64_tr_b16 v[168:169], v204 offset:0
    ds_read_b64_tr_b16 v[170:171], v205 offset:0
    ds_read_b64_tr_b16 v[172:173], v206 offset:0
    ds_read_b64_tr_b16 v[174:175], v207 offset:0
    s_mov_b32 s50, 7
oproj_kernel_loop:
    s_waitcnt vmcnt(38)
    ds_read_b64_tr_b16 v[176:177], v200 offset:4096
    ds_read_b64_tr_b16 v[178:179], v201 offset:4096
    ds_read_b64_tr_b16 v[180:181], v202 offset:4096
    ds_read_b64_tr_b16 v[182:183], v203 offset:4096
    ds_read_b64_tr_b16 v[184:185], v204 offset:4096
    ds_read_b64_tr_b16 v[186:187], v205 offset:4096
    ds_read_b64_tr_b16 v[188:189], v206 offset:4096
    ds_read_b64_tr_b16 v[190:191], v207 offset:4096
    s_add_u32 s43, s34, 143360
    s_add_u32 m0, s36, 28672
    s_nop 0
    buffer_load_dwordx4 v208, s[8:11], s43 offen offset:0 lds
    s_add_u32 s43, s34, 148480
    s_add_u32 m0, s36, 29696
    s_nop 0
    buffer_load_dwordx4 v209, s[8:11], s43 offen offset:0 lds
    s_add_u32 s43, s34, 153600
    s_add_u32 m0, s36, 30720
    s_nop 0
    buffer_load_dwordx4 v208, s[8:11], s43 offen offset:0 lds
    s_add_u32 s43, s34, 158720
    s_add_u32 m0, s36, 31744
    s_nop 0
    buffer_load_dwordx4 v209, s[8:11], s43 offen offset:0 lds
    s_add_u32 s44, s40, 4096
    buffer_load_dwordx4 v[84:87], v211, s[12:15], s44 offen offset:3072
    s_add_u32 s45, s41, 4096
    buffer_load_dwordx4 v[88:91], v211, s[12:15], s45 offen offset:3072
    s_add_u32 s46, s42, 4096
    buffer_load_dwordx4 v[92:95], v211, s[12:15], s46 offen offset:3072
    s_waitcnt lgkmcnt(14)
    v_mfma_f32_32x32x16_bf16 a[0:15], v[160:163], v[0:3], a[0:15]
    v_mfma_f32_32x32x16_bf16 a[64:79], v[160:163], v[4:7], a[64:79]
    v_mfma_f32_32x32x16_bf16 a[128:143], v[160:163], v[8:11], a[128:143]
    s_waitcnt lgkmcnt(12)
    v_mfma_f32_32x32x16_bf16 a[16:31], v[164:167], v[0:3], a[16:31]
    v_mfma_f32_32x32x16_bf16 a[80:95], v[164:167], v[4:7], a[80:95]
    v_mfma_f32_32x32x16_bf16 a[144:159], v[164:167], v[8:11], a[144:159]
    s_waitcnt lgkmcnt(10)
    v_mfma_f32_32x32x16_bf16 a[32:47], v[168:171], v[0:3], a[32:47]
    v_mfma_f32_32x32x16_bf16 a[96:111], v[168:171], v[4:7], a[96:111]
    v_mfma_f32_32x32x16_bf16 a[160:175], v[168:171], v[8:11], a[160:175]
    s_waitcnt lgkmcnt(8)
    v_mfma_f32_32x32x16_bf16 a[48:63], v[172:175], v[0:3], a[48:63]
    v_mfma_f32_32x32x16_bf16 a[112:127], v[172:175], v[4:7], a[112:127]
    v_mfma_f32_32x32x16_bf16 a[176:191], v[172:175], v[8:11], a[176:191]
    s_waitcnt vmcnt(38)
    ds_read_b64_tr_b16 v[160:161], v200 offset:8192
    ds_read_b64_tr_b16 v[162:163], v201 offset:8192
    ds_read_b64_tr_b16 v[164:165], v202 offset:8192
    ds_read_b64_tr_b16 v[166:167], v203 offset:8192
    ds_read_b64_tr_b16 v[168:169], v204 offset:8192
    ds_read_b64_tr_b16 v[170:171], v205 offset:8192
    ds_read_b64_tr_b16 v[172:173], v206 offset:8192
    ds_read_b64_tr_b16 v[174:175], v207 offset:8192
    s_add_u32 s43, s34, 163840
    s_add_u32 m0, s36, 0
    s_nop 0
    buffer_load_dwordx4 v208, s[8:11], s43 offen offset:0 lds
    s_add_u32 s43, s34, 168960
    s_add_u32 m0, s36, 1024
    s_nop 0
    buffer_load_dwordx4 v209, s[8:11], s43 offen offset:0 lds
    s_add_u32 s43, s34, 174080
    s_add_u32 m0, s36, 2048
    s_nop 0
    buffer_load_dwordx4 v208, s[8:11], s43 offen offset:0 lds
    s_add_u32 s43, s34, 179200
    s_add_u32 m0, s36, 3072
    s_nop 0
    buffer_load_dwordx4 v209, s[8:11], s43 offen offset:0 lds
    s_add_u32 s44, s40, 8192
    buffer_load_dwordx4 v[0:3], v211, s[12:15], s44 offen offset:0
    s_add_u32 s45, s41, 8192
    buffer_load_dwordx4 v[4:7], v211, s[12:15], s45 offen offset:0
    s_add_u32 s46, s42, 8192
    buffer_load_dwordx4 v[8:11], v211, s[12:15], s46 offen offset:0
    s_waitcnt lgkmcnt(14)
    v_mfma_f32_32x32x16_bf16 a[0:15], v[176:179], v[12:15], a[0:15]
    v_mfma_f32_32x32x16_bf16 a[64:79], v[176:179], v[16:19], a[64:79]
    v_mfma_f32_32x32x16_bf16 a[128:143], v[176:179], v[20:23], a[128:143]
    s_waitcnt lgkmcnt(12)
    v_mfma_f32_32x32x16_bf16 a[16:31], v[180:183], v[12:15], a[16:31]
    v_mfma_f32_32x32x16_bf16 a[80:95], v[180:183], v[16:19], a[80:95]
    v_mfma_f32_32x32x16_bf16 a[144:159], v[180:183], v[20:23], a[144:159]
    s_waitcnt lgkmcnt(10)
    v_mfma_f32_32x32x16_bf16 a[32:47], v[184:187], v[12:15], a[32:47]
    v_mfma_f32_32x32x16_bf16 a[96:111], v[184:187], v[16:19], a[96:111]
    v_mfma_f32_32x32x16_bf16 a[160:175], v[184:187], v[20:23], a[160:175]
    s_waitcnt lgkmcnt(8)
    v_mfma_f32_32x32x16_bf16 a[48:63], v[188:191], v[12:15], a[48:63]
    v_mfma_f32_32x32x16_bf16 a[112:127], v[188:191], v[16:19], a[112:127]
    v_mfma_f32_32x32x16_bf16 a[176:191], v[188:191], v[20:23], a[176:191]
    s_waitcnt vmcnt(38)
    ds_read_b64_tr_b16 v[176:177], v200 offset:12288
    ds_read_b64_tr_b16 v[178:179], v201 offset:12288
    ds_read_b64_tr_b16 v[180:181], v202 offset:12288
    ds_read_b64_tr_b16 v[182:183], v203 offset:12288
    ds_read_b64_tr_b16 v[184:185], v204 offset:12288
    ds_read_b64_tr_b16 v[186:187], v205 offset:12288
    ds_read_b64_tr_b16 v[188:189], v206 offset:12288
    ds_read_b64_tr_b16 v[190:191], v207 offset:12288
    s_add_u32 s43, s34, 184320
    s_add_u32 m0, s36, 4096
    s_nop 0
    buffer_load_dwordx4 v208, s[8:11], s43 offen offset:0 lds
    s_add_u32 s43, s34, 189440
    s_add_u32 m0, s36, 5120
    s_nop 0
    buffer_load_dwordx4 v209, s[8:11], s43 offen offset:0 lds
    s_add_u32 s43, s34, 194560
    s_add_u32 m0, s36, 6144
    s_nop 0
    buffer_load_dwordx4 v208, s[8:11], s43 offen offset:0 lds
    s_add_u32 s43, s34, 199680
    s_add_u32 m0, s36, 7168
    s_nop 0
    buffer_load_dwordx4 v209, s[8:11], s43 offen offset:0 lds
    s_add_u32 s44, s40, 8192
    buffer_load_dwordx4 v[12:15], v211, s[12:15], s44 offen offset:1024
    s_add_u32 s45, s41, 8192
    buffer_load_dwordx4 v[16:19], v211, s[12:15], s45 offen offset:1024
    s_add_u32 s46, s42, 8192
    buffer_load_dwordx4 v[20:23], v211, s[12:15], s46 offen offset:1024
    s_waitcnt lgkmcnt(14)
    v_mfma_f32_32x32x16_bf16 a[0:15], v[160:163], v[24:27], a[0:15]
    v_mfma_f32_32x32x16_bf16 a[64:79], v[160:163], v[28:31], a[64:79]
    v_mfma_f32_32x32x16_bf16 a[128:143], v[160:163], v[32:35], a[128:143]
    s_waitcnt lgkmcnt(12)
    v_mfma_f32_32x32x16_bf16 a[16:31], v[164:167], v[24:27], a[16:31]
    v_mfma_f32_32x32x16_bf16 a[80:95], v[164:167], v[28:31], a[80:95]
    v_mfma_f32_32x32x16_bf16 a[144:159], v[164:167], v[32:35], a[144:159]
    s_waitcnt lgkmcnt(10)
    v_mfma_f32_32x32x16_bf16 a[32:47], v[168:171], v[24:27], a[32:47]
    v_mfma_f32_32x32x16_bf16 a[96:111], v[168:171], v[28:31], a[96:111]
    v_mfma_f32_32x32x16_bf16 a[160:175], v[168:171], v[32:35], a[160:175]
    s_waitcnt lgkmcnt(8)
    v_mfma_f32_32x32x16_bf16 a[48:63], v[172:175], v[24:27], a[48:63]
    v_mfma_f32_32x32x16_bf16 a[112:127], v[172:175], v[28:31], a[112:127]
    v_mfma_f32_32x32x16_bf16 a[176:191], v[172:175], v[32:35], a[176:191]
    s_waitcnt vmcnt(38)
    ds_read_b64_tr_b16 v[160:161], v200 offset:16384
    ds_read_b64_tr_b16 v[162:163], v201 offset:16384
    ds_read_b64_tr_b16 v[164:165], v202 offset:16384
    ds_read_b64_tr_b16 v[166:167], v203 offset:16384
    ds_read_b64_tr_b16 v[168:169], v204 offset:16384
    ds_read_b64_tr_b16 v[170:171], v205 offset:16384
    ds_read_b64_tr_b16 v[172:173], v206 offset:16384
    ds_read_b64_tr_b16 v[174:175], v207 offset:16384
    s_add_u32 s43, s34, 204800
    s_add_u32 m0, s36, 8192
    s_nop 0
    buffer_load_dwordx4 v208, s[8:11], s43 offen offset:0 lds
    s_add_u32 s43, s34, 209920
    s_add_u32 m0, s36, 9216
    s_nop 0
    buffer_load_dwordx4 v209, s[8:11], s43 offen offset:0 lds
    s_add_u32 s43, s34, 215040
    s_add_u32 m0, s36, 10240
    s_nop 0
    buffer_load_dwordx4 v208, s[8:11], s43 offen offset:0 lds
    s_add_u32 s43, s34, 220160
    s_add_u32 m0, s36, 11264
    s_nop 0
    buffer_load_dwordx4 v209, s[8:11], s43 offen offset:0 lds
    s_add_u32 s44, s40, 8192
    buffer_load_dwordx4 v[24:27], v211, s[12:15], s44 offen offset:2048
    s_add_u32 s45, s41, 8192
    buffer_load_dwordx4 v[28:31], v211, s[12:15], s45 offen offset:2048
    s_add_u32 s46, s42, 8192
    buffer_load_dwordx4 v[32:35], v211, s[12:15], s46 offen offset:2048
    s_waitcnt lgkmcnt(14)
    v_mfma_f32_32x32x16_bf16 a[0:15], v[176:179], v[36:39], a[0:15]
    v_mfma_f32_32x32x16_bf16 a[64:79], v[176:179], v[40:43], a[64:79]
    v_mfma_f32_32x32x16_bf16 a[128:143], v[176:179], v[44:47], a[128:143]
    s_waitcnt lgkmcnt(12)
    v_mfma_f32_32x32x16_bf16 a[16:31], v[180:183], v[36:39], a[16:31]
    v_mfma_f32_32x32x16_bf16 a[80:95], v[180:183], v[40:43], a[80:95]
    v_mfma_f32_32x32x16_bf16 a[144:159], v[180:183], v[44:47], a[144:159]
    s_waitcnt lgkmcnt(10)
    v_mfma_f32_32x32x16_bf16 a[32:47], v[184:187], v[36:39], a[32:47]
    v_mfma_f32_32x32x16_bf16 a[96:111], v[184:187], v[40:43], a[96:111]
    v_mfma_f32_32x32x16_bf16 a[160:175], v[184:187], v[44:47], a[160:175]
    s_waitcnt lgkmcnt(8)
    v_mfma_f32_32x32x16_bf16 a[48:63], v[188:191], v[36:39], a[48:63]
    v_mfma_f32_32x32x16_bf16 a[112:127], v[188:191], v[40:43], a[112:127]
    v_mfma_f32_32x32x16_bf16 a[176:191], v[188:191], v[44:47], a[176:191]
    s_waitcnt vmcnt(38)
    ds_read_b64_tr_b16 v[176:177], v200 offset:20480
    ds_read_b64_tr_b16 v[178:179], v201 offset:20480
    ds_read_b64_tr_b16 v[180:181], v202 offset:20480
    ds_read_b64_tr_b16 v[182:183], v203 offset:20480
    ds_read_b64_tr_b16 v[184:185], v204 offset:20480
    ds_read_b64_tr_b16 v[186:187], v205 offset:20480
    ds_read_b64_tr_b16 v[188:189], v206 offset:20480
    ds_read_b64_tr_b16 v[190:191], v207 offset:20480
    s_add_u32 s43, s34, 225280
    s_add_u32 m0, s36, 12288
    s_nop 0
    buffer_load_dwordx4 v208, s[8:11], s43 offen offset:0 lds
    s_add_u32 s43, s34, 230400
    s_add_u32 m0, s36, 13312
    s_nop 0
    buffer_load_dwordx4 v209, s[8:11], s43 offen offset:0 lds
    s_add_u32 s43, s34, 235520
    s_add_u32 m0, s36, 14336
    s_nop 0
    buffer_load_dwordx4 v208, s[8:11], s43 offen offset:0 lds
    s_add_u32 s43, s34, 240640
    s_add_u32 m0, s36, 15360
    s_nop 0
    buffer_load_dwordx4 v209, s[8:11], s43 offen offset:0 lds
    s_add_u32 s44, s40, 8192
    buffer_load_dwordx4 v[36:39], v211, s[12:15], s44 offen offset:3072
    s_add_u32 s45, s41, 8192
    buffer_load_dwordx4 v[40:43], v211, s[12:15], s45 offen offset:3072
    s_add_u32 s46, s42, 8192
    buffer_load_dwordx4 v[44:47], v211, s[12:15], s46 offen offset:3072
    s_waitcnt lgkmcnt(14)
    v_mfma_f32_32x32x16_bf16 a[0:15], v[160:163], v[48:51], a[0:15]
    v_mfma_f32_32x32x16_bf16 a[64:79], v[160:163], v[52:55], a[64:79]
    v_mfma_f32_32x32x16_bf16 a[128:143], v[160:163], v[56:59], a[128:143]
    s_waitcnt lgkmcnt(12)
    v_mfma_f32_32x32x16_bf16 a[16:31], v[164:167], v[48:51], a[16:31]
    v_mfma_f32_32x32x16_bf16 a[80:95], v[164:167], v[52:55], a[80:95]
    v_mfma_f32_32x32x16_bf16 a[144:159], v[164:167], v[56:59], a[144:159]
    s_waitcnt lgkmcnt(10)
    v_mfma_f32_32x32x16_bf16 a[32:47], v[168:171], v[48:51], a[32:47]
    v_mfma_f32_32x32x16_bf16 a[96:111], v[168:171], v[52:55], a[96:111]
    v_mfma_f32_32x32x16_bf16 a[160:175], v[168:171], v[56:59], a[160:175]
    s_waitcnt lgkmcnt(8)
    v_mfma_f32_32x32x16_bf16 a[48:63], v[172:175], v[48:51], a[48:63]
    v_mfma_f32_32x32x16_bf16 a[112:127], v[172:175], v[52:55], a[112:127]
    v_mfma_f32_32x32x16_bf16 a[176:191], v[172:175], v[56:59], a[176:191]
    s_waitcnt vmcnt(38)
    ds_read_b64_tr_b16 v[160:161], v200 offset:24576
    ds_read_b64_tr_b16 v[162:163], v201 offset:24576
    ds_read_b64_tr_b16 v[164:165], v202 offset:24576
    ds_read_b64_tr_b16 v[166:167], v203 offset:24576
    ds_read_b64_tr_b16 v[168:169], v204 offset:24576
    ds_read_b64_tr_b16 v[170:171], v205 offset:24576
    ds_read_b64_tr_b16 v[172:173], v206 offset:24576
    ds_read_b64_tr_b16 v[174:175], v207 offset:24576
    s_add_u32 s43, s34, 245760
    s_add_u32 m0, s36, 16384
    s_nop 0
    buffer_load_dwordx4 v208, s[8:11], s43 offen offset:0 lds
    s_add_u32 s43, s34, 250880
    s_add_u32 m0, s36, 17408
    s_nop 0
    buffer_load_dwordx4 v209, s[8:11], s43 offen offset:0 lds
    s_add_u32 s43, s34, 256000
    s_add_u32 m0, s36, 18432
    s_nop 0
    buffer_load_dwordx4 v208, s[8:11], s43 offen offset:0 lds
    s_add_u32 s43, s34, 261120
    s_add_u32 m0, s36, 19456
    s_nop 0
    buffer_load_dwordx4 v209, s[8:11], s43 offen offset:0 lds
    s_add_u32 s44, s40, 12288
    buffer_load_dwordx4 v[48:51], v211, s[12:15], s44 offen offset:0
    s_add_u32 s45, s41, 12288
    buffer_load_dwordx4 v[52:55], v211, s[12:15], s45 offen offset:0
    s_add_u32 s46, s42, 12288
    buffer_load_dwordx4 v[56:59], v211, s[12:15], s46 offen offset:0
    s_waitcnt lgkmcnt(14)
    v_mfma_f32_32x32x16_bf16 a[0:15], v[176:179], v[60:63], a[0:15]
    v_mfma_f32_32x32x16_bf16 a[64:79], v[176:179], v[64:67], a[64:79]
    v_mfma_f32_32x32x16_bf16 a[128:143], v[176:179], v[68:71], a[128:143]
    s_waitcnt lgkmcnt(12)
    v_mfma_f32_32x32x16_bf16 a[16:31], v[180:183], v[60:63], a[16:31]
    v_mfma_f32_32x32x16_bf16 a[80:95], v[180:183], v[64:67], a[80:95]
    v_mfma_f32_32x32x16_bf16 a[144:159], v[180:183], v[68:71], a[144:159]
    s_waitcnt lgkmcnt(10)
    v_mfma_f32_32x32x16_bf16 a[32:47], v[184:187], v[60:63], a[32:47]
    v_mfma_f32_32x32x16_bf16 a[96:111], v[184:187], v[64:67], a[96:111]
    v_mfma_f32_32x32x16_bf16 a[160:175], v[184:187], v[68:71], a[160:175]
    s_waitcnt lgkmcnt(8)
    v_mfma_f32_32x32x16_bf16 a[48:63], v[188:191], v[60:63], a[48:63]
    v_mfma_f32_32x32x16_bf16 a[112:127], v[188:191], v[64:67], a[112:127]
    v_mfma_f32_32x32x16_bf16 a[176:191], v[188:191], v[68:71], a[176:191]
    s_waitcnt vmcnt(38)
    ds_read_b64_tr_b16 v[176:177], v200 offset:28672
    ds_read_b64_tr_b16 v[178:179], v201 offset:28672
    ds_read_b64_tr_b16 v[180:181], v202 offset:28672
    ds_read_b64_tr_b16 v[182:183], v203 offset:28672
    ds_read_b64_tr_b16 v[184:185], v204 offset:28672
    ds_read_b64_tr_b16 v[186:187], v205 offset:28672
    ds_read_b64_tr_b16 v[188:189], v206 offset:28672
    ds_read_b64_tr_b16 v[190:191], v207 offset:28672
    s_add_u32 s43, s34, 266240
    s_add_u32 m0, s36, 20480
    s_nop 0
    buffer_load_dwordx4 v208, s[8:11], s43 offen offset:0 lds
    s_add_u32 s43, s34, 271360
    s_add_u32 m0, s36, 21504
    s_nop 0
    buffer_load_dwordx4 v209, s[8:11], s43 offen offset:0 lds
    s_add_u32 s43, s34, 276480
    s_add_u32 m0, s36, 22528
    s_nop 0
    buffer_load_dwordx4 v208, s[8:11], s43 offen offset:0 lds
    s_add_u32 s43, s34, 281600
    s_add_u32 m0, s36, 23552
    s_nop 0
    buffer_load_dwordx4 v209, s[8:11], s43 offen offset:0 lds
    s_add_u32 s44, s40, 12288
    buffer_load_dwordx4 v[60:63], v211, s[12:15], s44 offen offset:1024
    s_add_u32 s45, s41, 12288
    buffer_load_dwordx4 v[64:67], v211, s[12:15], s45 offen offset:1024
    s_add_u32 s46, s42, 12288
    buffer_load_dwordx4 v[68:71], v211, s[12:15], s46 offen offset:1024
    s_waitcnt lgkmcnt(14)
    v_mfma_f32_32x32x16_bf16 a[0:15], v[160:163], v[72:75], a[0:15]
    v_mfma_f32_32x32x16_bf16 a[64:79], v[160:163], v[76:79], a[64:79]
    v_mfma_f32_32x32x16_bf16 a[128:143], v[160:163], v[80:83], a[128:143]
    s_waitcnt lgkmcnt(12)
    v_mfma_f32_32x32x16_bf16 a[16:31], v[164:167], v[72:75], a[16:31]
    v_mfma_f32_32x32x16_bf16 a[80:95], v[164:167], v[76:79], a[80:95]
    v_mfma_f32_32x32x16_bf16 a[144:159], v[164:167], v[80:83], a[144:159]
    s_waitcnt lgkmcnt(10)
    v_mfma_f32_32x32x16_bf16 a[32:47], v[168:171], v[72:75], a[32:47]
    v_mfma_f32_32x32x16_bf16 a[96:111], v[168:171], v[76:79], a[96:111]
    v_mfma_f32_32x32x16_bf16 a[160:175], v[168:171], v[80:83], a[160:175]
    s_waitcnt lgkmcnt(8)
    v_mfma_f32_32x32x16_bf16 a[48:63], v[172:175], v[72:75], a[48:63]
    v_mfma_f32_32x32x16_bf16 a[112:127], v[172:175], v[76:79], a[112:127]
    v_mfma_f32_32x32x16_bf16 a[176:191], v[172:175], v[80:83], a[176:191]
    s_waitcnt vmcnt(38)
    ds_read_b64_tr_b16 v[160:161], v200 offset:0
    ds_read_b64_tr_b16 v[162:163], v201 offset:0
    ds_read_b64_tr_b16 v[164:165], v202 offset:0
    ds_read_b64_tr_b16 v[166:167], v203 offset:0
    ds_read_b64_tr_b16 v[168:169], v204 offset:0
    ds_read_b64_tr_b16 v[170:171], v205 offset:0
    ds_read_b64_tr_b16 v[172:173], v206 offset:0
    ds_read_b64_tr_b16 v[174:175], v207 offset:0
    s_add_u32 s43, s34, 286720
    s_add_u32 m0, s36, 24576
    s_nop 0
    buffer_load_dwordx4 v208, s[8:11], s43 offen offset:0 lds
    s_add_u32 s43, s34, 291840
    s_add_u32 m0, s36, 25600
    s_nop 0
    buffer_load_dwordx4 v209, s[8:11], s43 offen offset:0 lds
    s_add_u32 s43, s34, 296960
    s_add_u32 m0, s36, 26624
    s_nop 0
    buffer_load_dwordx4 v208, s[8:11], s43 offen offset:0 lds
    s_add_u32 s43, s34, 302080
    s_add_u32 m0, s36, 27648
    s_nop 0
    buffer_load_dwordx4 v209, s[8:11], s43 offen offset:0 lds
    s_add_u32 s44, s40, 12288
    buffer_load_dwordx4 v[72:75], v211, s[12:15], s44 offen offset:2048
    s_add_u32 s45, s41, 12288
    buffer_load_dwordx4 v[76:79], v211, s[12:15], s45 offen offset:2048
    s_add_u32 s46, s42, 12288
    buffer_load_dwordx4 v[80:83], v211, s[12:15], s46 offen offset:2048
    s_waitcnt lgkmcnt(14)
    v_mfma_f32_32x32x16_bf16 a[0:15], v[176:179], v[84:87], a[0:15]
    v_mfma_f32_32x32x16_bf16 a[64:79], v[176:179], v[88:91], a[64:79]
    v_mfma_f32_32x32x16_bf16 a[128:143], v[176:179], v[92:95], a[128:143]
    s_waitcnt lgkmcnt(12)
    v_mfma_f32_32x32x16_bf16 a[16:31], v[180:183], v[84:87], a[16:31]
    v_mfma_f32_32x32x16_bf16 a[80:95], v[180:183], v[88:91], a[80:95]
    v_mfma_f32_32x32x16_bf16 a[144:159], v[180:183], v[92:95], a[144:159]
    s_waitcnt lgkmcnt(10)
    v_mfma_f32_32x32x16_bf16 a[32:47], v[184:187], v[84:87], a[32:47]
    v_mfma_f32_32x32x16_bf16 a[96:111], v[184:187], v[88:91], a[96:111]
    v_mfma_f32_32x32x16_bf16 a[160:175], v[184:187], v[92:95], a[160:175]
    s_waitcnt lgkmcnt(8)
    v_mfma_f32_32x32x16_bf16 a[48:63], v[188:191], v[84:87], a[48:63]
    v_mfma_f32_32x32x16_bf16 a[112:127], v[188:191], v[88:91], a[112:127]
    v_mfma_f32_32x32x16_bf16 a[176:191], v[188:191], v[92:95], a[176:191]
    s_add_u32 s34, s34, 163840
    s_add_u32 s40, s40, 8192
    s_add_u32 s41, s41, 8192
    s_add_u32 s42, s42, 8192
    s_sub_u32 s50, s50, 1
    s_cmp_lg_u32 s50, 0
    s_cbranch_scc1 oproj_kernel_loop
    s_waitcnt vmcnt(38)
    ds_read_b64_tr_b16 v[176:177], v200 offset:4096
    ds_read_b64_tr_b16 v[178:179], v201 offset:4096
    ds_read_b64_tr_b16 v[180:181], v202 offset:4096
    ds_read_b64_tr_b16 v[182:183], v203 offset:4096
    ds_read_b64_tr_b16 v[184:185], v204 offset:4096
    ds_read_b64_tr_b16 v[186:187], v205 offset:4096
    ds_read_b64_tr_b16 v[188:189], v206 offset:4096
    ds_read_b64_tr_b16 v[190:191], v207 offset:4096
    s_add_u32 s43, s34, 143360
    s_add_u32 m0, s36, 28672
    s_nop 0
    buffer_load_dwordx4 v208, s[8:11], s43 offen offset:0 lds
    s_add_u32 s43, s34, 148480
    s_add_u32 m0, s36, 29696
    s_nop 0
    buffer_load_dwordx4 v209, s[8:11], s43 offen offset:0 lds
    s_add_u32 s43, s34, 153600
    s_add_u32 m0, s36, 30720
    s_nop 0
    buffer_load_dwordx4 v208, s[8:11], s43 offen offset:0 lds
    s_add_u32 s43, s34, 158720
    s_add_u32 m0, s36, 31744
    s_nop 0
    buffer_load_dwordx4 v209, s[8:11], s43 offen offset:0 lds
    s_add_u32 s44, s40, 4096
    buffer_load_dwordx4 v[84:87], v211, s[12:15], s44 offen offset:3072
    s_add_u32 s45, s41, 4096
    buffer_load_dwordx4 v[88:91], v211, s[12:15], s45 offen offset:3072
    s_add_u32 s46, s42, 4096
    buffer_load_dwordx4 v[92:95], v211, s[12:15], s46 offen offset:3072
    s_waitcnt lgkmcnt(14)
    v_mfma_f32_32x32x16_bf16 a[0:15], v[160:163], v[0:3], a[0:15]
    v_mfma_f32_32x32x16_bf16 a[64:79], v[160:163], v[4:7], a[64:79]
    v_mfma_f32_32x32x16_bf16 a[128:143], v[160:163], v[8:11], a[128:143]
    s_waitcnt lgkmcnt(12)
    v_mfma_f32_32x32x16_bf16 a[16:31], v[164:167], v[0:3], a[16:31]
    v_mfma_f32_32x32x16_bf16 a[80:95], v[164:167], v[4:7], a[80:95]
    v_mfma_f32_32x32x16_bf16 a[144:159], v[164:167], v[8:11], a[144:159]
    s_waitcnt lgkmcnt(10)
    v_mfma_f32_32x32x16_bf16 a[32:47], v[168:171], v[0:3], a[32:47]
    v_mfma_f32_32x32x16_bf16 a[96:111], v[168:171], v[4:7], a[96:111]
    v_mfma_f32_32x32x16_bf16 a[160:175], v[168:171], v[8:11], a[160:175]
    s_waitcnt lgkmcnt(8)
    v_mfma_f32_32x32x16_bf16 a[48:63], v[172:175], v[0:3], a[48:63]
    v_mfma_f32_32x32x16_bf16 a[112:127], v[172:175], v[4:7], a[112:127]
    v_mfma_f32_32x32x16_bf16 a[176:191], v[172:175], v[8:11], a[176:191]
    s_waitcnt vmcnt(38)
    ds_read_b64_tr_b16 v[160:161], v200 offset:8192
    ds_read_b64_tr_b16 v[162:163], v201 offset:8192
    ds_read_b64_tr_b16 v[164:165], v202 offset:8192
    ds_read_b64_tr_b16 v[166:167], v203 offset:8192
    ds_read_b64_tr_b16 v[168:169], v204 offset:8192
    ds_read_b64_tr_b16 v[170:171], v205 offset:8192
    ds_read_b64_tr_b16 v[172:173], v206 offset:8192
    ds_read_b64_tr_b16 v[174:175], v207 offset:8192
    s_waitcnt lgkmcnt(14)
    v_mfma_f32_32x32x16_bf16 a[0:15], v[176:179], v[12:15], a[0:15]
    v_mfma_f32_32x32x16_bf16 a[64:79], v[176:179], v[16:19], a[64:79]
    v_mfma_f32_32x32x16_bf16 a[128:143], v[176:179], v[20:23], a[128:143]
    s_waitcnt lgkmcnt(12)
    v_mfma_f32_32x32x16_bf16 a[16:31], v[180:183], v[12:15], a[16:31]
    v_mfma_f32_32x32x16_bf16 a[80:95], v[180:183], v[16:19], a[80:95]
    v_mfma_f32_32x32x16_bf16 a[144:159], v[180:183], v[20:23], a[144:159]
    s_waitcnt lgkmcnt(10)
    v_mfma_f32_32x32x16_bf16 a[32:47], v[184:187], v[12:15], a[32:47]
    v_mfma_f32_32x32x16_bf16 a[96:111], v[184:187], v[16:19], a[96:111]
    v_mfma_f32_32x32x16_bf16 a[160:175], v[184:187], v[20:23], a[160:175]
    s_waitcnt lgkmcnt(8)
    v_mfma_f32_32x32x16_bf16 a[48:63], v[188:191], v[12:15], a[48:63]
    v_mfma_f32_32x32x16_bf16 a[112:127], v[188:191], v[16:19], a[112:127]
    v_mfma_f32_32x32x16_bf16 a[176:191], v[188:191], v[20:23], a[176:191]
    s_waitcnt vmcnt(31)
    ds_read_b64_tr_b16 v[176:177], v200 offset:12288
    ds_read_b64_tr_b16 v[178:179], v201 offset:12288
    ds_read_b64_tr_b16 v[180:181], v202 offset:12288
    ds_read_b64_tr_b16 v[182:183], v203 offset:12288
    ds_read_b64_tr_b16 v[184:185], v204 offset:12288
    ds_read_b64_tr_b16 v[186:187], v205 offset:12288
    ds_read_b64_tr_b16 v[188:189], v206 offset:12288
    ds_read_b64_tr_b16 v[190:191], v207 offset:12288
    s_waitcnt lgkmcnt(14)
    v_mfma_f32_32x32x16_bf16 a[0:15], v[160:163], v[24:27], a[0:15]
    v_mfma_f32_32x32x16_bf16 a[64:79], v[160:163], v[28:31], a[64:79]
    v_mfma_f32_32x32x16_bf16 a[128:143], v[160:163], v[32:35], a[128:143]
    s_waitcnt lgkmcnt(12)
    v_mfma_f32_32x32x16_bf16 a[16:31], v[164:167], v[24:27], a[16:31]
    v_mfma_f32_32x32x16_bf16 a[80:95], v[164:167], v[28:31], a[80:95]
    v_mfma_f32_32x32x16_bf16 a[144:159], v[164:167], v[32:35], a[144:159]
    s_waitcnt lgkmcnt(10)
    v_mfma_f32_32x32x16_bf16 a[32:47], v[168:171], v[24:27], a[32:47]
    v_mfma_f32_32x32x16_bf16 a[96:111], v[168:171], v[28:31], a[96:111]
    v_mfma_f32_32x32x16_bf16 a[160:175], v[168:171], v[32:35], a[160:175]
    s_waitcnt lgkmcnt(8)
    v_mfma_f32_32x32x16_bf16 a[48:63], v[172:175], v[24:27], a[48:63]
    v_mfma_f32_32x32x16_bf16 a[112:127], v[172:175], v[28:31], a[112:127]
    v_mfma_f32_32x32x16_bf16 a[176:191], v[172:175], v[32:35], a[176:191]
    s_waitcnt vmcnt(24)
    ds_read_b64_tr_b16 v[160:161], v200 offset:16384
    ds_read_b64_tr_b16 v[162:163], v201 offset:16384
    ds_read_b64_tr_b16 v[164:165], v202 offset:16384
    ds_read_b64_tr_b16 v[166:167], v203 offset:16384
    ds_read_b64_tr_b16 v[168:169], v204 offset:16384
    ds_read_b64_tr_b16 v[170:171], v205 offset:16384
    ds_read_b64_tr_b16 v[172:173], v206 offset:16384
    ds_read_b64_tr_b16 v[174:175], v207 offset:16384
    s_waitcnt lgkmcnt(14)
    v_mfma_f32_32x32x16_bf16 a[0:15], v[176:179], v[36:39], a[0:15]
    v_mfma_f32_32x32x16_bf16 a[64:79], v[176:179], v[40:43], a[64:79]
    v_mfma_f32_32x32x16_bf16 a[128:143], v[176:179], v[44:47], a[128:143]
    s_waitcnt lgkmcnt(12)
    v_mfma_f32_32x32x16_bf16 a[16:31], v[180:183], v[36:39], a[16:31]
    v_mfma_f32_32x32x16_bf16 a[80:95], v[180:183], v[40:43], a[80:95]
    v_mfma_f32_32x32x16_bf16 a[144:159], v[180:183], v[44:47], a[144:159]
    s_waitcnt lgkmcnt(10)
    v_mfma_f32_32x32x16_bf16 a[32:47], v[184:187], v[36:39], a[32:47]
    v_mfma_f32_32x32x16_bf16 a[96:111], v[184:187], v[40:43], a[96:111]
    v_mfma_f32_32x32x16_bf16 a[160:175], v[184:187], v[44:47], a[160:175]
    s_waitcnt lgkmcnt(8)
    v_mfma_f32_32x32x16_bf16 a[48:63], v[188:191], v[36:39], a[48:63]
    v_mfma_f32_32x32x16_bf16 a[112:127], v[188:191], v[40:43], a[112:127]
    v_mfma_f32_32x32x16_bf16 a[176:191], v[188:191], v[44:47], a[176:191]
    s_waitcnt vmcnt(17)
    ds_read_b64_tr_b16 v[176:177], v200 offset:20480
    ds_read_b64_tr_b16 v[178:179], v201 offset:20480
    ds_read_b64_tr_b16 v[180:181], v202 offset:20480
    ds_read_b64_tr_b16 v[182:183], v203 offset:20480
    ds_read_b64_tr_b16 v[184:185], v204 offset:20480
    ds_read_b64_tr_b16 v[186:187], v205 offset:20480
    ds_read_b64_tr_b16 v[188:189], v206 offset:20480
    ds_read_b64_tr_b16 v[190:191], v207 offset:20480
    s_waitcnt lgkmcnt(14)
    v_mfma_f32_32x32x16_bf16 a[0:15], v[160:163], v[48:51], a[0:15]
    v_mfma_f32_32x32x16_bf16 a[64:79], v[160:163], v[52:55], a[64:79]
    v_mfma_f32_32x32x16_bf16 a[128:143], v[160:163], v[56:59], a[128:143]
    s_waitcnt lgkmcnt(12)
    v_mfma_f32_32x32x16_bf16 a[16:31], v[164:167], v[48:51], a[16:31]
    v_mfma_f32_32x32x16_bf16 a[80:95], v[164:167], v[52:55], a[80:95]
    v_mfma_f32_32x32x16_bf16 a[144:159], v[164:167], v[56:59], a[144:159]
    s_waitcnt lgkmcnt(10)
    v_mfma_f32_32x32x16_bf16 a[32:47], v[168:171], v[48:51], a[32:47]
    v_mfma_f32_32x32x16_bf16 a[96:111], v[168:171], v[52:55], a[96:111]
    v_mfma_f32_32x32x16_bf16 a[160:175], v[168:171], v[56:59], a[160:175]
    s_waitcnt lgkmcnt(8)
    v_mfma_f32_32x32x16_bf16 a[48:63], v[172:175], v[48:51], a[48:63]
    v_mfma_f32_32x32x16_bf16 a[112:127], v[172:175], v[52:55], a[112:127]
    v_mfma_f32_32x32x16_bf16 a[176:191], v[172:175], v[56:59], a[176:191]
    s_waitcnt vmcnt(10)
    ds_read_b64_tr_b16 v[160:161], v200 offset:24576
    ds_read_b64_tr_b16 v[162:163], v201 offset:24576
    ds_read_b64_tr_b16 v[164:165], v202 offset:24576
    ds_read_b64_tr_b16 v[166:167], v203 offset:24576
    ds_read_b64_tr_b16 v[168:169], v204 offset:24576
    ds_read_b64_tr_b16 v[170:171], v205 offset:24576
    ds_read_b64_tr_b16 v[172:173], v206 offset:24576
    ds_read_b64_tr_b16 v[174:175], v207 offset:24576
    s_waitcnt lgkmcnt(14)
    v_mfma_f32_32x32x16_bf16 a[0:15], v[176:179], v[60:63], a[0:15]
    v_mfma_f32_32x32x16_bf16 a[64:79], v[176:179], v[64:67], a[64:79]
    v_mfma_f32_32x32x16_bf16 a[128:143], v[176:179], v[68:71], a[128:143]
    s_waitcnt lgkmcnt(12)
    v_mfma_f32_32x32x16_bf16 a[16:31], v[180:183], v[60:63], a[16:31]
    v_mfma_f32_32x32x16_bf16 a[80:95], v[180:183], v[64:67], a[80:95]
    v_mfma_f32_32x32x16_bf16 a[144:159], v[180:183], v[68:71], a[144:159]
    s_waitcnt lgkmcnt(10)
    v_mfma_f32_32x32x16_bf16 a[32:47], v[184:187], v[60:63], a[32:47]
    v_mfma_f32_32x32x16_bf16 a[96:111], v[184:187], v[64:67], a[96:111]
    v_mfma_f32_32x32x16_bf16 a[160:175], v[184:187], v[68:71], a[160:175]
    s_waitcnt lgkmcnt(8)
    v_mfma_f32_32x32x16_bf16 a[48:63], v[188:191], v[60:63], a[48:63]
    v_mfma_f32_32x32x16_bf16 a[112:127], v[188:191], v[64:67], a[112:127]
    v_mfma_f32_32x32x16_bf16 a[176:191], v[188:191], v[68:71], a[176:191]
    s_waitcnt vmcnt(3)
    ds_read_b64_tr_b16 v[176:177], v200 offset:28672
    ds_read_b64_tr_b16 v[178:179], v201 offset:28672
    ds_read_b64_tr_b16 v[180:181], v202 offset:28672
    ds_read_b64_tr_b16 v[182:183], v203 offset:28672
    ds_read_b64_tr_b16 v[184:185], v204 offset:28672
    ds_read_b64_tr_b16 v[186:187], v205 offset:28672
    ds_read_b64_tr_b16 v[188:189], v206 offset:28672
    ds_read_b64_tr_b16 v[190:191], v207 offset:28672
    s_waitcnt lgkmcnt(14)
    v_mfma_f32_32x32x16_bf16 a[0:15], v[160:163], v[72:75], a[0:15]
    v_mfma_f32_32x32x16_bf16 a[64:79], v[160:163], v[76:79], a[64:79]
    v_mfma_f32_32x32x16_bf16 a[128:143], v[160:163], v[80:83], a[128:143]
    s_waitcnt lgkmcnt(12)
    v_mfma_f32_32x32x16_bf16 a[16:31], v[164:167], v[72:75], a[16:31]
    v_mfma_f32_32x32x16_bf16 a[80:95], v[164:167], v[76:79], a[80:95]
    v_mfma_f32_32x32x16_bf16 a[144:159], v[164:167], v[80:83], a[144:159]
    s_waitcnt lgkmcnt(10)
    v_mfma_f32_32x32x16_bf16 a[32:47], v[168:171], v[72:75], a[32:47]
    v_mfma_f32_32x32x16_bf16 a[96:111], v[168:171], v[76:79], a[96:111]
    v_mfma_f32_32x32x16_bf16 a[160:175], v[168:171], v[80:83], a[160:175]
    s_waitcnt lgkmcnt(8)
    v_mfma_f32_32x32x16_bf16 a[48:63], v[172:175], v[72:75], a[48:63]
    v_mfma_f32_32x32x16_bf16 a[112:127], v[172:175], v[76:79], a[112:127]
    v_mfma_f32_32x32x16_bf16 a[176:191], v[172:175], v[80:83], a[176:191]
    s_waitcnt vmcnt(0)
    s_waitcnt lgkmcnt(6)
    v_mfma_f32_32x32x16_bf16 a[0:15], v[176:179], v[84:87], a[0:15]
    v_mfma_f32_32x32x16_bf16 a[64:79], v[176:179], v[88:91], a[64:79]
    v_mfma_f32_32x32x16_bf16 a[128:143], v[176:179], v[92:95], a[128:143]
    s_waitcnt lgkmcnt(4)
    v_mfma_f32_32x32x16_bf16 a[16:31], v[180:183], v[84:87], a[16:31]
    v_mfma_f32_32x32x16_bf16 a[80:95], v[180:183], v[88:91], a[80:95]
    v_mfma_f32_32x32x16_bf16 a[144:159], v[180:183], v[92:95], a[144:159]
    s_waitcnt lgkmcnt(2)
    v_mfma_f32_32x32x16_bf16 a[32:47], v[184:187], v[84:87], a[32:47]
    v_mfma_f32_32x32x16_bf16 a[96:111], v[184:187], v[88:91], a[96:111]
    v_mfma_f32_32x32x16_bf16 a[160:175], v[184:187], v[92:95], a[160:175]
    s_waitcnt lgkmcnt(0)
    v_mfma_f32_32x32x16_bf16 a[48:63], v[188:191], v[84:87], a[48:63]
    v_mfma_f32_32x32x16_bf16 a[112:127], v[188:191], v[88:91], a[112:127]
    v_mfma_f32_32x32x16_bf16 a[176:191], v[188:191], v[92:95], a[176:191]
    s_waitcnt vmcnt(0) lgkmcnt(0)
    s_barrier
    s_nop 15
    s_cmp_eq_u32 s28, 0
    s_cbranch_scc1 oproj_kernel_sk0
    s_sub_u32 s3, s28, 1
    s_and_b32 s3, s3, 3
    s_mul_i32 s3, s3, 12288
    s_add_u32 s3, s3, 0
    v_add_u32 v212, s3, v211
    ds_write_b128 v212, a[0:3] offset:0
    ds_write_b128 v212, a[4:7] offset:1024
    ds_write_b128 v212, a[8:11] offset:2048
    ds_write_b128 v212, a[12:15] offset:3072
    ds_write_b128 v212, a[64:67] offset:4096
    ds_write_b128 v212, a[68:71] offset:5120
    ds_write_b128 v212, a[72:75] offset:6144
    ds_write_b128 v212, a[76:79] offset:7168
    ds_write_b128 v212, a[128:131] offset:8192
    ds_write_b128 v212, a[132:135] offset:9216
    ds_write_b128 v212, a[136:139] offset:10240
    ds_write_b128 v212, a[140:143] offset:11264
    s_waitcnt lgkmcnt(0)
oproj_kernel_sk0:
    s_nop 1
    s_cmp_eq_u32 s28, 1
    s_cbranch_scc1 oproj_kernel_sk1
    s_sub_u32 s3, s28, 2
    s_and_b32 s3, s3, 3
    s_mul_i32 s3, s3, 12288
    s_add_u32 s3, s3, 36864
    v_add_u32 v212, s3, v211
    ds_write_b128 v212, a[16:19] offset:0
    ds_write_b128 v212, a[20:23] offset:1024
    ds_write_b128 v212, a[24:27] offset:2048
    ds_write_b128 v212, a[28:31] offset:3072
    ds_write_b128 v212, a[80:83] offset:4096
    ds_write_b128 v212, a[84:87] offset:5120
    ds_write_b128 v212, a[88:91] offset:6144
    ds_write_b128 v212, a[92:95] offset:7168
    ds_write_b128 v212, a[144:147] offset:8192
    ds_write_b128 v212, a[148:151] offset:9216
    ds_write_b128 v212, a[152:155] offset:10240
    ds_write_b128 v212, a[156:159] offset:11264
    s_waitcnt lgkmcnt(0)
oproj_kernel_sk1:
    s_nop 1
    s_cmp_eq_u32 s28, 2
    s_cbranch_scc1 oproj_kernel_sk2
    s_sub_u32 s3, s28, 3
    s_and_b32 s3, s3, 3
    s_mul_i32 s3, s3, 12288
    s_add_u32 s3, s3, 73728
    v_add_u32 v212, s3, v211
    ds_write_b128 v212, a[32:35] offset:0
    ds_write_b128 v212, a[36:39] offset:1024
    ds_write_b128 v212, a[40:43] offset:2048
    ds_write_b128 v212, a[44:47] offset:3072
    ds_write_b128 v212, a[96:99] offset:4096
    ds_write_b128 v212, a[100:103] offset:5120
    ds_write_b128 v212, a[104:107] offset:6144
    ds_write_b128 v212, a[108:111] offset:7168
    ds_write_b128 v212, a[160:163] offset:8192
    ds_write_b128 v212, a[164:167] offset:9216
    ds_write_b128 v212, a[168:171] offset:10240
    ds_write_b128 v212, a[172:175] offset:11264
    s_waitcnt lgkmcnt(0)
oproj_kernel_sk2:
    s_nop 1
    s_cmp_eq_u32 s28, 3
    s_cbranch_scc1 oproj_kernel_sk3
    s_sub_u32 s3, s28, 4
    s_and_b32 s3, s3, 3
    s_mul_i32 s3, s3, 12288
    s_add_u32 s3, s3, 110592
    v_add_u32 v212, s3, v211
    ds_write_b128 v212, a[48:51] offset:0
    ds_write_b128 v212, a[52:55] offset:1024
    ds_write_b128 v212, a[56:59] offset:2048
    ds_write_b128 v212, a[60:63] offset:3072
    ds_write_b128 v212, a[112:115] offset:4096
    ds_write_b128 v212, a[116:119] offset:5120
    ds_write_b128 v212, a[120:123] offset:6144
    ds_write_b128 v212, a[124:127] offset:7168
    ds_write_b128 v212, a[176:179] offset:8192
    ds_write_b128 v212, a[180:183] offset:9216
    ds_write_b128 v212, a[184:187] offset:10240
    ds_write_b128 v212, a[188:191] offset:11264
    s_waitcnt lgkmcnt(0)
oproj_kernel_sk3:
    s_nop 1
    s_waitcnt lgkmcnt(0)
    s_barrier
    s_cmp_lg_u32 s28, 0
    s_cbranch_scc1 oproj_kernel_mv0
    v_accvgpr_read_b32 v0, a0
    v_accvgpr_read_b32 v1, a1
    v_accvgpr_read_b32 v2, a2
    v_accvgpr_read_b32 v3, a3
    v_accvgpr_read_b32 v4, a4
    v_accvgpr_read_b32 v5, a5
    v_accvgpr_read_b32 v6, a6
    v_accvgpr_read_b32 v7, a7
    v_accvgpr_read_b32 v8, a8
    v_accvgpr_read_b32 v9, a9
    v_accvgpr_read_b32 v10, a10
    v_accvgpr_read_b32 v11, a11
    v_accvgpr_read_b32 v12, a12
    v_accvgpr_read_b32 v13, a13
    v_accvgpr_read_b32 v14, a14
    v_accvgpr_read_b32 v15, a15
    v_accvgpr_read_b32 v16, a64
    v_accvgpr_read_b32 v17, a65
    v_accvgpr_read_b32 v18, a66
    v_accvgpr_read_b32 v19, a67
    v_accvgpr_read_b32 v20, a68
    v_accvgpr_read_b32 v21, a69
    v_accvgpr_read_b32 v22, a70
    v_accvgpr_read_b32 v23, a71
    v_accvgpr_read_b32 v24, a72
    v_accvgpr_read_b32 v25, a73
    v_accvgpr_read_b32 v26, a74
    v_accvgpr_read_b32 v27, a75
    v_accvgpr_read_b32 v28, a76
    v_accvgpr_read_b32 v29, a77
    v_accvgpr_read_b32 v30, a78
    v_accvgpr_read_b32 v31, a79
    v_accvgpr_read_b32 v32, a128
    v_accvgpr_read_b32 v33, a129
    v_accvgpr_read_b32 v34, a130
    v_accvgpr_read_b32 v35, a131
    v_accvgpr_read_b32 v36, a132
    v_accvgpr_read_b32 v37, a133
    v_accvgpr_read_b32 v38, a134
    v_accvgpr_read_b32 v39, a135
    v_accvgpr_read_b32 v40, a136
    v_accvgpr_read_b32 v41, a137
    v_accvgpr_read_b32 v42, a138
    v_accvgpr_read_b32 v43, a139
    v_accvgpr_read_b32 v44, a140
    v_accvgpr_read_b32 v45, a141
    v_accvgpr_read_b32 v46, a142
    v_accvgpr_read_b32 v47, a143
oproj_kernel_mv0:
    s_nop 1
    s_cmp_lg_u32 s28, 1
    s_cbranch_scc1 oproj_kernel_mv1
    v_accvgpr_read_b32 v0, a16
    v_accvgpr_read_b32 v1, a17
    v_accvgpr_read_b32 v2, a18
    v_accvgpr_read_b32 v3, a19
    v_accvgpr_read_b32 v4, a20
    v_accvgpr_read_b32 v5, a21
    v_accvgpr_read_b32 v6, a22
    v_accvgpr_read_b32 v7, a23
    v_accvgpr_read_b32 v8, a24
    v_accvgpr_read_b32 v9, a25
    v_accvgpr_read_b32 v10, a26
    v_accvgpr_read_b32 v11, a27
    v_accvgpr_read_b32 v12, a28
    v_accvgpr_read_b32 v13, a29
    v_accvgpr_read_b32 v14, a30
    v_accvgpr_read_b32 v15, a31
    v_accvgpr_read_b32 v16, a80
    v_accvgpr_read_b32 v17, a81
    v_accvgpr_read_b32 v18, a82
    v_accvgpr_read_b32 v19, a83
    v_accvgpr_read_b32 v20, a84
    v_accvgpr_read_b32 v21, a85
    v_accvgpr_read_b32 v22, a86
    v_accvgpr_read_b32 v23, a87
    v_accvgpr_read_b32 v24, a88
    v_accvgpr_read_b32 v25, a89
    v_accvgpr_read_b32 v26, a90
    v_accvgpr_read_b32 v27, a91
    v_accvgpr_read_b32 v28, a92
    v_accvgpr_read_b32 v29, a93
    v_accvgpr_read_b32 v30, a94
    v_accvgpr_read_b32 v31, a95
    v_accvgpr_read_b32 v32, a144
    v_accvgpr_read_b32 v33, a145
    v_accvgpr_read_b32 v34, a146
    v_accvgpr_read_b32 v35, a147
    v_accvgpr_read_b32 v36, a148
    v_accvgpr_read_b32 v37, a149
    v_accvgpr_read_b32 v38, a150
    v_accvgpr_read_b32 v39, a151
    v_accvgpr_read_b32 v40, a152
    v_accvgpr_read_b32 v41, a153
    v_accvgpr_read_b32 v42, a154
    v_accvgpr_read_b32 v43, a155
    v_accvgpr_read_b32 v44, a156
    v_accvgpr_read_b32 v45, a157
    v_accvgpr_read_b32 v46, a158
    v_accvgpr_read_b32 v47, a159
oproj_kernel_mv1:
    s_nop 1
    s_cmp_lg_u32 s28, 2
    s_cbranch_scc1 oproj_kernel_mv2
    v_accvgpr_read_b32 v0, a32
    v_accvgpr_read_b32 v1, a33
    v_accvgpr_read_b32 v2, a34
    v_accvgpr_read_b32 v3, a35
    v_accvgpr_read_b32 v4, a36
    v_accvgpr_read_b32 v5, a37
    v_accvgpr_read_b32 v6, a38
    v_accvgpr_read_b32 v7, a39
    v_accvgpr_read_b32 v8, a40
    v_accvgpr_read_b32 v9, a41
    v_accvgpr_read_b32 v10, a42
    v_accvgpr_read_b32 v11, a43
    v_accvgpr_read_b32 v12, a44
    v_accvgpr_read_b32 v13, a45
    v_accvgpr_read_b32 v14, a46
    v_accvgpr_read_b32 v15, a47
    v_accvgpr_read_b32 v16, a96
    v_accvgpr_read_b32 v17, a97
    v_accvgpr_read_b32 v18, a98
    v_accvgpr_read_b32 v19, a99
    v_accvgpr_read_b32 v20, a100
    v_accvgpr_read_b32 v21, a101
    v_accvgpr_read_b32 v22, a102
    v_accvgpr_read_b32 v23, a103
    v_accvgpr_read_b32 v24, a104
    v_accvgpr_read_b32 v25, a105
    v_accvgpr_read_b32 v26, a106
    v_accvgpr_read_b32 v27, a107
    v_accvgpr_read_b32 v28, a108
    v_accvgpr_read_b32 v29, a109
    v_accvgpr_read_b32 v30, a110
    v_accvgpr_read_b32 v31, a111
    v_accvgpr_read_b32 v32, a160
    v_accvgpr_read_b32 v33, a161
    v_accvgpr_read_b32 v34, a162
    v_accvgpr_read_b32 v35, a163
    v_accvgpr_read_b32 v36, a164
    v_accvgpr_read_b32 v37, a165
    v_accvgpr_read_b32 v38, a166
    v_accvgpr_read_b32 v39, a167
    v_accvgpr_read_b32 v40, a168
    v_accvgpr_read_b32 v41, a169
    v_accvgpr_read_b32 v42, a170
    v_accvgpr_read_b32 v43, a171
    v_accvgpr_read_b32 v44, a172
    v_accvgpr_read_b32 v45, a173
    v_accvgpr_read_b32 v46, a174
    v_accvgpr_read_b32 v47, a175
oproj_kernel_mv2:
    s_nop 1
    s_cmp_lg_u32 s28, 3
    s_cbranch_scc1 oproj_kernel_mv3
    v_accvgpr_read_b32 v0, a48
    v_accvgpr_read_b32 v1, a49
    v_accvgpr_read_b32 v2, a50
    v_accvgpr_read_b32 v3, a51
    v_accvgpr_read_b32 v4, a52
    v_accvgpr_read_b32 v5, a53
    v_accvgpr_read_b32 v6, a54
    v_accvgpr_read_b32 v7, a55
    v_accvgpr_read_b32 v8, a56
    v_accvgpr_read_b32 v9, a57
    v_accvgpr_read_b32 v10, a58
    v_accvgpr_read_b32 v11, a59
    v_accvgpr_read_b32 v12, a60
    v_accvgpr_read_b32 v13, a61
    v_accvgpr_read_b32 v14, a62
    v_accvgpr_read_b32 v15, a63
    v_accvgpr_read_b32 v16, a112
    v_accvgpr_read_b32 v17, a113
    v_accvgpr_read_b32 v18, a114
    v_accvgpr_read_b32 v19, a115
    v_accvgpr_read_b32 v20, a116
    v_accvgpr_read_b32 v21, a117
    v_accvgpr_read_b32 v22, a118
    v_accvgpr_read_b32 v23, a119
    v_accvgpr_read_b32 v24, a120
    v_accvgpr_read_b32 v25, a121
    v_accvgpr_read_b32 v26, a122
    v_accvgpr_read_b32 v27, a123
    v_accvgpr_read_b32 v28, a124
    v_accvgpr_read_b32 v29, a125
    v_accvgpr_read_b32 v30, a126
    v_accvgpr_read_b32 v31, a127
    v_accvgpr_read_b32 v32, a176
    v_accvgpr_read_b32 v33, a177
    v_accvgpr_read_b32 v34, a178
    v_accvgpr_read_b32 v35, a179
    v_accvgpr_read_b32 v36, a180
    v_accvgpr_read_b32 v37, a181
    v_accvgpr_read_b32 v38, a182
    v_accvgpr_read_b32 v39, a183
    v_accvgpr_read_b32 v40, a184
    v_accvgpr_read_b32 v41, a185
    v_accvgpr_read_b32 v42, a186
    v_accvgpr_read_b32 v43, a187
    v_accvgpr_read_b32 v44, a188
    v_accvgpr_read_b32 v45, a189
    v_accvgpr_read_b32 v46, a190
    v_accvgpr_read_b32 v47, a191
oproj_kernel_mv3:
    s_nop 1
    s_mul_i32 s3, s28, 36864
    v_add_u32 v212, s3, v211
    ds_read_b128 v[48:51], v212 offset:0
    ds_read_b128 v[52:55], v212 offset:1024
    ds_read_b128 v[56:59], v212 offset:2048
    ds_read_b128 v[60:63], v212 offset:3072
    ds_read_b128 v[64:67], v212 offset:4096
    ds_read_b128 v[68:71], v212 offset:5120
    ds_read_b128 v[72:75], v212 offset:6144
    ds_read_b128 v[76:79], v212 offset:7168
    ds_read_b128 v[80:83], v212 offset:8192
    ds_read_b128 v[84:87], v212 offset:9216
    ds_read_b128 v[88:91], v212 offset:10240
    ds_read_b128 v[92:95], v212 offset:11264
    s_waitcnt lgkmcnt(0)
    ds_read_b128 v[96:99], v212 offset:12288
    ds_read_b128 v[100:103], v212 offset:13312
    ds_read_b128 v[104:107], v212 offset:14336
    ds_read_b128 v[108:111], v212 offset:15360
    ds_read_b128 v[112:115], v212 offset:16384
    ds_read_b128 v[116:119], v212 offset:17408
    ds_read_b128 v[120:123], v212 offset:18432
    ds_read_b128 v[124:127], v212 offset:19456
    ds_read_b128 v[128:131], v212 offset:20480
    ds_read_b128 v[132:135], v212 offset:21504
    ds_read_b128 v[136:139], v212 offset:22528
    ds_read_b128 v[140:143], v212 offset:23552
    s_waitcnt lgkmcnt(0)
    ds_read_b128 v[144:147], v212 offset:24576
    ds_read_b128 v[148:151], v212 offset:25600
    ds_read_b128 v[152:155], v212 offset:26624
    ds_read_b128 v[156:159], v212 offset:27648
    ds_read_b128 v[160:163], v212 offset:28672
    ds_read_b128 v[164:167], v212 offset:29696
    ds_read_b128 v[168:171], v212 offset:30720
    ds_read_b128 v[172:175], v212 offset:31744
    ds_read_b128 v[176:179], v212 offset:32768
    ds_read_b128 v[180:183], v212 offset:33792
    ds_read_b128 v[184:187], v212 offset:34816
    ds_read_b128 v[188:191], v212 offset:35840
    s_waitcnt lgkmcnt(0)
    v_add_f32 v0, v0, v48
    v_add_f32 v96, v96, v144
    v_add_f32 v1, v1, v49
    v_add_f32 v97, v97, v145
    v_add_f32 v2, v2, v50
    v_add_f32 v98, v98, v146
    v_add_f32 v3, v3, v51
    v_add_f32 v99, v99, v147
    v_add_f32 v4, v4, v52
    v_add_f32 v100, v100, v148
    v_add_f32 v5, v5, v53
    v_add_f32 v101, v101, v149
    v_add_f32 v6, v6, v54
    v_add_f32 v102, v102, v150
    v_add_f32 v7, v7, v55
    v_add_f32 v103, v103, v151
    v_add_f32 v8, v8, v56
    v_add_f32 v104, v104, v152
    v_add_f32 v9, v9, v57
    v_add_f32 v105, v105, v153
    v_add_f32 v10, v10, v58
    v_add_f32 v106, v106, v154
    v_add_f32 v11, v11, v59
    v_add_f32 v107, v107, v155
    v_add_f32 v12, v12, v60
    v_add_f32 v108, v108, v156
    v_add_f32 v13, v13, v61
    v_add_f32 v109, v109, v157
    v_add_f32 v14, v14, v62
    v_add_f32 v110, v110, v158
    v_add_f32 v15, v15, v63
    v_add_f32 v111, v111, v159
    v_add_f32 v16, v16, v64
    v_add_f32 v112, v112, v160
    v_add_f32 v17, v17, v65
    v_add_f32 v113, v113, v161
    v_add_f32 v18, v18, v66
    v_add_f32 v114, v114, v162
    v_add_f32 v19, v19, v67
    v_add_f32 v115, v115, v163
    v_add_f32 v20, v20, v68
    v_add_f32 v116, v116, v164
    v_add_f32 v21, v21, v69
    v_add_f32 v117, v117, v165
    v_add_f32 v22, v22, v70
    v_add_f32 v118, v118, v166
    v_add_f32 v23, v23, v71
    v_add_f32 v119, v119, v167
    v_add_f32 v24, v24, v72
    v_add_f32 v120, v120, v168
    v_add_f32 v25, v25, v73
    v_add_f32 v121, v121, v169
    v_add_f32 v26, v26, v74
    v_add_f32 v122, v122, v170
    v_add_f32 v27, v27, v75
    v_add_f32 v123, v123, v171
    v_add_f32 v28, v28, v76
    v_add_f32 v124, v124, v172
    v_add_f32 v29, v29, v77
    v_add_f32 v125, v125, v173
    v_add_f32 v30, v30, v78
    v_add_f32 v126, v126, v174
    v_add_f32 v31, v31, v79
    v_add_f32 v127, v127, v175
    v_add_f32 v32, v32, v80
    v_add_f32 v128, v128, v176
    v_add_f32 v33, v33, v81
    v_add_f32 v129, v129, v177
    v_add_f32 v34, v34, v82
    v_add_f32 v130, v130, v178
    v_add_f32 v35, v35, v83
    v_add_f32 v131, v131, v179
    v_add_f32 v36, v36, v84
    v_add_f32 v132, v132, v180
    v_add_f32 v37, v37, v85
    v_add_f32 v133, v133, v181
    v_add_f32 v38, v38, v86
    v_add_f32 v134, v134, v182
    v_add_f32 v39, v39, v87
    v_add_f32 v135, v135, v183
    v_add_f32 v40, v40, v88
    v_add_f32 v136, v136, v184
    v_add_f32 v41, v41, v89
    v_add_f32 v137, v137, v185
    v_add_f32 v42, v42, v90
    v_add_f32 v138, v138, v186
    v_add_f32 v43, v43, v91
    v_add_f32 v139, v139, v187
    v_add_f32 v44, v44, v92
    v_add_f32 v140, v140, v188
    v_add_f32 v45, v45, v93
    v_add_f32 v141, v141, v189
    v_add_f32 v46, v46, v94
    v_add_f32 v142, v142, v190
    v_add_f32 v47, v47, v95
    v_add_f32 v143, v143, v191
    v_add_f32 v0, v0, v96
    v_add_f32 v1, v1, v97
    v_add_f32 v2, v2, v98
    v_add_f32 v3, v3, v99
    v_add_f32 v4, v4, v100
    v_add_f32 v5, v5, v101
    v_add_f32 v6, v6, v102
    v_add_f32 v7, v7, v103
    v_add_f32 v8, v8, v104
    v_add_f32 v9, v9, v105
    v_add_f32 v10, v10, v106
    v_add_f32 v11, v11, v107
    v_add_f32 v12, v12, v108
    v_add_f32 v13, v13, v109
    v_add_f32 v14, v14, v110
    v_add_f32 v15, v15, v111
    v_add_f32 v16, v16, v112
    v_add_f32 v17, v17, v113
    v_add_f32 v18, v18, v114
    v_add_f32 v19, v19, v115
    v_add_f32 v20, v20, v116
    v_add_f32 v21, v21, v117
    v_add_f32 v22, v22, v118
    v_add_f32 v23, v23, v119
    v_add_f32 v24, v24, v120
    v_add_f32 v25, v25, v121
    v_add_f32 v26, v26, v122
    v_add_f32 v27, v27, v123
    v_add_f32 v28, v28, v124
    v_add_f32 v29, v29, v125
    v_add_f32 v30, v30, v126
    v_add_f32 v31, v31, v127
    v_add_f32 v32, v32, v128
    v_add_f32 v33, v33, v129
    v_add_f32 v34, v34, v130
    v_add_f32 v35, v35, v131
    v_add_f32 v36, v36, v132
    v_add_f32 v37, v37, v133
    v_add_f32 v38, v38, v134
    v_add_f32 v39, v39, v135
    v_add_f32 v40, v40, v136
    v_add_f32 v41, v41, v137
    v_add_f32 v42, v42, v138
    v_add_f32 v43, v43, v139
    v_add_f32 v44, v44, v140
    v_add_f32 v45, v45, v141
    v_add_f32 v46, v46, v142
    v_add_f32 v47, v47, v143
    v_cvt_pk_bf16_f32 v0, v0, v1
    v_cvt_pk_bf16_f32 v1, v2, v3
    v_cvt_pk_bf16_f32 v2, v4, v5
    v_cvt_pk_bf16_f32 v3, v6, v7
    v_cvt_pk_bf16_f32 v4, v8, v9
    v_cvt_pk_bf16_f32 v5, v10, v11
    v_cvt_pk_bf16_f32 v6, v12, v13
    v_cvt_pk_bf16_f32 v7, v14, v15
    v_cvt_pk_bf16_f32 v8, v16, v17
    v_cvt_pk_bf16_f32 v9, v18, v19
    v_cvt_pk_bf16_f32 v10, v20, v21
    v_cvt_pk_bf16_f32 v11, v22, v23
    v_cvt_pk_bf16_f32 v12, v24, v25
    v_cvt_pk_bf16_f32 v13, v26, v27
    v_cvt_pk_bf16_f32 v14, v28, v29
    v_cvt_pk_bf16_f32 v15, v30, v31
    v_cvt_pk_bf16_f32 v16, v32, v33
    v_cvt_pk_bf16_f32 v17, v34, v35
    v_cvt_pk_bf16_f32 v18, v36, v37
    v_cvt_pk_bf16_f32 v19, v38, v39
    v_cvt_pk_bf16_f32 v20, v40, v41
    v_cvt_pk_bf16_f32 v21, v42, v43
    v_cvt_pk_bf16_f32 v22, v44, v45
    v_cvt_pk_bf16_f32 v23, v46, v47
    v_and_b32 v213, 31, v210
    v_lshrrev_b32 v215, 5, v210
    v_lshlrev_b32 v215, 4, v215
    s_mul_i32 s3, s29, 1280
    s_lshl_b32 s4, s31, 8
    s_add_u32 s3, s3, s4
    s_lshl_b32 s4, s28, 6
    s_add_u32 s3, s3, s4
    v_add_u32 v215, s3, v215
    v_lshrrev_b32 v216, 4, v213
    v_mul_u32_u24 v216, 144, v216
    v_and_b32 v214, 15, v213
    v_add_u32 v216, v216, v214
    s_movk_i32 s7, 2560
    s_mul_i32 s3, s30, 3
    s_add_u32 s3, s3, 0
    s_lshr_b32 s4, s3, 2
    s_mul_i32 s4, s4, 144
    s_and_b32 s5, s3, 3
    s_lshl_b32 s5, s5, 5
    s_add_u32 s4, s4, s5
    s_sub_u32 s5, s3, 64
    s_mul_i32 s5, s5, 288
    s_add_u32 s5, s5, 128
    s_cmp_lt_u32 s3, 64
    s_cselect_b32 s4, s4, s5
    s_cselect_b64 vcc, -1, 0
    s_nop 0
    v_cndmask_b32 v214, v216, v213, vcc
    v_add_u32 v214, s4, v214
    v_mul_lo_u32 v214, v214, s7
    v_add_u32 v217, v214, v215
    buffer_store_dwordx4 v[0:3], v217, s[16:19], 0 offen offset:0
    buffer_store_dwordx4 v[4:7], v217, s[16:19], 0 offen offset:32
    s_mul_i32 s3, s30, 3
    s_add_u32 s3, s3, 1
    s_lshr_b32 s4, s3, 2
    s_mul_i32 s4, s4, 144
    s_and_b32 s5, s3, 3
    s_lshl_b32 s5, s5, 5
    s_add_u32 s4, s4, s5
    s_sub_u32 s5, s3, 64
    s_mul_i32 s5, s5, 288
    s_add_u32 s5, s5, 128
    s_cmp_lt_u32 s3, 64
    s_cselect_b32 s4, s4, s5
    s_cselect_b64 vcc, -1, 0
    s_nop 0
    v_cndmask_b32 v214, v216, v213, vcc
    v_add_u32 v214, s4, v214
    v_mul_lo_u32 v214, v214, s7
    v_add_u32 v218, v214, v215
    buffer_store_dwordx4 v[8:11], v218, s[16:19], 0 offen offset:0
    buffer_store_dwordx4 v[12:15], v218, s[16:19], 0 offen offset:32
    s_mul_i32 s3, s30, 3
    s_add_u32 s3, s3, 2
    s_lshr_b32 s4, s3, 2
    s_mul_i32 s4, s4, 144
    s_and_b32 s5, s3, 3
    s_lshl_b32 s5, s5, 5
    s_add_u32 s4, s4, s5
    s_sub_u32 s5, s3, 64
    s_mul_i32 s5, s5, 288
    s_add_u32 s5, s5, 128
    s_cmp_lt_u32 s3, 64
    s_cselect_b32 s4, s4, s5
    s_cselect_b64 vcc, -1, 0
    s_nop 0
    v_cndmask_b32 v214, v216, v213, vcc
    v_add_u32 v214, s4, v214
    v_mul_lo_u32 v214, v214, s7
    v_add_u32 v219, v214, v215
    buffer_store_dwordx4 v[16:19], v219, s[16:19], 0 offen offset:0
    buffer_store_dwordx4 v[20:23], v219, s[16:19], 0 offen offset:32
oproj_kernel_end:
    s_endpgm
.section .rodata,"a"
.p2align 6
.amdhsa_kernel xprep_kernel
  .amdhsa_next_free_vgpr 24
  .amdhsa_next_free_sgpr 102
  .amdhsa_accum_offset 24
  .amdhsa_group_segment_fixed_size 0
  .amdhsa_kernarg_size 104
  .amdhsa_user_sgpr_count 2
  .amdhsa_user_sgpr_kernarg_segment_ptr 1
  .amdhsa_system_sgpr_workgroup_id_x 1
.end_amdhsa_kernel
.p2align 6
.amdhsa_kernel concat_heads__gqa_block_cached__gqa_block_cached__near_ridge_kernel
  .amdhsa_next_free_vgpr 256
  .amdhsa_next_free_sgpr 102
  .amdhsa_accum_offset 256
  .amdhsa_group_segment_fixed_size 0
  .amdhsa_kernarg_size 104
  .amdhsa_user_sgpr_count 2
  .amdhsa_user_sgpr_kernarg_segment_ptr 1
  .amdhsa_system_sgpr_workgroup_id_x 1
.end_amdhsa_kernel
.p2align 6
.amdhsa_kernel oproj_kernel
  .amdhsa_next_free_vgpr 448
  .amdhsa_next_free_sgpr 102
  .amdhsa_accum_offset 256
  .amdhsa_group_segment_fixed_size 0
  .amdhsa_kernarg_size 104
  .amdhsa_user_sgpr_count 2
  .amdhsa_user_sgpr_kernarg_segment_ptr 1
  .amdhsa_system_sgpr_workgroup_id_x 1
.end_amdhsa_kernel
```
